```python
import torch

def _softmax(x, axis=-1):
    return torch.softmax(x, dim=axis)
def _gelu(x):
    return torch.nn.functional.gelu(x, approximate="tanh")
def _silu(x):
    return torch.nn.functional.silu(x)
def _sigmoid(x):
    return torch.sigmoid(x)
def _layernorm(x, axis=-1, eps=1e-5):
    m = x.mean(dim=axis, keepdim=True)
    v = x.var(dim=axis, keepdim=True, unbiased=False)
    return (x - m) / torch.sqrt(v + eps)
def _scatter_add(tgt, idx, src, axis=0):
    return tgt.clone().index_add_(axis, idx, src)
def _segment_sum(src, seg, n):
    out = torch.zeros((n,) + src.shape[1:], dtype=src.dtype)
    return out.index_add_(0, seg, src)
def _pad(x, pw):
    flat = tuple(v for pair in reversed(pw) for v in pair)
    return torch.nn.functional.pad(x, flat)

kernel_name = 'recurrent_scan__grouped_kv_mqa__glu_gated_geglu__prompt'

def setup_inputs():

    _w = (lambda a: (lambda t: t.to(torch.bfloat16) if t.is_floating_point() else t)(torch.as_tensor(a)))
    def _A_setup():
        B, S, D, H = 1, 2048, 512, 32
        Dh = D // H
        return {
            "x": _w((lambda *s: torch.randn(*s, dtype=torch.bfloat16) * 0.05)(B, S, D)),
            "wq": _w((lambda *s: torch.randn(*s, dtype=torch.bfloat16) * 0.2)(D, H * Dh)),
            "wk": _w((lambda *s: torch.randn(*s, dtype=torch.bfloat16) * 0.2)(D, Dh)),
            "wv": _w((lambda *s: torch.randn(*s, dtype=torch.bfloat16) * 0.2)(D, Dh)),
            "wo": _w((lambda *s: torch.randn(*s, dtype=torch.bfloat16) * 0.2)(H * Dh, D)),
        }
    _A_in = _A_setup()

    def _B_setup():
        B, S, Dm, Df = 1, 2048, 512, 1792
        return {
            "x": _w((lambda *s: torch.randn(*s, dtype=torch.bfloat16) * 0.05)(B, S, Dm)),
            "w_gate": _w((lambda *s: torch.randn(*s, dtype=torch.bfloat16) * 0.1)(Dm, Df) * (Dm ** -0.5)),
            "w_up": _w((lambda *s: torch.randn(*s, dtype=torch.bfloat16) * 0.1)(Dm, Df) * (Dm ** -0.5)),
            "w_down": _w((lambda *s: torch.randn(*s, dtype=torch.bfloat16) * 0.1)(Df, Dm) * (Df ** -0.5)),
        }
    _B_in = _B_setup()

    return {
        "A_x": _A_in["x"],
        "A_wq": _A_in["wq"],
        "A_wk": _A_in["wk"],
        "A_wv": _A_in["wv"],
        "A_wo": _A_in["wo"],
        "B_x": _B_in["x"],
        "B_w_gate": _B_in["w_gate"],
        "B_w_up": _B_in["w_up"],
        "B_w_down": _B_in["w_down"],
    }

def reference(A_x, A_wq, A_wk, A_wv, A_wo, B_x, B_w_gate, B_w_up, B_w_down):
    def _A_ref(x, wq, wk, wv, wo):
        B, S, D = x.shape
        H = 32
        Dh = D // H
        q = (lambda x, *d: x.permute(*d))((x @ wq).reshape(B, S, H, Dh), 0, 2, 1, 3)
        k = x @ wk
        v = x @ wv
        scores = torch.einsum("bhqd,bkd->bhqk", q, k) * (Dh ** -0.5)
        p = _softmax(scores, axis=-1)
        o = torch.einsum("bhqk,bkd->bhqd", p, v)
        return (lambda x, *d: x.permute(*d))(o, 0, 2, 1, 3).reshape(B, S, H * Dh) @ wo

    def _B_ref(x, w_gate, w_up, w_down):
        g = torch.einsum("bsd,df->bsf", x, w_gate)
        u = torch.einsum("bsd,df->bsf", x, w_up)
        h = _gelu(g) * u
        return torch.einsum("bsf,fd->bsd", h, w_down)

    x = A_x
    xn = _layernorm(x, axis=-1)
    s = _A_ref(xn, A_wq, A_wk, A_wv, A_wo)
    g = _silu(_B_ref(xn, B_w_gate, B_w_up, B_w_down))
    return x + s * g
```

```asm
; @launch grid=(256,1,1) block=(512,1,1) lds=163840
.amdgcn_target "amdgcn-amd-amdhsa--gfx950"
.text
.globl recurrent_scan__grouped_kv_mqa__glu_gated_geglu__prompt_kernel
.p2align 8
.type recurrent_scan__grouped_kv_mqa__glu_gated_geglu__prompt_kernel,@function
recurrent_scan__grouped_kv_mqa__glu_gated_geglu__prompt_kernel:
    s_cmp_ge_u32 s2, 256
    s_cbranch_scc1 L_end
    s_load_dwordx16 s[4:19], s[0:1], 0
    s_load_dwordx8 s[20:27], s[0:1], 64
    v_lshrrev_b32 v2, 6, v0
    v_and_b32 v1, 63, v0
    s_getpc_b64 s[84:85]
L_pc:
    v_readfirstlane_b32 s56, v2
    s_and_b32 s68, s2, 0xf8
    v_add_u32 v2, s68, v2
    v_lshl_add_u32 v2, v2, 1, v1
    v_lshlrev_b32 v252, 7, v2
    v_min_u32 v252, L_code_end-L_pc-4, v252
    v_mov_b32 v253, 0
    v_lshl_add_u64 v[252:253], v[252:253], 0, s[84:85]
    s_mov_b64 exec, 3
    global_load_dword v9, v[252:253], off
    s_mov_b64 exec, -1
    s_and_b32 s68, s2, 7
    s_lshr_b32 s69, s2, 3
    s_and_b32 s60, s69, 7
    s_and_b32 s70, s68, 1
    s_lshl_b32 s70, s70, 3
    s_add_u32 s57, s70, s60
    s_lshr_b32 s69, s69, 3
    s_lshr_b32 s70, s68, 1
    s_lshl_b32 s70, s70, 2
    s_add_u32 s58, s70, s69
    s_lshl_b32 s70, s68, 2
    s_add_u32 s59, s70, s69
    s_and_b32 s66, s56, 3
    s_lshl_b32 s3, s66, 12
    v_lshlrev_b32 v208, 4, v1
    s_mov_b32 s30, 0x200000
    s_mov_b32 s31, 0x20000
    s_cmp_ge_u32 s56, 4
    s_cbranch_scc1 L_helper
    v_and_b32 v5, 15, v1
    v_lshrrev_b32 v6, 4, v1
    v_lshrrev_b32 v7, 3, v1
    v_and_b32 v4, 7, v1
    s_lshl_b32 s61, s57, 3
    s_lshr_b32 s70, s58, 1
    s_add_u32 s61, s61, s70
    s_cmp_lg_u32 s66, 0
    s_cbranch_scc1 L_csld
    v_xor_b32 v2, v6, v4
    v_lshlrev_b32 v2, 4, v2
    v_lshl_add_u32 v132, v7, 10, v2
    v_xor_b32 v133, 64, v132
    v_add_u32 v133, 7168, v133
    s_lshl_b32 s64, s61, 14
    s_mov_b32 s34, 0x4000
    s_mov_b32 s35, 0x20000
    s_mov_b32 m0, 16384
    s_and_b32 s71, s58, 1
    s_waitcnt lgkmcnt(0)
    s_mov_b32 s28, s4
    s_and_b32 s29, s5, 0xffff
    buffer_load_dwordx4 v132, s[28:31], s64 offen lds
    buffer_load_dwordx4 v133, s[28:31], s64 offen offset:1024 lds
    s_mov_b32 m0, 18432
    s_add_u32 s64, s64, 128
    buffer_load_dwordx4 v132, s[28:31], s64 offen lds
    buffer_load_dwordx4 v133, s[28:31], s64 offen offset:1024 lds
    s_cmp_eq_u32 s71, 0
    s_cselect_b32 s32, s8, s10
    s_cselect_b32 s33, s9, s11
    s_and_b32 s33, s33, 0xffff
    s_mov_b32 m0, 147456
    s_movk_i32 s68, 0
    buffer_load_dwordx4 v208, s[32:35], s68 offen offset:0 lds
    buffer_load_dwordx4 v208, s[32:35], s68 offen offset:1024 lds
    buffer_load_dwordx4 v208, s[32:35], s68 offen offset:2048 lds
    buffer_load_dwordx4 v208, s[32:35], s68 offen offset:3072 lds
    s_mov_b32 m0, 20480
    s_add_u32 s64, s64, 128
    buffer_load_dwordx4 v132, s[28:31], s64 offen lds
    buffer_load_dwordx4 v133, s[28:31], s64 offen offset:1024 lds
    s_mov_b32 m0, 22528
    s_add_u32 s64, s64, 128
    buffer_load_dwordx4 v132, s[28:31], s64 offen lds
    buffer_load_dwordx4 v133, s[28:31], s64 offen offset:1024 lds
    s_mov_b32 m0, 151552
    s_movk_i32 s68, 4096
    buffer_load_dwordx4 v208, s[32:35], s68 offen offset:0 lds
    buffer_load_dwordx4 v208, s[32:35], s68 offen offset:1024 lds
    buffer_load_dwordx4 v208, s[32:35], s68 offen offset:2048 lds
    buffer_load_dwordx4 v208, s[32:35], s68 offen offset:3072 lds
    s_mov_b32 m0, 24576
    s_add_u32 s64, s64, 128
    buffer_load_dwordx4 v132, s[28:31], s64 offen lds
    buffer_load_dwordx4 v133, s[28:31], s64 offen offset:1024 lds
    s_mov_b32 m0, 26624
    s_add_u32 s64, s64, 128
    buffer_load_dwordx4 v132, s[28:31], s64 offen lds
    buffer_load_dwordx4 v133, s[28:31], s64 offen offset:1024 lds
    s_mov_b32 m0, 155648
    s_movk_i32 s68, 8192
    buffer_load_dwordx4 v208, s[32:35], s68 offen offset:0 lds
    buffer_load_dwordx4 v208, s[32:35], s68 offen offset:1024 lds
    buffer_load_dwordx4 v208, s[32:35], s68 offen offset:2048 lds
    buffer_load_dwordx4 v208, s[32:35], s68 offen offset:3072 lds
    s_mov_b32 m0, 28672
    s_add_u32 s64, s64, 128
    buffer_load_dwordx4 v132, s[28:31], s64 offen lds
    buffer_load_dwordx4 v133, s[28:31], s64 offen offset:1024 lds
    s_mov_b32 m0, 30720
    s_add_u32 s64, s64, 128
    buffer_load_dwordx4 v132, s[28:31], s64 offen lds
    buffer_load_dwordx4 v133, s[28:31], s64 offen offset:1024 lds
    s_mov_b32 m0, 159744
    s_movk_i32 s68, 12288
    buffer_load_dwordx4 v208, s[32:35], s68 offen offset:0 lds
    buffer_load_dwordx4 v208, s[32:35], s68 offen offset:1024 lds
    buffer_load_dwordx4 v208, s[32:35], s68 offen offset:2048 lds
    buffer_load_dwordx4 v208, s[32:35], s68 offen offset:3072 lds
    s_barrier
L_ld_done:
    s_mov_b32 s67, 0x3f803f80
    v_lshlrev_b32 v2, 3, v5
    v_lshl_add_u32 v2, v6, 8, v2
    v_add_u32 v130, 147456, v2
    v_lshrrev_b32 v3, 1, v5
    v_xor_b32 v3, v3, v6
    v_lshlrev_b32 v3, 4, v3
    v_lshl_add_u32 v3, v5, 7, v3
    v_mov_b32 v248, v3
    v_xor_b32 v249, 64, v3
    v_lshrrev_b32 v3, 5, v1
    v_and_b32 v7, 1, v6
    v_bfe_u32 v8, v1, 2, 2
    v_lshl_add_u32 v4, v6, 3, v8
    v_lshlrev_b32 v4, 7, v4
    v_and_b32 v2, 3, v1
    v_lshl_add_u32 v4, v2, 3, v4
    v_lshrrev_b32 v8, 1, v8
    v_lshl_add_u32 v8, v7, 1, v8
    v_xor_b32 v8, s66, v8
    v_lshl_add_u32 v8, v8, 5, v4
    v_add_u32 v250, 49152, v8
    v_add_u32 v251, 98304, v8
    s_lshr_b32 s84, s61, 1
    s_lshl_b32 s84, s84, 11
    s_and_b32 s71, s61, 1
    s_and_b32 s70, s58, 1
    s_cmp_eq_u32 s70, 0
    s_cbranch_scc0 L_pubV
    s_lshl_b32 s71, s71, 8
    s_add_u32 s84, s84, s71
    v_lshl_add_u32 v2, v3, 5, v5
    s_lshl_b32 s85, s61, 10
    s_add_u32 s85, s85, 524288
    s_branch L_pub
L_pubV:
    s_lshl_b32 s71, s71, 9
    s_add_u32 s84, s84, s71
    s_add_u32 s84, s84, 1024
    v_and_b32 v2, 3, v5
    v_bfe_u32 v4, v5, 2, 1
    v_lshl_add_u32 v2, v4, 3, v2
    v_bfe_u32 v4, v5, 3, 1
    v_lshl_add_u32 v2, v4, 2, v2
    v_lshl_add_u32 v2, v3, 4, v2
    s_mov_b32 s85, 16777216
L_pub:
    v_lshlrev_b32 v2, 4, v2
    v_lshl_add_u32 v220, v7, 3, v2
    s_mov_b32 s52, s26
    s_and_b32 s53, s27, 0xffff
    s_mov_b32 s54, 0x1000000
    s_mov_b32 s55, 0x20000
    v_and_b32 v6, 7, v1
    v_lshrrev_b32 v4, 4, v1
    v_lshl_add_u32 v6, v6, 2, v4
    v_bfe_u32 v4, v1, 3, 1
    v_lshl_add_u32 v6, v6, 1, v4
    v_lshlrev_b32 v222, 2, v6
    s_lshl_b32 s68, s58, 14
    s_lshl_b32 s69, s57, 10
    s_add_u32 s68, s68, s69
    s_lshl_b32 s69, s66, 8
    s_add_u32 s68, s68, s69
    s_add_u32 s88, s68, 262144
    s_cmp_lg_u32 s66, 0
    s_cbranch_scc1 L_cs
    v_mov_b32 v100, s67
    v_mov_b32 v101, s67
    v_mov_b32 v102, s67
    v_mov_b32 v103, s67
    v_mov_b32 v107, 1.0
    v_mov_b32 v106, 0
    v_mov_b32 v104, 0
    v_mov_b32 v105, 0
    v_mov_b32 v221, 0
    s_mov_b32 s68, 0x00100001
    s_mov_b32 s69, 0x10000100
    s_lshl_b64 exec, s[68:69], 0
    v_mov_b32 v104, 0x4780
    s_lshl_b64 exec, s[68:69], 1
    v_mov_b32 v104, 0x47800000
    s_lshl_b64 exec, s[68:69], 2
    v_mov_b32 v105, 0x4780
    s_lshl_b64 exec, s[68:69], 3
    v_mov_b32 v105, 0x47800000
    s_mov_b64 exec, -1
    s_waitcnt vmcnt(24)
    ds_read_b128 v[16:19], v248 offset:16384
    ds_read_b64_tr_b16 v[20:21], v130 offset:0
    ds_read_b64_tr_b16 v[22:23], v130 offset:128
    ds_read_b128 v[24:27], v249 offset:16384
    ds_read_b64_tr_b16 v[28:29], v130 offset:1024
    ds_read_b64_tr_b16 v[30:31], v130 offset:1152
    ds_read_b128 v[32:35], v248 offset:18432
    ds_read_b64_tr_b16 v[36:37], v130 offset:2048
    ds_read_b64_tr_b16 v[38:39], v130 offset:2176
    ds_read_b128 v[40:43], v249 offset:18432
    ds_read_b64_tr_b16 v[44:45], v130 offset:3072
    ds_read_b64_tr_b16 v[46:47], v130 offset:3200
    s_waitcnt lgkmcnt(0)
    v_mfma_f32_16x16x32_bf16 v[92:95], v[16:19], v[16:19], 0
    v_mfma_f32_16x16x32_bf16 v[88:91], v[100:103], v[16:19], 0
    v_mfma_f32_16x16x32_bf16 v[84:87], v[20:23], v[100:103], 0
    v_mfma_f32_16x16x32_bf16 v[80:83], v[20:23], v[16:19], 0
    s_waitcnt vmcnt(16)
    ds_read_b128 v[48:51], v248 offset:20480
    v_mfma_f32_16x16x32_bf16 v[92:95], v[24:27], v[24:27], v[92:95]
    ds_read_b64_tr_b16 v[52:53], v130 offset:4096
    v_mfma_f32_16x16x32_bf16 v[88:91], v[100:103], v[24:27], v[88:91]
    ds_read_b64_tr_b16 v[54:55], v130 offset:4224
    v_mfma_f32_16x16x32_bf16 v[84:87], v[28:31], v[100:103], v[84:87]
    ds_read_b128 v[56:59], v249 offset:20480
    v_mfma_f32_16x16x32_bf16 v[80:83], v[28:31], v[24:27], v[80:83]
    ds_read_b64_tr_b16 v[60:61], v130 offset:5120
    v_mfma_f32_16x16x32_bf16 v[92:95], v[32:35], v[32:35], v[92:95]
    ds_read_b64_tr_b16 v[62:63], v130 offset:5248
    v_mfma_f32_16x16x32_bf16 v[88:91], v[100:103], v[32:35], v[88:91]
    ds_read_b128 v[64:67], v248 offset:22528
    v_mfma_f32_16x16x32_bf16 v[84:87], v[36:39], v[100:103], v[84:87]
    ds_read_b64_tr_b16 v[68:69], v130 offset:6144
    v_mfma_f32_16x16x32_bf16 v[80:83], v[36:39], v[32:35], v[80:83]
    ds_read_b64_tr_b16 v[70:71], v130 offset:6272
    v_mfma_f32_16x16x32_bf16 v[92:95], v[40:43], v[40:43], v[92:95]
    ds_read_b128 v[72:75], v249 offset:22528
    v_mfma_f32_16x16x32_bf16 v[88:91], v[100:103], v[40:43], v[88:91]
    ds_read_b64_tr_b16 v[76:77], v130 offset:7168
    v_mfma_f32_16x16x32_bf16 v[84:87], v[44:47], v[100:103], v[84:87]
    ds_read_b64_tr_b16 v[78:79], v130 offset:7296
    v_mfma_f32_16x16x32_bf16 v[80:83], v[44:47], v[40:43], v[80:83]
    s_waitcnt lgkmcnt(0)
    v_mfma_f32_16x16x32_bf16 v[92:95], v[48:51], v[48:51], v[92:95]
    v_mfma_f32_16x16x32_bf16 v[88:91], v[100:103], v[48:51], v[88:91]
    v_mfma_f32_16x16x32_bf16 v[84:87], v[52:55], v[100:103], v[84:87]
    v_mfma_f32_16x16x32_bf16 v[80:83], v[52:55], v[48:51], v[80:83]
    s_waitcnt vmcnt(8)
    ds_read_b128 v[16:19], v248 offset:24576
    v_mfma_f32_16x16x32_bf16 v[92:95], v[56:59], v[56:59], v[92:95]
    ds_read_b64_tr_b16 v[20:21], v130 offset:8192
    v_mfma_f32_16x16x32_bf16 v[88:91], v[100:103], v[56:59], v[88:91]
    ds_read_b64_tr_b16 v[22:23], v130 offset:8320
    v_mfma_f32_16x16x32_bf16 v[84:87], v[60:63], v[100:103], v[84:87]
    ds_read_b128 v[24:27], v249 offset:24576
    v_mfma_f32_16x16x32_bf16 v[80:83], v[60:63], v[56:59], v[80:83]
    ds_read_b64_tr_b16 v[28:29], v130 offset:9216
    v_mfma_f32_16x16x32_bf16 v[92:95], v[64:67], v[64:67], v[92:95]
    ds_read_b64_tr_b16 v[30:31], v130 offset:9344
    v_mfma_f32_16x16x32_bf16 v[88:91], v[100:103], v[64:67], v[88:91]
    ds_read_b128 v[32:35], v248 offset:26624
    v_mfma_f32_16x16x32_bf16 v[84:87], v[68:71], v[100:103], v[84:87]
    ds_read_b64_tr_b16 v[36:37], v130 offset:10240
    v_mfma_f32_16x16x32_bf16 v[80:83], v[68:71], v[64:67], v[80:83]
    ds_read_b64_tr_b16 v[38:39], v130 offset:10368
    v_mfma_f32_16x16x32_bf16 v[92:95], v[72:75], v[72:75], v[92:95]
    ds_read_b128 v[40:43], v249 offset:26624
    v_mfma_f32_16x16x32_bf16 v[88:91], v[100:103], v[72:75], v[88:91]
    ds_read_b64_tr_b16 v[44:45], v130 offset:11264
    v_mfma_f32_16x16x32_bf16 v[84:87], v[76:79], v[100:103], v[84:87]
    ds_read_b64_tr_b16 v[46:47], v130 offset:11392
    v_mfma_f32_16x16x32_bf16 v[80:83], v[76:79], v[72:75], v[80:83]
    s_waitcnt lgkmcnt(0)
    v_mfma_f32_16x16x32_bf16 v[92:95], v[16:19], v[16:19], v[92:95]
    v_mfma_f32_16x16x32_bf16 v[88:91], v[100:103], v[16:19], v[88:91]
    v_mfma_f32_16x16x32_bf16 v[84:87], v[20:23], v[100:103], v[84:87]
    v_mfma_f32_16x16x32_bf16 v[80:83], v[20:23], v[16:19], v[80:83]
    s_waitcnt vmcnt(0)
    ds_read_b128 v[48:51], v248 offset:28672
    v_mfma_f32_16x16x32_bf16 v[92:95], v[24:27], v[24:27], v[92:95]
    ds_read_b64_tr_b16 v[52:53], v130 offset:12288
    v_mfma_f32_16x16x32_bf16 v[88:91], v[100:103], v[24:27], v[88:91]
    ds_read_b64_tr_b16 v[54:55], v130 offset:12416
    v_mfma_f32_16x16x32_bf16 v[84:87], v[28:31], v[100:103], v[84:87]
    ds_read_b128 v[56:59], v249 offset:28672
    v_mfma_f32_16x16x32_bf16 v[80:83], v[28:31], v[24:27], v[80:83]
    ds_read_b64_tr_b16 v[60:61], v130 offset:13312
    v_mfma_f32_16x16x32_bf16 v[92:95], v[32:35], v[32:35], v[92:95]
    ds_read_b64_tr_b16 v[62:63], v130 offset:13440
    v_mfma_f32_16x16x32_bf16 v[88:91], v[100:103], v[32:35], v[88:91]
    ds_read_b128 v[64:67], v248 offset:30720
    v_mfma_f32_16x16x32_bf16 v[84:87], v[36:39], v[100:103], v[84:87]
    ds_read_b64_tr_b16 v[68:69], v130 offset:14336
    v_mfma_f32_16x16x32_bf16 v[80:83], v[36:39], v[32:35], v[80:83]
    ds_read_b64_tr_b16 v[70:71], v130 offset:14464
    v_mfma_f32_16x16x32_bf16 v[92:95], v[40:43], v[40:43], v[92:95]
    ds_read_b128 v[72:75], v249 offset:30720
    v_mfma_f32_16x16x32_bf16 v[88:91], v[100:103], v[40:43], v[88:91]
    ds_read_b64_tr_b16 v[76:77], v130 offset:15360
    v_mfma_f32_16x16x32_bf16 v[84:87], v[44:47], v[100:103], v[84:87]
    ds_read_b64_tr_b16 v[78:79], v130 offset:15488
    v_mfma_f32_16x16x32_bf16 v[80:83], v[44:47], v[40:43], v[80:83]
    s_waitcnt lgkmcnt(0)
    v_mfma_f32_16x16x32_bf16 v[92:95], v[48:51], v[48:51], v[92:95]
    v_mfma_f32_16x16x32_bf16 v[88:91], v[100:103], v[48:51], v[88:91]
    v_mfma_f32_16x16x32_bf16 v[84:87], v[52:55], v[100:103], v[84:87]
    v_mfma_f32_16x16x32_bf16 v[80:83], v[52:55], v[48:51], v[80:83]
    v_mfma_f32_16x16x32_bf16 v[92:95], v[56:59], v[56:59], v[92:95]
    v_mfma_f32_16x16x32_bf16 v[88:91], v[100:103], v[56:59], v[88:91]
    v_mfma_f32_16x16x32_bf16 v[84:87], v[60:63], v[100:103], v[84:87]
    v_mfma_f32_16x16x32_bf16 v[80:83], v[60:63], v[56:59], v[80:83]
    v_mfma_f32_16x16x32_bf16 v[92:95], v[64:67], v[64:67], v[92:95]
    v_mfma_f32_16x16x32_bf16 v[88:91], v[100:103], v[64:67], v[88:91]
    v_mfma_f32_16x16x32_bf16 v[84:87], v[68:71], v[100:103], v[84:87]
    v_mfma_f32_16x16x32_bf16 v[80:83], v[68:71], v[64:67], v[80:83]
    v_mfma_f32_16x16x32_bf16 v[92:95], v[72:75], v[72:75], v[92:95]
    v_mfma_f32_16x16x32_bf16 v[88:91], v[100:103], v[72:75], v[88:91]
    v_mfma_f32_16x16x32_bf16 v[84:87], v[76:79], v[100:103], v[84:87]
    v_mfma_f32_16x16x32_bf16 v[80:83], v[76:79], v[72:75], v[80:83]
    s_nop 3
    s_lshl_b64 exec, s[68:69], 0
    v_mov_b32 v106, v92
    s_lshl_b64 exec, s[68:69], 1
    v_mov_b32 v106, v93
    s_lshl_b64 exec, s[68:69], 2
    v_mov_b32 v106, v94
    s_lshl_b64 exec, s[68:69], 3
    v_mov_b32 v106, v95
    s_mov_b64 exec, -1
    v_mul_f32 v88, 0xbb000000, v88
    v_mfma_f32_16x16x4_f32 v[96:99], v107, v106, 0
    v_fmac_f32 v80, v88, v84
    v_fmac_f32 v81, v88, v85
    v_fmac_f32 v82, v88, v86
    v_fmac_f32 v83, v88, v87
    v_cvt_pk_bf16_f32 v12, v88, v88
    v_and_b32 v2, 0xffff0000, v12
    v_sub_f32 v2, v88, v2
    v_cvt_pk_bf16_f32 v12, v88, v2
    s_and_b32 s70, s58, 1
    s_cmp_eq_u32 s70, 0
    v_mul_f32 v14, 0x3b000000, v96
    v_fma_f32 v14, -v88, v88, v14
    v_max_f32 v14, 0, v14
    v_add_f32 v14, 0x3727c5ac, v14
    v_rsq_f32 v3, v14
    s_nop 0
    v_mul_f32 v80, v80, v3
    v_mul_f32 v81, v81, v3
    v_mul_f32 v82, v82, v3
    v_mul_f32 v83, v83, v3
    v_cvt_pk_bf16_f32 v216, v80, v81
    v_cvt_pk_bf16_f32 v217, v82, v83
    s_cbranch_scc0 L_preV
    s_mov_b32 exec_lo, 0
    v_mov_b32 v12, 0
    s_and_b32 s68, s61, 1
    s_sub_u32 exec_lo, s68, 1
    s_mov_b32 exec_hi, exec_lo
    v_swap_b32 v12, v14
    s_mov_b32 exec_lo, 0xffff0000
    s_mov_b32 exec_hi, 0
    v_mul_f32 v12, 0xc0135761, v3
    v_mul_f32 v2, v3, v3
    v_mul_f32 v14, 0x3d372713, v12
    v_mul_f32 v14, v14, v2
    s_mov_b64 exec, -1
    v_mov_b32 v13, v12
    v_mov_b32 v15, v14
    s_branch L_nofin
L_preV:
    s_nop 0
    v_mfma_f32_16x16x16_bf16 v[80:83], v[216:217], v[104:105], 0
    s_nop 7
    v_cvt_pk_bf16_f32 v216, v80, v81
    v_cvt_pk_bf16_f32 v217, v82, v83
    s_branch L_nofin
L_cs:
    s_cmp_eq_u32 s66, 1
    s_cbranch_scc0 L_nt1
    s_call_b64 s[0:1], L_stub1
L_nt1:
    s_cmp_eq_u32 s66, 2
    s_cbranch_scc0 L_nt16
    s_call_b64 s[0:1], L_stub16
L_nt16:
    s_cmp_eq_u32 s66, 3
    s_cbranch_scc0 L_nt52
    s_call_b64 s[0:1], L_stub52
L_nt52:
    s_waitcnt vmcnt(5)
    v_lshlrev_b32 v40, 16, v16
    v_and_b32 v41, 0xffff0000, v16
    v_lshlrev_b32 v42, 16, v17
    v_and_b32 v43, 0xffff0000, v17
    v_lshlrev_b32 v44, 16, v18
    v_and_b32 v45, 0xffff0000, v18
    v_lshlrev_b32 v46, 16, v19
    v_and_b32 v47, 0xffff0000, v19
    s_waitcnt vmcnt(4)
    v_lshlrev_b32 v2, 16, v20
    v_and_b32 v3, 0xffff0000, v20
    v_add_f32 v40, v40, v2
    v_add_f32 v41, v41, v3
    v_lshlrev_b32 v2, 16, v21
    v_and_b32 v3, 0xffff0000, v21
    v_add_f32 v42, v42, v2
    v_add_f32 v43, v43, v3
    v_lshlrev_b32 v2, 16, v22
    v_and_b32 v3, 0xffff0000, v22
    v_add_f32 v44, v44, v2
    v_add_f32 v45, v45, v3
    v_lshlrev_b32 v2, 16, v23
    v_and_b32 v3, 0xffff0000, v23
    v_add_f32 v46, v46, v2
    v_add_f32 v47, v47, v3
    s_waitcnt vmcnt(3)
    v_lshlrev_b32 v2, 16, v24
    v_and_b32 v3, 0xffff0000, v24
    v_add_f32 v40, v40, v2
    v_add_f32 v41, v41, v3
    v_lshlrev_b32 v2, 16, v25
    v_and_b32 v3, 0xffff0000, v25
    v_add_f32 v42, v42, v2
    v_add_f32 v43, v43, v3
    v_lshlrev_b32 v2, 16, v26
    v_and_b32 v3, 0xffff0000, v26
    v_add_f32 v44, v44, v2
    v_add_f32 v45, v45, v3
    v_lshlrev_b32 v2, 16, v27
    v_and_b32 v3, 0xffff0000, v27
    v_add_f32 v46, v46, v2
    v_add_f32 v47, v47, v3
    s_waitcnt vmcnt(2)
    v_lshlrev_b32 v2, 16, v28
    v_and_b32 v3, 0xffff0000, v28
    v_add_f32 v40, v40, v2
    v_add_f32 v41, v41, v3
    v_lshlrev_b32 v2, 16, v29
    v_and_b32 v3, 0xffff0000, v29
    v_add_f32 v42, v42, v2
    v_add_f32 v43, v43, v3
    v_lshlrev_b32 v2, 16, v30
    v_and_b32 v3, 0xffff0000, v30
    v_add_f32 v44, v44, v2
    v_add_f32 v45, v45, v3
    v_lshlrev_b32 v2, 16, v31
    v_and_b32 v3, 0xffff0000, v31
    v_add_f32 v46, v46, v2
    v_add_f32 v47, v47, v3
    s_waitcnt vmcnt(1)
    v_lshlrev_b32 v2, 16, v32
    v_and_b32 v3, 0xffff0000, v32
    v_add_f32 v40, v40, v2
    v_add_f32 v41, v41, v3
    v_lshlrev_b32 v2, 16, v33
    v_and_b32 v3, 0xffff0000, v33
    v_add_f32 v42, v42, v2
    v_add_f32 v43, v43, v3
    v_lshlrev_b32 v2, 16, v34
    v_and_b32 v3, 0xffff0000, v34
    v_add_f32 v44, v44, v2
    v_add_f32 v45, v45, v3
    v_lshlrev_b32 v2, 16, v35
    v_and_b32 v3, 0xffff0000, v35
    v_add_f32 v46, v46, v2
    v_add_f32 v47, v47, v3
    s_waitcnt vmcnt(0)
    v_lshlrev_b32 v2, 16, v36
    v_and_b32 v3, 0xffff0000, v36
    v_add_f32 v40, v40, v2
    v_add_f32 v41, v41, v3
    v_lshlrev_b32 v2, 16, v37
    v_and_b32 v3, 0xffff0000, v37
    v_add_f32 v42, v42, v2
    v_add_f32 v43, v43, v3
    v_lshlrev_b32 v2, 16, v38
    v_and_b32 v3, 0xffff0000, v38
    v_add_f32 v44, v44, v2
    v_add_f32 v45, v45, v3
    v_lshlrev_b32 v2, 16, v39
    v_and_b32 v3, 0xffff0000, v39
    v_add_f32 v46, v46, v2
    v_add_f32 v47, v47, v3
    v_permlane32_swap_b32 v40, v44
    v_permlane32_swap_b32 v41, v45
    v_permlane32_swap_b32 v42, v46
    v_permlane32_swap_b32 v43, v47
    v_add_f32 v40, v40, v44
    v_add_f32 v42, v42, v46
    v_add_f32 v41, v41, v45
    v_add_f32 v43, v43, v47
    v_permlane16_swap_b32 v40, v42
    s_nop 0
    v_permlane16_swap_b32 v41, v43
    v_add_f32 v40, v40, v42
    v_add_f32 v41, v41, v43
    s_nop 0
    v_add_f32_dpp v221, v40, v40 row_ror:8 row_mask:0xf bank_mask:0xf
    v_add_f32_dpp v221, v41, v41 row_ror:8 row_mask:0xf bank_mask:0xc
L_nofin:
    s_barrier
    ds_read_b128 v[144:147], v248 offset:32768
    ds_read_b128 v[148:151], v249 offset:32768
    ds_read_b128 v[152:155], v248 offset:34816
    ds_read_b128 v[156:159], v249 offset:34816
    ds_read_b64_tr_b16 v[176:177], v250 offset:16384
    ds_read_b64_tr_b16 v[178:179], v250 offset:16896
    ds_read_b64_tr_b16 v[180:181], v250 offset:20480
    ds_read_b64_tr_b16 v[182:183], v250 offset:20992
    ds_read_b64_tr_b16 v[184:185], v250 offset:40960
    ds_read_b64_tr_b16 v[186:187], v250 offset:41472
    ds_read_b64_tr_b16 v[188:189], v250 offset:45056
    ds_read_b64_tr_b16 v[190:191], v250 offset:45568
    ds_read_b64_tr_b16 v[192:193], v251 offset:16384
    ds_read_b64_tr_b16 v[194:195], v251 offset:16896
    ds_read_b64_tr_b16 v[196:197], v251 offset:20480
    ds_read_b64_tr_b16 v[198:199], v251 offset:20992
    s_branch L_pg1
.p2align 12
L_stub1:
    s_nop 0
    s_setpc_b64 s[0:1]
L_pg1:
    s_waitcnt lgkmcnt(8)
    v_mfma_f32_16x16x32_bf16 v[16:19], v[176:179], v[144:147], 0
    ds_read_b64_tr_b16 v[200:201], v251 offset:40960
    v_mfma_f32_16x16x32_bf16 v[16:19], v[180:183], v[148:151], v[16:19]
    ds_read_b64_tr_b16 v[202:203], v251 offset:41472
    v_mfma_f32_16x16x32_bf16 v[20:23], v[180:183], v[156:159], 0
    ds_read_b64_tr_b16 v[204:205], v251 offset:45056
    v_mfma_f32_16x16x32_bf16 v[20:23], v[176:179], v[152:155], v[20:23]
    ds_read_b64_tr_b16 v[206:207], v251 offset:45568
    s_waitcnt lgkmcnt(4)
    v_mfma_f32_16x16x32_bf16 v[28:31], v[184:187], v[152:155], 0
    ds_read_b128 v[160:163], v248 offset:36864
    v_mfma_f32_16x16x32_bf16 v[28:31], v[188:191], v[156:159], v[28:31]
    ds_read_b128 v[164:167], v249 offset:36864
    v_mfma_f32_16x16x32_bf16 v[24:27], v[188:191], v[148:151], 0
    ds_read_b128 v[168:171], v248 offset:38912
    v_mfma_f32_16x16x32_bf16 v[24:27], v[184:187], v[144:147], v[24:27]
    ds_read_b128 v[172:175], v249 offset:38912
    v_mfma_f32_16x16x32_bf16 v[80:83], v[192:195], v[144:147], 0
    v_mfma_f32_16x16x32_bf16 v[80:83], v[196:199], v[148:151], v[80:83]
    v_mfma_f32_16x16x32_bf16 v[84:87], v[196:199], v[156:159], 0
    v_mfma_f32_16x16x32_bf16 v[84:87], v[192:195], v[152:155], v[84:87]
    s_waitcnt lgkmcnt(4)
    v_mfma_f32_16x16x32_bf16 v[92:95], v[200:203], v[152:155], 0
    v_mfma_f32_16x16x32_bf16 v[92:95], v[204:207], v[156:159], v[92:95]
    v_mfma_f32_16x16x32_bf16 v[88:91], v[204:207], v[148:151], 0
    v_mfma_f32_16x16x32_bf16 v[88:91], v[200:203], v[144:147], v[88:91]
    s_waitcnt lgkmcnt(0)
    v_mfma_f32_16x16x32_bf16 v[32:35], v[176:179], v[160:163], 0
    ds_read_b128 v[144:147], v248 offset:40960
    v_mfma_f32_16x16x32_bf16 v[32:35], v[180:183], v[164:167], v[32:35]
    v_mfma_f32_16x16x32_bf16 v[36:39], v[180:183], v[172:175], 0
    ds_read_b128 v[148:151], v249 offset:40960
    v_mfma_f32_16x16x32_bf16 v[36:39], v[176:179], v[168:171], v[36:39]
    v_mfma_f32_16x16x32_bf16 v[44:47], v[184:187], v[168:171], 0
    ds_read_b128 v[152:155], v248 offset:43008
    v_mfma_f32_16x16x32_bf16 v[44:47], v[188:191], v[172:175], v[44:47]
    v_mfma_f32_16x16x32_bf16 v[40:43], v[188:191], v[164:167], 0
    ds_read_b128 v[156:159], v249 offset:43008
    v_mfma_f32_16x16x32_bf16 v[40:43], v[184:187], v[160:163], v[40:43]
    v_mfma_f32_16x16x32_bf16 v[96:99], v[192:195], v[160:163], 0
    v_mfma_f32_16x16x32_bf16 v[96:99], v[196:199], v[164:167], v[96:99]
    v_mfma_f32_16x16x32_bf16 v[100:103], v[196:199], v[172:175], 0
    v_mfma_f32_16x16x32_bf16 v[100:103], v[192:195], v[168:171], v[100:103]
    v_mfma_f32_16x16x32_bf16 v[108:111], v[200:203], v[168:171], 0
    v_mfma_f32_16x16x32_bf16 v[108:111], v[204:207], v[172:175], v[108:111]
    v_mfma_f32_16x16x32_bf16 v[104:107], v[204:207], v[164:167], 0
    v_mfma_f32_16x16x32_bf16 v[104:107], v[200:203], v[160:163], v[104:107]
    s_waitcnt lgkmcnt(0)
    v_mfma_f32_16x16x32_bf16 v[48:51], v[176:179], v[144:147], 0
    ds_read_b128 v[160:163], v248 offset:45056
    v_mfma_f32_16x16x32_bf16 v[48:51], v[180:183], v[148:151], v[48:51]
    v_mfma_f32_16x16x32_bf16 v[52:55], v[180:183], v[156:159], 0
    ds_read_b128 v[164:167], v249 offset:45056
    v_mfma_f32_16x16x32_bf16 v[52:55], v[176:179], v[152:155], v[52:55]
    v_mfma_f32_16x16x32_bf16 v[60:63], v[184:187], v[152:155], 0
    ds_read_b128 v[168:171], v248 offset:47104
    v_mfma_f32_16x16x32_bf16 v[60:63], v[188:191], v[156:159], v[60:63]
    v_mfma_f32_16x16x32_bf16 v[56:59], v[188:191], v[148:151], 0
    ds_read_b128 v[172:175], v249 offset:47104
    v_mfma_f32_16x16x32_bf16 v[56:59], v[184:187], v[144:147], v[56:59]
    v_mfma_f32_16x16x32_bf16 v[112:115], v[192:195], v[144:147], 0
    v_mfma_f32_16x16x32_bf16 v[112:115], v[196:199], v[148:151], v[112:115]
    buffer_store_dword v221, v222, s[52:55], s88 offen sc1
    v_mfma_f32_16x16x32_bf16 v[116:119], v[196:199], v[156:159], 0
    v_mfma_f32_16x16x32_bf16 v[116:119], v[192:195], v[152:155], v[116:119]
    v_mfma_f32_16x16x32_bf16 v[124:127], v[200:203], v[152:155], 0
    s_cmp_lg_u32 s66, 0
    s_cbranch_scc1 L_nopub
    buffer_store_dwordx2 v[216:217], v220, s[52:55], s84 offen sc1
    buffer_store_dwordx4 v[12:15], v208, s[52:55], s85 offen sc1
L_nopub:
    v_mfma_f32_16x16x32_bf16 v[124:127], v[204:207], v[156:159], v[124:127]
    v_mfma_f32_16x16x32_bf16 v[120:123], v[204:207], v[148:151], 0
    v_mfma_f32_16x16x32_bf16 v[120:123], v[200:203], v[144:147], v[120:123]
    s_waitcnt lgkmcnt(0)
    v_mfma_f32_16x16x32_bf16 v[64:67], v[176:179], v[160:163], 0
    s_barrier
    ds_read_b128 v[144:147], v248 offset:0
    v_mfma_f32_16x16x32_bf16 v[64:67], v[180:183], v[164:167], v[64:67]
    ds_read_b128 v[148:151], v249 offset:0
    v_mfma_f32_16x16x32_bf16 v[68:71], v[180:183], v[172:175], 0
    ds_read_b128 v[152:155], v248 offset:2048
    v_mfma_f32_16x16x32_bf16 v[68:71], v[176:179], v[168:171], v[68:71]
    ds_read_b128 v[156:159], v249 offset:2048
    v_mfma_f32_16x16x32_bf16 v[76:79], v[184:187], v[168:171], 0
    ds_read_b64_tr_b16 v[176:177], v250 offset:0
    v_mfma_f32_16x16x32_bf16 v[76:79], v[188:191], v[172:175], v[76:79]
    ds_read_b64_tr_b16 v[178:179], v250 offset:512
    v_mfma_f32_16x16x32_bf16 v[72:75], v[188:191], v[164:167], 0
    ds_read_b64_tr_b16 v[180:181], v250 offset:4096
    v_mfma_f32_16x16x32_bf16 v[72:75], v[184:187], v[160:163], v[72:75]
    ds_read_b64_tr_b16 v[182:183], v250 offset:4608
    v_mfma_f32_16x16x32_bf16 v[128:131], v[192:195], v[160:163], 0
    ds_read_b64_tr_b16 v[184:185], v250 offset:24576
    v_mfma_f32_16x16x32_bf16 v[128:131], v[196:199], v[164:167], v[128:131]
    ds_read_b64_tr_b16 v[186:187], v250 offset:25088
    v_mfma_f32_16x16x32_bf16 v[132:135], v[196:199], v[172:175], 0
    ds_read_b64_tr_b16 v[188:189], v250 offset:28672
    v_mfma_f32_16x16x32_bf16 v[132:135], v[192:195], v[168:171], v[132:135]
    ds_read_b64_tr_b16 v[190:191], v250 offset:29184
    v_mfma_f32_16x16x32_bf16 v[140:143], v[200:203], v[168:171], 0
    ds_read_b64_tr_b16 v[192:193], v251 offset:0
    v_mfma_f32_16x16x32_bf16 v[140:143], v[204:207], v[172:175], v[140:143]
    ds_read_b64_tr_b16 v[194:195], v251 offset:512
    v_mfma_f32_16x16x32_bf16 v[136:139], v[204:207], v[164:167], 0
    ds_read_b64_tr_b16 v[196:197], v251 offset:4096
    v_mfma_f32_16x16x32_bf16 v[136:139], v[200:203], v[160:163], v[136:139]
    ds_read_b64_tr_b16 v[198:199], v251 offset:4608
    s_waitcnt lgkmcnt(8)
    v_mfma_f32_16x16x32_bf16 v[16:19], v[176:179], v[144:147], v[16:19]
    ds_read_b64_tr_b16 v[200:201], v251 offset:24576
    v_mfma_f32_16x16x32_bf16 v[16:19], v[180:183], v[148:151], v[16:19]
    ds_read_b64_tr_b16 v[202:203], v251 offset:25088
    v_mfma_f32_16x16x32_bf16 v[20:23], v[180:183], v[156:159], v[20:23]
    ds_read_b64_tr_b16 v[204:205], v251 offset:28672
    v_mfma_f32_16x16x32_bf16 v[20:23], v[176:179], v[152:155], v[20:23]
    ds_read_b64_tr_b16 v[206:207], v251 offset:29184
    s_waitcnt lgkmcnt(4)
    v_mfma_f32_16x16x32_bf16 v[28:31], v[184:187], v[152:155], v[28:31]
    ds_read_b128 v[160:163], v248 offset:4096
    v_mfma_f32_16x16x32_bf16 v[28:31], v[188:191], v[156:159], v[28:31]
    ds_read_b128 v[164:167], v249 offset:4096
    v_mfma_f32_16x16x32_bf16 v[24:27], v[188:191], v[148:151], v[24:27]
    ds_read_b128 v[168:171], v248 offset:6144
    v_mfma_f32_16x16x32_bf16 v[24:27], v[184:187], v[144:147], v[24:27]
    ds_read_b128 v[172:175], v249 offset:6144
    v_mfma_f32_16x16x32_bf16 v[80:83], v[192:195], v[144:147], v[80:83]
    s_lshr_b32 s75, s56, 1
    s_and_b32 s76, s56, 1
    v_mfma_f32_16x16x32_bf16 v[80:83], v[196:199], v[148:151], v[80:83]
    s_lshl_b32 s70, s59, 1
    s_add_u32 s70, s70, s76
    v_mfma_f32_16x16x32_bf16 v[84:87], v[196:199], v[156:159], v[84:87]
    s_lshl_b32 s68, s70, 3
    s_add_u32 s68, s68, s60
    v_mfma_f32_16x16x32_bf16 v[84:87], v[192:195], v[152:155], v[84:87]
    s_waitcnt lgkmcnt(4)
    v_mfma_f32_16x16x32_bf16 v[92:95], v[200:203], v[152:155], v[92:95]
    s_lshl_b32 s68, s68, 2
    s_add_u32 s68, s68, s75
    v_mfma_f32_16x16x32_bf16 v[92:95], v[204:207], v[156:159], v[92:95]
    s_lshl_b32 s68, s68, 10
    s_add_u32 s72, s68, 1048576
    v_mfma_f32_16x16x32_bf16 v[88:91], v[204:207], v[148:151], v[88:91]
    s_lshl_b32 s68, s2, 7
    s_lshl_b32 s69, s56, 2
    v_mfma_f32_16x16x32_bf16 v[88:91], v[200:203], v[144:147], v[88:91]
    s_add_u32 s68, s68, s69
    s_add_u32 s73, s68, 163840
    s_waitcnt lgkmcnt(0)
    v_mfma_f32_16x16x32_bf16 v[32:35], v[176:179], v[160:163], v[32:35]
    ds_read_b128 v[144:147], v248 offset:8192
    v_mfma_f32_16x16x32_bf16 v[32:35], v[180:183], v[164:167], v[32:35]
    v_mov_b32 v12, -1
    v_mov_b32 v13, -1
    v_mfma_f32_16x16x32_bf16 v[36:39], v[180:183], v[172:175], v[36:39]
    ds_read_b128 v[148:151], v249 offset:8192
    v_mfma_f32_16x16x32_bf16 v[36:39], v[176:179], v[168:171], v[36:39]
    v_mov_b32 v14, -1
    v_mov_b32 v15, -1
    v_mfma_f32_16x16x32_bf16 v[44:47], v[184:187], v[168:171], v[44:47]
    ds_read_b128 v[152:155], v248 offset:10240
    v_mfma_f32_16x16x32_bf16 v[44:47], v[188:191], v[172:175], v[44:47]
    s_mov_b32 s36, s20
    s_and_b32 s37, s21, 0xffff
    v_mfma_f32_16x16x32_bf16 v[40:43], v[188:191], v[164:167], v[40:43]
    ds_read_b128 v[156:159], v249 offset:10240
    v_mfma_f32_16x16x32_bf16 v[40:43], v[184:187], v[160:163], v[40:43]
    s_mov_b32 s38, 0x1c0000
    s_mov_b32 s39, 0x20000
    v_mfma_f32_16x16x32_bf16 v[96:99], v[192:195], v[160:163], v[96:99]
    s_mov_b32 s40, s12
    s_and_b32 s41, s13, 0xffff
    v_mfma_f32_16x16x32_bf16 v[96:99], v[196:199], v[164:167], v[96:99]
    s_mov_b32 s42, 0x80000
    s_mov_b32 s43, 0x20000
    v_mfma_f32_16x16x32_bf16 v[100:103], v[196:199], v[172:175], v[100:103]
    s_mov_b32 s44, s22
    s_and_b32 s45, s23, 0xffff
    v_mfma_f32_16x16x32_bf16 v[100:103], v[192:195], v[168:171], v[100:103]
    s_mov_b32 s46, 0x200000
    s_mov_b32 s47, 0x20000
    v_mfma_f32_16x16x32_bf16 v[108:111], v[200:203], v[168:171], v[108:111]
    s_lshl_b32 s79, s56, 12
    s_lshl_b32 s80, s56, 11
    v_mfma_f32_16x16x32_bf16 v[108:111], v[204:207], v[172:175], v[108:111]
    s_mov_b32 s62, 0xffff
    s_mov_b32 s63, 0xffff
    v_mfma_f32_16x16x32_bf16 v[104:107], v[204:207], v[164:167], v[104:107]
    s_lshl_b32 s70, s59, 1
    s_add_u32 s70, s70, s76
    v_mfma_f32_16x16x32_bf16 v[104:107], v[200:203], v[160:163], v[104:107]
    s_mul_i32 s68, s75, 458752
    s_lshl_b32 s69, s76, 15
    s_waitcnt lgkmcnt(0)
    v_mfma_f32_16x16x32_bf16 v[48:51], v[176:179], v[144:147], v[48:51]
    ds_read_b128 v[160:163], v248 offset:12288
    v_mfma_f32_16x16x32_bf16 v[48:51], v[180:183], v[148:151], v[48:51]
    s_add_u32 s68, s68, s69
    s_lshl_b32 s69, s60, 7
    v_mfma_f32_16x16x32_bf16 v[52:55], v[180:183], v[156:159], v[52:55]
    ds_read_b128 v[164:167], v249 offset:12288
    v_mfma_f32_16x16x32_bf16 v[52:55], v[176:179], v[152:155], v[52:55]
    s_add_u32 s77, s68, s69
    s_lshl_b32 s68, s56, 15
    v_mfma_f32_16x16x32_bf16 v[60:63], v[184:187], v[152:155], v[60:63]
    ds_read_b128 v[168:171], v248 offset:14336
    v_mfma_f32_16x16x32_bf16 v[60:63], v[188:191], v[156:159], v[60:63]
    s_add_u32 s82, s68, s69
    s_and_b32 s68, s60, 0
    v_mfma_f32_16x16x32_bf16 v[56:59], v[188:191], v[148:151], v[56:59]
    ds_read_b128 v[172:175], v249 offset:14336
    v_mfma_f32_16x16x32_bf16 v[56:59], v[184:187], v[144:147], v[56:59]
    s_lshl_b32 s61, s68, 18
    s_add_u32 s82, s82, s61
    v_mfma_f32_16x16x32_bf16 v[112:115], v[192:195], v[144:147], v[112:115]
    s_mul_i32 s68, s70, 112
    s_mul_i32 s71, s75, 28
    v_mfma_f32_16x16x32_bf16 v[112:115], v[196:199], v[148:151], v[112:115]
    s_add_u32 s68, s68, s71
    s_lshl_b32 s68, s68, 10
    v_mfma_f32_16x16x32_bf16 v[116:119], v[196:199], v[156:159], v[116:119]
    s_add_u32 s78, s68, 4194304
    s_lshl_b32 s68, s70, 15
    v_mfma_f32_16x16x32_bf16 v[116:119], v[192:195], v[152:155], v[116:119]
    s_lshl_b32 s71, s75, 13
    s_add_u32 s71, s68, s71
    v_mfma_f32_16x16x32_bf16 v[124:127], v[200:203], v[152:155], v[124:127]
    s_lshr_b32 s68, s61, 4
    s_xor_b32 s83, s71, s68
    v_mfma_f32_16x16x32_bf16 v[124:127], v[204:207], v[156:159], v[124:127]
    s_add_u32 s83, s83, 1048576
    s_add_u32 s68, s71, s69
    v_mfma_f32_16x16x32_bf16 v[120:123], v[204:207], v[148:151], v[120:123]
    v_lshrrev_b32 v3, 5, v1
    v_bfe_u32 v5, v1, 3, 1
    v_mfma_f32_16x16x32_bf16 v[120:123], v[200:203], v[144:147], v[120:123]
    v_lshl_add_u32 v2, v3, 1, v5
    v_bfe_u32 v7, v1, 4, 1
    s_waitcnt vmcnt(0) lgkmcnt(0)
    v_mfma_f32_16x16x32_bf16 v[64:67], v[176:179], v[160:163], v[64:67]
    s_barrier
    ds_read_b128 v[144:147], v248 offset:16384
    v_mfma_f32_16x16x32_bf16 v[64:67], v[180:183], v[164:167], v[64:67]
    ds_read_b128 v[148:151], v249 offset:16384
    v_mfma_f32_16x16x32_bf16 v[68:71], v[180:183], v[172:175], v[68:71]
    ds_read_b128 v[152:155], v248 offset:18432
    v_mfma_f32_16x16x32_bf16 v[68:71], v[176:179], v[168:171], v[68:71]
    ds_read_b128 v[156:159], v249 offset:18432
    v_mfma_f32_16x16x32_bf16 v[76:79], v[184:187], v[168:171], v[76:79]
    ds_read_b64_tr_b16 v[176:177], v250 offset:8192
    v_mfma_f32_16x16x32_bf16 v[76:79], v[188:191], v[172:175], v[76:79]
    ds_read_b64_tr_b16 v[178:179], v250 offset:8704
    v_mfma_f32_16x16x32_bf16 v[72:75], v[188:191], v[164:167], v[72:75]
    ds_read_b64_tr_b16 v[180:181], v250 offset:12288
    v_mfma_f32_16x16x32_bf16 v[72:75], v[184:187], v[160:163], v[72:75]
    ds_read_b64_tr_b16 v[182:183], v250 offset:12800
    v_mfma_f32_16x16x32_bf16 v[128:131], v[192:195], v[160:163], v[128:131]
    ds_read_b64_tr_b16 v[184:185], v250 offset:32768
    v_mfma_f32_16x16x32_bf16 v[128:131], v[196:199], v[164:167], v[128:131]
    ds_read_b64_tr_b16 v[186:187], v250 offset:33280
    v_mfma_f32_16x16x32_bf16 v[132:135], v[196:199], v[172:175], v[132:135]
    ds_read_b64_tr_b16 v[188:189], v250 offset:36864
    v_mfma_f32_16x16x32_bf16 v[132:135], v[192:195], v[168:171], v[132:135]
    ds_read_b64_tr_b16 v[190:191], v250 offset:37376
    v_mfma_f32_16x16x32_bf16 v[140:143], v[200:203], v[168:171], v[140:143]
    ds_read_b64_tr_b16 v[192:193], v251 offset:8192
    v_mfma_f32_16x16x32_bf16 v[140:143], v[204:207], v[172:175], v[140:143]
    ds_read_b64_tr_b16 v[194:195], v251 offset:8704
    v_mfma_f32_16x16x32_bf16 v[136:139], v[204:207], v[164:167], v[136:139]
    ds_read_b64_tr_b16 v[196:197], v251 offset:12288
    v_mfma_f32_16x16x32_bf16 v[136:139], v[200:203], v[160:163], v[136:139]
    ds_read_b64_tr_b16 v[198:199], v251 offset:12800
    s_waitcnt lgkmcnt(8)
    v_mfma_f32_16x16x32_bf16 v[16:19], v[176:179], v[144:147], v[16:19]
    ds_read_b64_tr_b16 v[200:201], v251 offset:32768
    v_mfma_f32_16x16x32_bf16 v[16:19], v[180:183], v[148:151], v[16:19]
    ds_read_b64_tr_b16 v[202:203], v251 offset:33280
    v_mfma_f32_16x16x32_bf16 v[20:23], v[180:183], v[156:159], v[20:23]
    ds_read_b64_tr_b16 v[204:205], v251 offset:36864
    v_mfma_f32_16x16x32_bf16 v[20:23], v[176:179], v[152:155], v[20:23]
    ds_read_b64_tr_b16 v[206:207], v251 offset:37376
    s_waitcnt lgkmcnt(4)
    v_mfma_f32_16x16x32_bf16 v[28:31], v[184:187], v[152:155], v[28:31]
    ds_read_b128 v[160:163], v248 offset:20480
    v_mfma_f32_16x16x32_bf16 v[28:31], v[188:191], v[156:159], v[28:31]
    ds_read_b128 v[164:167], v249 offset:20480
    v_mfma_f32_16x16x32_bf16 v[24:27], v[188:191], v[148:151], v[24:27]
    ds_read_b128 v[168:171], v248 offset:22528
    v_mfma_f32_16x16x32_bf16 v[24:27], v[184:187], v[144:147], v[24:27]
    ds_read_b128 v[172:175], v249 offset:22528
    v_mfma_f32_16x16x32_bf16 v[80:83], v[192:195], v[144:147], v[80:83]
    v_lshl_add_u32 v4, v7, 2, v2
    v_and_b32 v6, 7, v1
    v_mfma_f32_16x16x32_bf16 v[80:83], v[196:199], v[148:151], v[80:83]
    v_lshlrev_b32 v8, 4, v6
    v_lshl_add_u32 v4, v4, 10, v8
    v_mfma_f32_16x16x32_bf16 v[84:87], v[196:199], v[156:159], v[84:87]
    v_add_u32 v215, s68, v4
    v_lshlrev_b32 v2, 8, v2
    v_mfma_f32_16x16x32_bf16 v[84:87], v[192:195], v[152:155], v[84:87]
    s_waitcnt lgkmcnt(4)
    v_mfma_f32_16x16x32_bf16 v[92:95], v[200:203], v[152:155], v[92:95]
    v_lshl_add_u32 v2, v7, 7, v2
    v_lshl_add_u32 v2, v5, 4, v2
    v_mfma_f32_16x16x32_bf16 v[92:95], v[204:207], v[156:159], v[92:95]
    v_and_b32 v4, 3, v6
    v_lshl_add_u32 v2, v4, 5, v2
    v_mfma_f32_16x16x32_bf16 v[88:91], v[204:207], v[148:151], v[88:91]
    v_lshrrev_b32 v4, 2, v6
    v_lshl_add_u32 v2, v4, 12, v2
    v_mfma_f32_16x16x32_bf16 v[88:91], v[200:203], v[144:147], v[88:91]
    s_lshl_b32 s68, s76, 13
    s_lshl_b32 s69, s75, 10
    s_waitcnt lgkmcnt(0)
    v_mfma_f32_16x16x32_bf16 v[32:35], v[176:179], v[160:163], v[32:35]
    ds_read_b128 v[144:147], v248 offset:24576
    v_mfma_f32_16x16x32_bf16 v[32:35], v[180:183], v[164:167], v[32:35]
    s_add_u32 s68, s68, s69
    v_add_u32 v0, s68, v2
    v_mfma_f32_16x16x32_bf16 v[36:39], v[180:183], v[172:175], v[36:39]
    ds_read_b128 v[148:151], v249 offset:24576
    v_mfma_f32_16x16x32_bf16 v[36:39], v[176:179], v[168:171], v[36:39]
    v_add_u32 v209, 0, v208
    v_and_b32 v2, 15, v1
    v_mfma_f32_16x16x32_bf16 v[44:47], v[184:187], v[168:171], v[44:47]
    ds_read_b128 v[152:155], v248 offset:26624
    v_mfma_f32_16x16x32_bf16 v[44:47], v[188:191], v[172:175], v[44:47]
    v_lshl_add_u32 v2, v3, 4, v2
    v_lshlrev_b32 v2, 4, v2
    v_mfma_f32_16x16x32_bf16 v[40:43], v[188:191], v[164:167], v[40:43]
    ds_read_b128 v[156:159], v249 offset:26624
    v_mfma_f32_16x16x32_bf16 v[40:43], v[184:187], v[160:163], v[40:43]
    v_add_u32 v211, 1024, v2
    v_lshrrev_b32 v5, 3, v1
    v_mfma_f32_16x16x32_bf16 v[96:99], v[192:195], v[160:163], v[96:99]
    v_and_b32 v6, 7, v1
    v_bfe_u32 v7, v1, 4, 1
    v_mfma_f32_16x16x32_bf16 v[96:99], v[196:199], v[164:167], v[96:99]
    v_lshlrev_b32 v8, 2, v7
    v_xor_b32 v6, v6, v8
    v_mfma_f32_16x16x32_bf16 v[100:103], v[196:199], v[172:175], v[100:103]
    v_lshlrev_b32 v6, 4, v6
    v_lshl_add_u32 v210, v5, 10, v6
    v_mfma_f32_16x16x32_bf16 v[100:103], v[192:195], v[168:171], v[100:103]
    v_and_b32 v2, 1, v1
    v_bfe_u32 v4, v1, 1, 1
    v_mfma_f32_16x16x32_bf16 v[108:111], v[200:203], v[168:171], v[108:111]
    v_lshl_add_u32 v2, v2, 1, v4
    v_bfe_u32 v5, v1, 2, 2
    v_mfma_f32_16x16x32_bf16 v[108:111], v[204:207], v[172:175], v[108:111]
    v_lshl_add_u32 v4, v3, 3, v5
    v_lshlrev_b32 v4, 7, v4
    v_mfma_f32_16x16x32_bf16 v[104:107], v[204:207], v[164:167], v[104:107]
    v_and_b32 v6, 2, v5
    v_xor_b32 v6, v6, v7
    v_mfma_f32_16x16x32_bf16 v[104:107], v[200:203], v[160:163], v[104:107]
    v_lshl_add_u32 v6, v6, 5, v4
    v_and_b32 v8, 3, v1
    s_waitcnt lgkmcnt(0)
    v_mfma_f32_16x16x32_bf16 v[48:51], v[176:179], v[144:147], v[48:51]
    ds_read_b128 v[160:163], v248 offset:28672
    v_mfma_f32_16x16x32_bf16 v[48:51], v[180:183], v[148:151], v[48:51]
    v_lshl_add_u32 v6, v8, 3, v6
    v_lshl_add_u32 v4, v2, 3, v4
    v_mfma_f32_16x16x32_bf16 v[52:55], v[180:183], v[156:159], v[52:55]
    ds_read_b128 v[164:167], v249 offset:28672
    v_mfma_f32_16x16x32_bf16 v[52:55], v[176:179], v[152:155], v[52:55]
    s_lshl_b32 s68, s75, 13
    s_add_u32 s68, s68, 65536
    v_mfma_f32_16x16x32_bf16 v[60:63], v[184:187], v[152:155], v[60:63]
    ds_read_b128 v[168:171], v248 offset:30720
    v_mfma_f32_16x16x32_bf16 v[60:63], v[188:191], v[156:159], v[60:63]
    v_add_u32 v212, s68, v6
    v_xor_b32 v213, 64, v212
    v_mfma_f32_16x16x32_bf16 v[56:59], v[188:191], v[148:151], v[56:59]
    ds_read_b128 v[172:175], v249 offset:30720
    v_mfma_f32_16x16x32_bf16 v[56:59], v[184:187], v[144:147], v[56:59]
    s_lshr_b32 s68, s59, 4
    s_lshl_b32 s69, s75, 1
    v_mfma_f32_16x16x32_bf16 v[112:115], v[192:195], v[144:147], v[112:115]
    s_add_u32 s68, s68, s69
    s_bfe_u32 s70, s59, 0x30001
    v_mfma_f32_16x16x32_bf16 v[112:115], v[196:199], v[148:151], v[112:115]
    s_lshl_b32 s70, s70, 3
    s_add_u32 s68, s68, s70
    v_mfma_f32_16x16x32_bf16 v[116:119], v[196:199], v[156:159], v[116:119]
    s_lshl_b32 s68, s68, 7
    v_and_b32 v2, 3, v1
    v_mfma_f32_16x16x32_bf16 v[116:119], v[192:195], v[152:155], v[116:119]
    v_lshlrev_b32 v6, 2, v2
    v_lshl_add_u32 v6, v5, 13, v6
    v_mfma_f32_16x16x32_bf16 v[124:127], v[200:203], v[152:155], v[124:127]
    v_add_u32 v6, s68, v6
    s_lshr_b32 s68, s61, 16
    v_mfma_f32_16x16x32_bf16 v[124:127], v[204:207], v[156:159], v[124:127]
    s_xor_b32 s69, s69, s68
    s_and_b32 s68, s2, 0xc7
    v_mfma_f32_16x16x32_bf16 v[120:123], v[204:207], v[148:151], v[120:123]
    s_lshl_b32 s69, s69, 3
    s_add_u32 s68, s68, s69
    v_mfma_f32_16x16x32_bf16 v[120:123], v[200:203], v[144:147], v[120:123]
    s_lshl_b32 s68, s68, 7
    s_lshl_b32 s69, s76, 2
    s_waitcnt lgkmcnt(0)
    v_mfma_f32_16x16x32_bf16 v[64:67], v[176:179], v[160:163], v[64:67]
    s_barrier
    ds_read_b128 v[144:147], v248 offset:32768
    v_mfma_f32_16x16x32_bf16 v[64:67], v[180:183], v[164:167], v[64:67]
    ds_read_b128 v[148:151], v249 offset:32768
    v_mfma_f32_16x16x32_bf16 v[68:71], v[180:183], v[172:175], v[68:71]
    ds_read_b128 v[152:155], v248 offset:34816
    v_mfma_f32_16x16x32_bf16 v[68:71], v[176:179], v[168:171], v[68:71]
    ds_read_b128 v[156:159], v249 offset:34816
    v_mfma_f32_16x16x32_bf16 v[76:79], v[184:187], v[168:171], v[76:79]
    ds_read_b64_tr_b16 v[176:177], v250 offset:16384
    v_mfma_f32_16x16x32_bf16 v[76:79], v[188:191], v[172:175], v[76:79]
    ds_read_b64_tr_b16 v[178:179], v250 offset:16896
    v_mfma_f32_16x16x32_bf16 v[72:75], v[188:191], v[164:167], v[72:75]
    ds_read_b64_tr_b16 v[180:181], v250 offset:20480
    v_mfma_f32_16x16x32_bf16 v[72:75], v[184:187], v[160:163], v[72:75]
    ds_read_b64_tr_b16 v[182:183], v250 offset:20992
    v_mfma_f32_16x16x32_bf16 v[128:131], v[192:195], v[160:163], v[128:131]
    ds_read_b64_tr_b16 v[184:185], v250 offset:40960
    v_mfma_f32_16x16x32_bf16 v[128:131], v[196:199], v[164:167], v[128:131]
    ds_read_b64_tr_b16 v[186:187], v250 offset:41472
    v_mfma_f32_16x16x32_bf16 v[132:135], v[196:199], v[172:175], v[132:135]
    ds_read_b64_tr_b16 v[188:189], v250 offset:45056
    v_mfma_f32_16x16x32_bf16 v[132:135], v[192:195], v[168:171], v[132:135]
    ds_read_b64_tr_b16 v[190:191], v250 offset:45568
    v_mfma_f32_16x16x32_bf16 v[140:143], v[200:203], v[168:171], v[140:143]
    ds_read_b64_tr_b16 v[192:193], v251 offset:16384
    v_mfma_f32_16x16x32_bf16 v[140:143], v[204:207], v[172:175], v[140:143]
    ds_read_b64_tr_b16 v[194:195], v251 offset:16896
    v_mfma_f32_16x16x32_bf16 v[136:139], v[204:207], v[164:167], v[136:139]
    ds_read_b64_tr_b16 v[196:197], v251 offset:20480
    v_mfma_f32_16x16x32_bf16 v[136:139], v[200:203], v[160:163], v[136:139]
    ds_read_b64_tr_b16 v[198:199], v251 offset:20992
    s_waitcnt lgkmcnt(8)
    v_mfma_f32_16x16x32_bf16 v[16:19], v[176:179], v[144:147], v[16:19]
    ds_read_b64_tr_b16 v[200:201], v251 offset:40960
    v_mfma_f32_16x16x32_bf16 v[16:19], v[180:183], v[148:151], v[16:19]
    ds_read_b64_tr_b16 v[202:203], v251 offset:41472
    v_mfma_f32_16x16x32_bf16 v[20:23], v[180:183], v[156:159], v[20:23]
    ds_read_b64_tr_b16 v[204:205], v251 offset:45056
    v_mfma_f32_16x16x32_bf16 v[20:23], v[176:179], v[152:155], v[20:23]
    ds_read_b64_tr_b16 v[206:207], v251 offset:45568
    s_waitcnt lgkmcnt(4)
    v_mfma_f32_16x16x32_bf16 v[28:31], v[184:187], v[152:155], v[28:31]
    ds_read_b128 v[160:163], v248 offset:36864
    v_mfma_f32_16x16x32_bf16 v[28:31], v[188:191], v[156:159], v[28:31]
    ds_read_b128 v[164:167], v249 offset:36864
    v_mfma_f32_16x16x32_bf16 v[24:27], v[188:191], v[148:151], v[24:27]
    ds_read_b128 v[168:171], v248 offset:38912
    v_mfma_f32_16x16x32_bf16 v[24:27], v[184:187], v[144:147], v[24:27]
    ds_read_b128 v[172:175], v249 offset:38912
    v_mfma_f32_16x16x32_bf16 v[80:83], v[192:195], v[144:147], v[80:83]
    s_add_u32 s68, s68, s69
    v_and_b32 v8, 1, v5
    v_mfma_f32_16x16x32_bf16 v[80:83], v[196:199], v[148:151], v[80:83]
    v_lshlrev_b32 v8, 10, v8
    v_lshl_add_u32 v8, v2, 3, v8
    v_mfma_f32_16x16x32_bf16 v[84:87], v[196:199], v[156:159], v[84:87]
    v_cmp_gt_u32 vcc, 16, v1
    v_add_u32 v8, s68, v8
    v_mfma_f32_16x16x32_bf16 v[84:87], v[192:195], v[152:155], v[84:87]
    s_waitcnt lgkmcnt(4)
    v_mfma_f32_16x16x32_bf16 v[92:95], v[200:203], v[152:155], v[92:95]
    s_nop 0
    v_cndmask_b32 v214, v8, v6, vcc
    v_mfma_f32_16x16x32_bf16 v[92:95], v[204:207], v[156:159], v[92:95]
    v_and_b32 v2, 0xff, v208
    v_add_u32 v11, 147712, v2
    v_mfma_f32_16x16x32_bf16 v[88:91], v[204:207], v[148:151], v[88:91]
    v_xor_b32 v6, v3, v7
    v_lshl_add_u32 v2, v6, 9, v2
    v_mfma_f32_16x16x32_bf16 v[88:91], v[200:203], v[144:147], v[88:91]
    v_add_u32 v10, 147456, v2
    s_lshl_b32 s68, s66, 11
    s_waitcnt lgkmcnt(0)
    v_mfma_f32_16x16x32_bf16 v[32:35], v[176:179], v[160:163], v[32:35]
    ds_read_b128 v[144:147], v248 offset:40960
    v_mfma_f32_16x16x32_bf16 v[32:35], v[180:183], v[164:167], v[32:35]
    v_add_u32 v254, s68, v208
    s_mul_i32 s68, s66, 2208
    v_mfma_f32_16x16x32_bf16 v[36:39], v[180:183], v[172:175], v[36:39]
    ds_read_b128 v[148:151], v249 offset:40960
    v_mfma_f32_16x16x32_bf16 v[36:39], v[176:179], v[168:171], v[36:39]
    v_lshl_add_u32 v9, v3, 4, v208
    v_add_u32 v9, s68, v9
    v_mfma_f32_16x16x32_bf16 v[44:47], v[184:187], v[168:171], v[44:47]
    ds_read_b128 v[152:155], v248 offset:43008
    v_mfma_f32_16x16x32_bf16 v[44:47], v[188:191], v[172:175], v[44:47]
    s_lshr_b32 s68, s58, 2
    s_and_b32 s69, s58, 3
    v_mfma_f32_16x16x32_bf16 v[40:43], v[188:191], v[164:167], v[40:43]
    ds_read_b128 v[156:159], v249 offset:43008
    v_mfma_f32_16x16x32_bf16 v[40:43], v[184:187], v[160:163], v[40:43]
    s_mul_i32 s70, s57, 448
    s_mul_i32 s71, s68, 28
    v_mfma_f32_16x16x32_bf16 v[96:99], v[192:195], v[160:163], v[96:99]
    s_add_u32 s70, s70, s71
    s_lshl_b32 s71, s69, 3
    v_mfma_f32_16x16x32_bf16 v[96:99], v[196:199], v[164:167], v[96:99]
    s_add_u32 s70, s70, s71
    s_add_u32 s70, s70, s66
    v_mfma_f32_16x16x32_bf16 v[100:103], v[196:199], v[172:175], v[100:103]
    s_lshl_b32 s70, s70, 10
    s_add_u32 s74, s70, 4194304
    v_mfma_f32_16x16x32_bf16 v[100:103], v[192:195], v[168:171], v[100:103]
    s_add_u32 s14, s74, 4096
    s_lshl_b32 s70, s57, 7
    v_mfma_f32_16x16x32_bf16 v[108:111], v[200:203], v[168:171], v[108:111]
    s_lshl_b32 s71, s68, 3
    s_add_u32 s70, s70, s71
    v_mfma_f32_16x16x32_bf16 v[108:111], v[204:207], v[172:175], v[108:111]
    s_add_u32 s70, s70, s66
    s_lshl_b32 s70, s70, 10
    v_mfma_f32_16x16x32_bf16 v[104:107], v[204:207], v[164:167], v[104:107]
    s_add_u32 s70, s70, 14680064
    s_cmp_eq_u32 s69, 3
    s_cselect_b32 s14, s70, s14
    v_mfma_f32_16x16x32_bf16 v[104:107], v[200:203], v[160:163], v[104:107]
    s_waitcnt lgkmcnt(0)
    v_mfma_f32_16x16x32_bf16 v[48:51], v[176:179], v[144:147], v[48:51]
    ds_read_b128 v[160:163], v248 offset:45056
    v_mfma_f32_16x16x32_bf16 v[48:51], v[180:183], v[148:151], v[48:51]
    v_mfma_f32_16x16x32_bf16 v[52:55], v[180:183], v[156:159], v[52:55]
    ds_read_b128 v[164:167], v249 offset:45056
    v_mfma_f32_16x16x32_bf16 v[52:55], v[176:179], v[152:155], v[52:55]
    v_mfma_f32_16x16x32_bf16 v[60:63], v[184:187], v[152:155], v[60:63]
    ds_read_b128 v[168:171], v248 offset:47104
    v_mfma_f32_16x16x32_bf16 v[60:63], v[188:191], v[156:159], v[60:63]
    v_mfma_f32_16x16x32_bf16 v[56:59], v[188:191], v[148:151], v[56:59]
    ds_read_b128 v[172:175], v249 offset:47104
    v_mfma_f32_16x16x32_bf16 v[56:59], v[184:187], v[144:147], v[56:59]
    v_mfma_f32_16x16x32_bf16 v[112:115], v[192:195], v[144:147], v[112:115]
    v_mfma_f32_16x16x32_bf16 v[112:115], v[196:199], v[148:151], v[112:115]
    v_mfma_f32_16x16x32_bf16 v[116:119], v[196:199], v[156:159], v[116:119]
    v_mfma_f32_16x16x32_bf16 v[116:119], v[192:195], v[152:155], v[116:119]
    v_mfma_f32_16x16x32_bf16 v[124:127], v[200:203], v[152:155], v[124:127]
    v_mfma_f32_16x16x32_bf16 v[124:127], v[204:207], v[156:159], v[124:127]
    v_mfma_f32_16x16x32_bf16 v[120:123], v[204:207], v[148:151], v[120:123]
    v_mfma_f32_16x16x32_bf16 v[120:123], v[200:203], v[144:147], v[120:123]
    s_branch L_pg16
.p2align 12
L_stub16:
    s_nop 0
    s_setpc_b64 s[0:1]
L_pg16:
    s_waitcnt lgkmcnt(0)
    v_mfma_f32_16x16x32_bf16 v[64:67], v[176:179], v[160:163], v[64:67]
    s_barrier
    ds_read_b128 v[144:147], v248 offset:0
    v_mfma_f32_16x16x32_bf16 v[64:67], v[180:183], v[164:167], v[64:67]
    ds_read_b128 v[148:151], v249 offset:0
    v_mfma_f32_16x16x32_bf16 v[68:71], v[180:183], v[172:175], v[68:71]
    ds_read_b128 v[152:155], v248 offset:2048
    v_mfma_f32_16x16x32_bf16 v[68:71], v[176:179], v[168:171], v[68:71]
    ds_read_b128 v[156:159], v249 offset:2048
    v_mfma_f32_16x16x32_bf16 v[76:79], v[184:187], v[168:171], v[76:79]
    ds_read_b64_tr_b16 v[176:177], v250 offset:0
    v_mfma_f32_16x16x32_bf16 v[76:79], v[188:191], v[172:175], v[76:79]
    ds_read_b64_tr_b16 v[178:179], v250 offset:512
    v_mfma_f32_16x16x32_bf16 v[72:75], v[188:191], v[164:167], v[72:75]
    ds_read_b64_tr_b16 v[180:181], v250 offset:4096
    v_mfma_f32_16x16x32_bf16 v[72:75], v[184:187], v[160:163], v[72:75]
    ds_read_b64_tr_b16 v[182:183], v250 offset:4608
    v_mfma_f32_16x16x32_bf16 v[128:131], v[192:195], v[160:163], v[128:131]
    ds_read_b64_tr_b16 v[184:185], v250 offset:24576
    v_mfma_f32_16x16x32_bf16 v[128:131], v[196:199], v[164:167], v[128:131]
    ds_read_b64_tr_b16 v[186:187], v250 offset:25088
    v_mfma_f32_16x16x32_bf16 v[132:135], v[196:199], v[172:175], v[132:135]
    ds_read_b64_tr_b16 v[188:189], v250 offset:28672
    v_mfma_f32_16x16x32_bf16 v[132:135], v[192:195], v[168:171], v[132:135]
    ds_read_b64_tr_b16 v[190:191], v250 offset:29184
    v_mfma_f32_16x16x32_bf16 v[140:143], v[200:203], v[168:171], v[140:143]
    ds_read_b64_tr_b16 v[192:193], v251 offset:0
    v_mfma_f32_16x16x32_bf16 v[140:143], v[204:207], v[172:175], v[140:143]
    ds_read_b64_tr_b16 v[194:195], v251 offset:512
    v_mfma_f32_16x16x32_bf16 v[136:139], v[204:207], v[164:167], v[136:139]
    ds_read_b64_tr_b16 v[196:197], v251 offset:4096
    v_mfma_f32_16x16x32_bf16 v[136:139], v[200:203], v[160:163], v[136:139]
    ds_read_b64_tr_b16 v[198:199], v251 offset:4608
    s_waitcnt lgkmcnt(8)
    v_mfma_f32_16x16x32_bf16 v[16:19], v[176:179], v[144:147], v[16:19]
    ds_read_b64_tr_b16 v[200:201], v251 offset:24576
    v_mfma_f32_16x16x32_bf16 v[16:19], v[180:183], v[148:151], v[16:19]
    ds_read_b64_tr_b16 v[202:203], v251 offset:25088
    v_mfma_f32_16x16x32_bf16 v[20:23], v[180:183], v[156:159], v[20:23]
    ds_read_b64_tr_b16 v[204:205], v251 offset:28672
    v_mfma_f32_16x16x32_bf16 v[20:23], v[176:179], v[152:155], v[20:23]
    ds_read_b64_tr_b16 v[206:207], v251 offset:29184
    s_waitcnt lgkmcnt(4)
    v_mfma_f32_16x16x32_bf16 v[28:31], v[184:187], v[152:155], v[28:31]
    ds_read_b128 v[160:163], v248 offset:4096
    v_mfma_f32_16x16x32_bf16 v[28:31], v[188:191], v[156:159], v[28:31]
    ds_read_b128 v[164:167], v249 offset:4096
    v_mfma_f32_16x16x32_bf16 v[24:27], v[188:191], v[148:151], v[24:27]
    ds_read_b128 v[168:171], v248 offset:6144
    v_mfma_f32_16x16x32_bf16 v[24:27], v[184:187], v[144:147], v[24:27]
    ds_read_b128 v[172:175], v249 offset:6144
    v_mfma_f32_16x16x32_bf16 v[80:83], v[192:195], v[144:147], v[80:83]
    v_mfma_f32_16x16x32_bf16 v[80:83], v[196:199], v[148:151], v[80:83]
    v_mfma_f32_16x16x32_bf16 v[84:87], v[196:199], v[156:159], v[84:87]
    v_mfma_f32_16x16x32_bf16 v[84:87], v[192:195], v[152:155], v[84:87]
    s_waitcnt lgkmcnt(4)
    v_mfma_f32_16x16x32_bf16 v[92:95], v[200:203], v[152:155], v[92:95]
    v_mfma_f32_16x16x32_bf16 v[92:95], v[204:207], v[156:159], v[92:95]
    v_mfma_f32_16x16x32_bf16 v[88:91], v[204:207], v[148:151], v[88:91]
    v_mfma_f32_16x16x32_bf16 v[88:91], v[200:203], v[144:147], v[88:91]
    s_waitcnt lgkmcnt(0)
    v_mfma_f32_16x16x32_bf16 v[32:35], v[176:179], v[160:163], v[32:35]
    ds_read_b128 v[144:147], v248 offset:8192
    v_mfma_f32_16x16x32_bf16 v[32:35], v[180:183], v[164:167], v[32:35]
    v_mfma_f32_16x16x32_bf16 v[36:39], v[180:183], v[172:175], v[36:39]
    ds_read_b128 v[148:151], v249 offset:8192
    v_mfma_f32_16x16x32_bf16 v[36:39], v[176:179], v[168:171], v[36:39]
    v_mfma_f32_16x16x32_bf16 v[44:47], v[184:187], v[168:171], v[44:47]
    ds_read_b128 v[152:155], v248 offset:10240
    v_mfma_f32_16x16x32_bf16 v[44:47], v[188:191], v[172:175], v[44:47]
    v_mfma_f32_16x16x32_bf16 v[40:43], v[188:191], v[164:167], v[40:43]
    ds_read_b128 v[156:159], v249 offset:10240
    v_mfma_f32_16x16x32_bf16 v[40:43], v[184:187], v[160:163], v[40:43]
    v_mfma_f32_16x16x32_bf16 v[96:99], v[192:195], v[160:163], v[96:99]
    v_mfma_f32_16x16x32_bf16 v[96:99], v[196:199], v[164:167], v[96:99]
    v_mfma_f32_16x16x32_bf16 v[100:103], v[196:199], v[172:175], v[100:103]
    v_mfma_f32_16x16x32_bf16 v[100:103], v[192:195], v[168:171], v[100:103]
    v_mfma_f32_16x16x32_bf16 v[108:111], v[200:203], v[168:171], v[108:111]
    v_mfma_f32_16x16x32_bf16 v[108:111], v[204:207], v[172:175], v[108:111]
    v_mfma_f32_16x16x32_bf16 v[104:107], v[204:207], v[164:167], v[104:107]
    v_mfma_f32_16x16x32_bf16 v[104:107], v[200:203], v[160:163], v[104:107]
    s_waitcnt lgkmcnt(0)
    v_mfma_f32_16x16x32_bf16 v[48:51], v[176:179], v[144:147], v[48:51]
    ds_read_b128 v[160:163], v248 offset:12288
    v_mfma_f32_16x16x32_bf16 v[48:51], v[180:183], v[148:151], v[48:51]
    v_mfma_f32_16x16x32_bf16 v[52:55], v[180:183], v[156:159], v[52:55]
    ds_read_b128 v[164:167], v249 offset:12288
    v_mfma_f32_16x16x32_bf16 v[52:55], v[176:179], v[152:155], v[52:55]
    v_mfma_f32_16x16x32_bf16 v[60:63], v[184:187], v[152:155], v[60:63]
    ds_read_b128 v[168:171], v248 offset:14336
    v_mfma_f32_16x16x32_bf16 v[60:63], v[188:191], v[156:159], v[60:63]
    v_mfma_f32_16x16x32_bf16 v[56:59], v[188:191], v[148:151], v[56:59]
    ds_read_b128 v[172:175], v249 offset:14336
    v_mfma_f32_16x16x32_bf16 v[56:59], v[184:187], v[144:147], v[56:59]
    v_mfma_f32_16x16x32_bf16 v[112:115], v[192:195], v[144:147], v[112:115]
    v_mfma_f32_16x16x32_bf16 v[112:115], v[196:199], v[148:151], v[112:115]
    v_mfma_f32_16x16x32_bf16 v[116:119], v[196:199], v[156:159], v[116:119]
    v_mfma_f32_16x16x32_bf16 v[116:119], v[192:195], v[152:155], v[116:119]
    v_mfma_f32_16x16x32_bf16 v[124:127], v[200:203], v[152:155], v[124:127]
    v_mfma_f32_16x16x32_bf16 v[124:127], v[204:207], v[156:159], v[124:127]
    v_mfma_f32_16x16x32_bf16 v[120:123], v[204:207], v[148:151], v[120:123]
    v_mfma_f32_16x16x32_bf16 v[120:123], v[200:203], v[144:147], v[120:123]
    s_waitcnt lgkmcnt(0)
    v_mfma_f32_16x16x32_bf16 v[64:67], v[176:179], v[160:163], v[64:67]
    s_barrier
    ds_read_b128 v[144:147], v248 offset:16384
    v_mfma_f32_16x16x32_bf16 v[64:67], v[180:183], v[164:167], v[64:67]
    ds_read_b128 v[148:151], v249 offset:16384
    v_mfma_f32_16x16x32_bf16 v[68:71], v[180:183], v[172:175], v[68:71]
    ds_read_b128 v[152:155], v248 offset:18432
    v_mfma_f32_16x16x32_bf16 v[68:71], v[176:179], v[168:171], v[68:71]
    ds_read_b128 v[156:159], v249 offset:18432
    v_mfma_f32_16x16x32_bf16 v[76:79], v[184:187], v[168:171], v[76:79]
    ds_read_b64_tr_b16 v[176:177], v250 offset:8192
    v_mfma_f32_16x16x32_bf16 v[76:79], v[188:191], v[172:175], v[76:79]
    ds_read_b64_tr_b16 v[178:179], v250 offset:8704
    v_mfma_f32_16x16x32_bf16 v[72:75], v[188:191], v[164:167], v[72:75]
    ds_read_b64_tr_b16 v[180:181], v250 offset:12288
    v_mfma_f32_16x16x32_bf16 v[72:75], v[184:187], v[160:163], v[72:75]
    ds_read_b64_tr_b16 v[182:183], v250 offset:12800
    v_mfma_f32_16x16x32_bf16 v[128:131], v[192:195], v[160:163], v[128:131]
    ds_read_b64_tr_b16 v[184:185], v250 offset:32768
    v_mfma_f32_16x16x32_bf16 v[128:131], v[196:199], v[164:167], v[128:131]
    ds_read_b64_tr_b16 v[186:187], v250 offset:33280
    v_mfma_f32_16x16x32_bf16 v[132:135], v[196:199], v[172:175], v[132:135]
    ds_read_b64_tr_b16 v[188:189], v250 offset:36864
    v_mfma_f32_16x16x32_bf16 v[132:135], v[192:195], v[168:171], v[132:135]
    ds_read_b64_tr_b16 v[190:191], v250 offset:37376
    v_mfma_f32_16x16x32_bf16 v[140:143], v[200:203], v[168:171], v[140:143]
    ds_read_b64_tr_b16 v[192:193], v251 offset:8192
    v_mfma_f32_16x16x32_bf16 v[140:143], v[204:207], v[172:175], v[140:143]
    ds_read_b64_tr_b16 v[194:195], v251 offset:8704
    v_mfma_f32_16x16x32_bf16 v[136:139], v[204:207], v[164:167], v[136:139]
    ds_read_b64_tr_b16 v[196:197], v251 offset:12288
    v_mfma_f32_16x16x32_bf16 v[136:139], v[200:203], v[160:163], v[136:139]
    ds_read_b64_tr_b16 v[198:199], v251 offset:12800
    s_waitcnt lgkmcnt(8)
    v_mfma_f32_16x16x32_bf16 v[16:19], v[176:179], v[144:147], v[16:19]
    ds_read_b64_tr_b16 v[200:201], v251 offset:32768
    v_mfma_f32_16x16x32_bf16 v[16:19], v[180:183], v[148:151], v[16:19]
    ds_read_b64_tr_b16 v[202:203], v251 offset:33280
    v_mfma_f32_16x16x32_bf16 v[20:23], v[180:183], v[156:159], v[20:23]
    ds_read_b64_tr_b16 v[204:205], v251 offset:36864
    v_mfma_f32_16x16x32_bf16 v[20:23], v[176:179], v[152:155], v[20:23]
    ds_read_b64_tr_b16 v[206:207], v251 offset:37376
    s_waitcnt lgkmcnt(4)
    v_mfma_f32_16x16x32_bf16 v[28:31], v[184:187], v[152:155], v[28:31]
    ds_read_b128 v[160:163], v248 offset:20480
    v_mfma_f32_16x16x32_bf16 v[28:31], v[188:191], v[156:159], v[28:31]
    ds_read_b128 v[164:167], v249 offset:20480
    v_mfma_f32_16x16x32_bf16 v[24:27], v[188:191], v[148:151], v[24:27]
    ds_read_b128 v[168:171], v248 offset:22528
    v_mfma_f32_16x16x32_bf16 v[24:27], v[184:187], v[144:147], v[24:27]
    ds_read_b128 v[172:175], v249 offset:22528
    v_mfma_f32_16x16x32_bf16 v[80:83], v[192:195], v[144:147], v[80:83]
    v_mfma_f32_16x16x32_bf16 v[80:83], v[196:199], v[148:151], v[80:83]
    v_mfma_f32_16x16x32_bf16 v[84:87], v[196:199], v[156:159], v[84:87]
    v_mfma_f32_16x16x32_bf16 v[84:87], v[192:195], v[152:155], v[84:87]
    s_waitcnt lgkmcnt(4)
    v_mfma_f32_16x16x32_bf16 v[92:95], v[200:203], v[152:155], v[92:95]
    v_mfma_f32_16x16x32_bf16 v[92:95], v[204:207], v[156:159], v[92:95]
    v_mfma_f32_16x16x32_bf16 v[88:91], v[204:207], v[148:151], v[88:91]
    v_mfma_f32_16x16x32_bf16 v[88:91], v[200:203], v[144:147], v[88:91]
    s_waitcnt lgkmcnt(0)
    v_mfma_f32_16x16x32_bf16 v[32:35], v[176:179], v[160:163], v[32:35]
    ds_read_b128 v[144:147], v248 offset:24576
    v_mfma_f32_16x16x32_bf16 v[32:35], v[180:183], v[164:167], v[32:35]
    v_mfma_f32_16x16x32_bf16 v[36:39], v[180:183], v[172:175], v[36:39]
    ds_read_b128 v[148:151], v249 offset:24576
    v_mfma_f32_16x16x32_bf16 v[36:39], v[176:179], v[168:171], v[36:39]
    v_mfma_f32_16x16x32_bf16 v[44:47], v[184:187], v[168:171], v[44:47]
    ds_read_b128 v[152:155], v248 offset:26624
    v_mfma_f32_16x16x32_bf16 v[44:47], v[188:191], v[172:175], v[44:47]
    v_mfma_f32_16x16x32_bf16 v[40:43], v[188:191], v[164:167], v[40:43]
    ds_read_b128 v[156:159], v249 offset:26624
    v_mfma_f32_16x16x32_bf16 v[40:43], v[184:187], v[160:163], v[40:43]
    v_mfma_f32_16x16x32_bf16 v[96:99], v[192:195], v[160:163], v[96:99]
    v_mfma_f32_16x16x32_bf16 v[96:99], v[196:199], v[164:167], v[96:99]
    v_mfma_f32_16x16x32_bf16 v[100:103], v[196:199], v[172:175], v[100:103]
    v_mfma_f32_16x16x32_bf16 v[100:103], v[192:195], v[168:171], v[100:103]
    v_mfma_f32_16x16x32_bf16 v[108:111], v[200:203], v[168:171], v[108:111]
    v_mfma_f32_16x16x32_bf16 v[108:111], v[204:207], v[172:175], v[108:111]
    v_mfma_f32_16x16x32_bf16 v[104:107], v[204:207], v[164:167], v[104:107]
    v_mfma_f32_16x16x32_bf16 v[104:107], v[200:203], v[160:163], v[104:107]
    s_waitcnt lgkmcnt(0)
    v_mfma_f32_16x16x32_bf16 v[48:51], v[176:179], v[144:147], v[48:51]
    ds_read_b128 v[160:163], v248 offset:28672
    v_mfma_f32_16x16x32_bf16 v[48:51], v[180:183], v[148:151], v[48:51]
    v_mfma_f32_16x16x32_bf16 v[52:55], v[180:183], v[156:159], v[52:55]
    ds_read_b128 v[164:167], v249 offset:28672
    v_mfma_f32_16x16x32_bf16 v[52:55], v[176:179], v[152:155], v[52:55]
    v_mfma_f32_16x16x32_bf16 v[60:63], v[184:187], v[152:155], v[60:63]
    ds_read_b128 v[168:171], v248 offset:30720
    v_mfma_f32_16x16x32_bf16 v[60:63], v[188:191], v[156:159], v[60:63]
    v_mfma_f32_16x16x32_bf16 v[56:59], v[188:191], v[148:151], v[56:59]
    ds_read_b128 v[172:175], v249 offset:30720
    v_mfma_f32_16x16x32_bf16 v[56:59], v[184:187], v[144:147], v[56:59]
    v_mfma_f32_16x16x32_bf16 v[112:115], v[192:195], v[144:147], v[112:115]
    v_mfma_f32_16x16x32_bf16 v[112:115], v[196:199], v[148:151], v[112:115]
    v_mfma_f32_16x16x32_bf16 v[116:119], v[196:199], v[156:159], v[116:119]
    v_mfma_f32_16x16x32_bf16 v[116:119], v[192:195], v[152:155], v[116:119]
    v_mfma_f32_16x16x32_bf16 v[124:127], v[200:203], v[152:155], v[124:127]
    v_mfma_f32_16x16x32_bf16 v[124:127], v[204:207], v[156:159], v[124:127]
    v_mfma_f32_16x16x32_bf16 v[120:123], v[204:207], v[148:151], v[120:123]
    v_mfma_f32_16x16x32_bf16 v[120:123], v[200:203], v[144:147], v[120:123]
    s_waitcnt lgkmcnt(0)
    v_mfma_f32_16x16x32_bf16 v[64:67], v[176:179], v[160:163], v[64:67]
    s_barrier
    ds_read_b128 v[144:147], v248 offset:32768
    v_mfma_f32_16x16x32_bf16 v[64:67], v[180:183], v[164:167], v[64:67]
    ds_read_b128 v[148:151], v249 offset:32768
    v_mfma_f32_16x16x32_bf16 v[68:71], v[180:183], v[172:175], v[68:71]
    ds_read_b128 v[152:155], v248 offset:34816
    v_mfma_f32_16x16x32_bf16 v[68:71], v[176:179], v[168:171], v[68:71]
    ds_read_b128 v[156:159], v249 offset:34816
    v_mfma_f32_16x16x32_bf16 v[76:79], v[184:187], v[168:171], v[76:79]
    ds_read_b64_tr_b16 v[176:177], v250 offset:16384
    v_mfma_f32_16x16x32_bf16 v[76:79], v[188:191], v[172:175], v[76:79]
    ds_read_b64_tr_b16 v[178:179], v250 offset:16896
    v_mfma_f32_16x16x32_bf16 v[72:75], v[188:191], v[164:167], v[72:75]
    ds_read_b64_tr_b16 v[180:181], v250 offset:20480
    v_mfma_f32_16x16x32_bf16 v[72:75], v[184:187], v[160:163], v[72:75]
    ds_read_b64_tr_b16 v[182:183], v250 offset:20992
    v_mfma_f32_16x16x32_bf16 v[128:131], v[192:195], v[160:163], v[128:131]
    ds_read_b64_tr_b16 v[184:185], v250 offset:40960
    v_mfma_f32_16x16x32_bf16 v[128:131], v[196:199], v[164:167], v[128:131]
    ds_read_b64_tr_b16 v[186:187], v250 offset:41472
    v_mfma_f32_16x16x32_bf16 v[132:135], v[196:199], v[172:175], v[132:135]
    ds_read_b64_tr_b16 v[188:189], v250 offset:45056
    v_mfma_f32_16x16x32_bf16 v[132:135], v[192:195], v[168:171], v[132:135]
    ds_read_b64_tr_b16 v[190:191], v250 offset:45568
    v_mfma_f32_16x16x32_bf16 v[140:143], v[200:203], v[168:171], v[140:143]
    ds_read_b64_tr_b16 v[192:193], v251 offset:16384
    v_mfma_f32_16x16x32_bf16 v[140:143], v[204:207], v[172:175], v[140:143]
    ds_read_b64_tr_b16 v[194:195], v251 offset:16896
    v_mfma_f32_16x16x32_bf16 v[136:139], v[204:207], v[164:167], v[136:139]
    ds_read_b64_tr_b16 v[196:197], v251 offset:20480
    v_mfma_f32_16x16x32_bf16 v[136:139], v[200:203], v[160:163], v[136:139]
    ds_read_b64_tr_b16 v[198:199], v251 offset:20992
    s_waitcnt lgkmcnt(8)
    v_mfma_f32_16x16x32_bf16 v[16:19], v[176:179], v[144:147], v[16:19]
    ds_read_b64_tr_b16 v[200:201], v251 offset:40960
    v_mfma_f32_16x16x32_bf16 v[16:19], v[180:183], v[148:151], v[16:19]
    ds_read_b64_tr_b16 v[202:203], v251 offset:41472
    v_mfma_f32_16x16x32_bf16 v[20:23], v[180:183], v[156:159], v[20:23]
    ds_read_b64_tr_b16 v[204:205], v251 offset:45056
    v_mfma_f32_16x16x32_bf16 v[20:23], v[176:179], v[152:155], v[20:23]
    ds_read_b64_tr_b16 v[206:207], v251 offset:45568
    s_waitcnt lgkmcnt(4)
    v_mfma_f32_16x16x32_bf16 v[28:31], v[184:187], v[152:155], v[28:31]
    ds_read_b128 v[160:163], v248 offset:36864
    v_mfma_f32_16x16x32_bf16 v[28:31], v[188:191], v[156:159], v[28:31]
    ds_read_b128 v[164:167], v249 offset:36864
    v_mfma_f32_16x16x32_bf16 v[24:27], v[188:191], v[148:151], v[24:27]
    ds_read_b128 v[168:171], v248 offset:38912
    v_mfma_f32_16x16x32_bf16 v[24:27], v[184:187], v[144:147], v[24:27]
    ds_read_b128 v[172:175], v249 offset:38912
    v_mfma_f32_16x16x32_bf16 v[80:83], v[192:195], v[144:147], v[80:83]
    v_mfma_f32_16x16x32_bf16 v[80:83], v[196:199], v[148:151], v[80:83]
    v_mfma_f32_16x16x32_bf16 v[84:87], v[196:199], v[156:159], v[84:87]
    v_mfma_f32_16x16x32_bf16 v[84:87], v[192:195], v[152:155], v[84:87]
    s_waitcnt lgkmcnt(4)
    v_mfma_f32_16x16x32_bf16 v[92:95], v[200:203], v[152:155], v[92:95]
    v_mfma_f32_16x16x32_bf16 v[92:95], v[204:207], v[156:159], v[92:95]
    v_mfma_f32_16x16x32_bf16 v[88:91], v[204:207], v[148:151], v[88:91]
    v_mfma_f32_16x16x32_bf16 v[88:91], v[200:203], v[144:147], v[88:91]
    s_waitcnt lgkmcnt(0)
    v_mfma_f32_16x16x32_bf16 v[32:35], v[176:179], v[160:163], v[32:35]
    ds_read_b128 v[144:147], v248 offset:40960
    v_mfma_f32_16x16x32_bf16 v[32:35], v[180:183], v[164:167], v[32:35]
    v_mfma_f32_16x16x32_bf16 v[36:39], v[180:183], v[172:175], v[36:39]
    ds_read_b128 v[148:151], v249 offset:40960
    v_mfma_f32_16x16x32_bf16 v[36:39], v[176:179], v[168:171], v[36:39]
    v_mfma_f32_16x16x32_bf16 v[44:47], v[184:187], v[168:171], v[44:47]
    ds_read_b128 v[152:155], v248 offset:43008
    v_mfma_f32_16x16x32_bf16 v[44:47], v[188:191], v[172:175], v[44:47]
    v_mfma_f32_16x16x32_bf16 v[40:43], v[188:191], v[164:167], v[40:43]
    ds_read_b128 v[156:159], v249 offset:43008
    v_mfma_f32_16x16x32_bf16 v[40:43], v[184:187], v[160:163], v[40:43]
    v_mfma_f32_16x16x32_bf16 v[96:99], v[192:195], v[160:163], v[96:99]
    v_mfma_f32_16x16x32_bf16 v[96:99], v[196:199], v[164:167], v[96:99]
    v_mfma_f32_16x16x32_bf16 v[100:103], v[196:199], v[172:175], v[100:103]
    v_mfma_f32_16x16x32_bf16 v[100:103], v[192:195], v[168:171], v[100:103]
    v_mfma_f32_16x16x32_bf16 v[108:111], v[200:203], v[168:171], v[108:111]
    v_mfma_f32_16x16x32_bf16 v[108:111], v[204:207], v[172:175], v[108:111]
    v_mfma_f32_16x16x32_bf16 v[104:107], v[204:207], v[164:167], v[104:107]
    v_mfma_f32_16x16x32_bf16 v[104:107], v[200:203], v[160:163], v[104:107]
    s_waitcnt lgkmcnt(0)
    v_mfma_f32_16x16x32_bf16 v[48:51], v[176:179], v[144:147], v[48:51]
    ds_read_b128 v[160:163], v248 offset:45056
    v_mfma_f32_16x16x32_bf16 v[48:51], v[180:183], v[148:151], v[48:51]
    v_mfma_f32_16x16x32_bf16 v[52:55], v[180:183], v[156:159], v[52:55]
    ds_read_b128 v[164:167], v249 offset:45056
    v_mfma_f32_16x16x32_bf16 v[52:55], v[176:179], v[152:155], v[52:55]
    v_mfma_f32_16x16x32_bf16 v[60:63], v[184:187], v[152:155], v[60:63]
    ds_read_b128 v[168:171], v248 offset:47104
    v_mfma_f32_16x16x32_bf16 v[60:63], v[188:191], v[156:159], v[60:63]
    v_mfma_f32_16x16x32_bf16 v[56:59], v[188:191], v[148:151], v[56:59]
    ds_read_b128 v[172:175], v249 offset:47104
    v_mfma_f32_16x16x32_bf16 v[56:59], v[184:187], v[144:147], v[56:59]
    v_mfma_f32_16x16x32_bf16 v[112:115], v[192:195], v[144:147], v[112:115]
    v_mfma_f32_16x16x32_bf16 v[112:115], v[196:199], v[148:151], v[112:115]
    v_mfma_f32_16x16x32_bf16 v[116:119], v[196:199], v[156:159], v[116:119]
    v_mfma_f32_16x16x32_bf16 v[116:119], v[192:195], v[152:155], v[116:119]
    v_mfma_f32_16x16x32_bf16 v[124:127], v[200:203], v[152:155], v[124:127]
    v_mfma_f32_16x16x32_bf16 v[124:127], v[204:207], v[156:159], v[124:127]
    v_mfma_f32_16x16x32_bf16 v[120:123], v[204:207], v[148:151], v[120:123]
    v_mfma_f32_16x16x32_bf16 v[120:123], v[200:203], v[144:147], v[120:123]
    s_waitcnt lgkmcnt(0)
    v_mfma_f32_16x16x32_bf16 v[64:67], v[176:179], v[160:163], v[64:67]
    s_barrier
    ds_read_b128 v[144:147], v248 offset:0
    v_mfma_f32_16x16x32_bf16 v[64:67], v[180:183], v[164:167], v[64:67]
    ds_read_b128 v[148:151], v249 offset:0
    v_mfma_f32_16x16x32_bf16 v[68:71], v[180:183], v[172:175], v[68:71]
    ds_read_b128 v[152:155], v248 offset:2048
    v_mfma_f32_16x16x32_bf16 v[68:71], v[176:179], v[168:171], v[68:71]
    ds_read_b128 v[156:159], v249 offset:2048
    v_mfma_f32_16x16x32_bf16 v[76:79], v[184:187], v[168:171], v[76:79]
    ds_read_b64_tr_b16 v[176:177], v250 offset:0
    v_mfma_f32_16x16x32_bf16 v[76:79], v[188:191], v[172:175], v[76:79]
    ds_read_b64_tr_b16 v[178:179], v250 offset:512
    v_mfma_f32_16x16x32_bf16 v[72:75], v[188:191], v[164:167], v[72:75]
    ds_read_b64_tr_b16 v[180:181], v250 offset:4096
    v_mfma_f32_16x16x32_bf16 v[72:75], v[184:187], v[160:163], v[72:75]
    ds_read_b64_tr_b16 v[182:183], v250 offset:4608
    v_mfma_f32_16x16x32_bf16 v[128:131], v[192:195], v[160:163], v[128:131]
    ds_read_b64_tr_b16 v[184:185], v250 offset:24576
    v_mfma_f32_16x16x32_bf16 v[128:131], v[196:199], v[164:167], v[128:131]
    ds_read_b64_tr_b16 v[186:187], v250 offset:25088
    v_mfma_f32_16x16x32_bf16 v[132:135], v[196:199], v[172:175], v[132:135]
    ds_read_b64_tr_b16 v[188:189], v250 offset:28672
    v_mfma_f32_16x16x32_bf16 v[132:135], v[192:195], v[168:171], v[132:135]
    ds_read_b64_tr_b16 v[190:191], v250 offset:29184
    v_mfma_f32_16x16x32_bf16 v[140:143], v[200:203], v[168:171], v[140:143]
    ds_read_b64_tr_b16 v[192:193], v251 offset:0
    v_mfma_f32_16x16x32_bf16 v[140:143], v[204:207], v[172:175], v[140:143]
    ds_read_b64_tr_b16 v[194:195], v251 offset:512
    v_mfma_f32_16x16x32_bf16 v[136:139], v[204:207], v[164:167], v[136:139]
    ds_read_b64_tr_b16 v[196:197], v251 offset:4096
    v_mfma_f32_16x16x32_bf16 v[136:139], v[200:203], v[160:163], v[136:139]
    ds_read_b64_tr_b16 v[198:199], v251 offset:4608
    s_waitcnt lgkmcnt(8)
    v_mfma_f32_16x16x32_bf16 v[16:19], v[176:179], v[144:147], v[16:19]
    ds_read_b64_tr_b16 v[200:201], v251 offset:24576
    v_mfma_f32_16x16x32_bf16 v[16:19], v[180:183], v[148:151], v[16:19]
    ds_read_b64_tr_b16 v[202:203], v251 offset:25088
    v_mfma_f32_16x16x32_bf16 v[20:23], v[180:183], v[156:159], v[20:23]
    ds_read_b64_tr_b16 v[204:205], v251 offset:28672
    v_mfma_f32_16x16x32_bf16 v[20:23], v[176:179], v[152:155], v[20:23]
    ds_read_b64_tr_b16 v[206:207], v251 offset:29184
    s_waitcnt lgkmcnt(4)
    v_mfma_f32_16x16x32_bf16 v[28:31], v[184:187], v[152:155], v[28:31]
    ds_read_b128 v[160:163], v248 offset:4096
    v_mfma_f32_16x16x32_bf16 v[28:31], v[188:191], v[156:159], v[28:31]
    ds_read_b128 v[164:167], v249 offset:4096
    v_mfma_f32_16x16x32_bf16 v[24:27], v[188:191], v[148:151], v[24:27]
    ds_read_b128 v[168:171], v248 offset:6144
    v_mfma_f32_16x16x32_bf16 v[24:27], v[184:187], v[144:147], v[24:27]
    ds_read_b128 v[172:175], v249 offset:6144
    v_mfma_f32_16x16x32_bf16 v[80:83], v[192:195], v[144:147], v[80:83]
    v_mfma_f32_16x16x32_bf16 v[80:83], v[196:199], v[148:151], v[80:83]
    v_mfma_f32_16x16x32_bf16 v[84:87], v[196:199], v[156:159], v[84:87]
    v_mfma_f32_16x16x32_bf16 v[84:87], v[192:195], v[152:155], v[84:87]
    s_waitcnt lgkmcnt(4)
    v_mfma_f32_16x16x32_bf16 v[92:95], v[200:203], v[152:155], v[92:95]
    v_mfma_f32_16x16x32_bf16 v[92:95], v[204:207], v[156:159], v[92:95]
    v_mfma_f32_16x16x32_bf16 v[88:91], v[204:207], v[148:151], v[88:91]
    v_mfma_f32_16x16x32_bf16 v[88:91], v[200:203], v[144:147], v[88:91]
    s_waitcnt lgkmcnt(0)
    v_mfma_f32_16x16x32_bf16 v[32:35], v[176:179], v[160:163], v[32:35]
    s_barrier
    v_mfma_f32_16x16x32_bf16 v[32:35], v[180:183], v[164:167], v[32:35]
    ds_read_b128 v[144:147], v248 offset:8192
    v_mfma_f32_16x16x32_bf16 v[36:39], v[180:183], v[172:175], v[36:39]
    ds_read_b128 v[148:151], v249 offset:8192
    v_mfma_f32_16x16x32_bf16 v[36:39], v[176:179], v[168:171], v[36:39]
    ds_read_b128 v[152:155], v248 offset:10240
    v_mfma_f32_16x16x32_bf16 v[44:47], v[184:187], v[168:171], v[44:47]
    ds_read_b128 v[156:159], v249 offset:10240
    v_mfma_f32_16x16x32_bf16 v[44:47], v[188:191], v[172:175], v[44:47]
    ds_read_b128 v[2:5], v9 offset:57344
    v_mfma_f32_16x16x32_bf16 v[40:43], v[188:191], v[164:167], v[40:43]
    ds_read_b128 v[6:9], v9 offset:58400
    v_mfma_f32_16x16x32_bf16 v[40:43], v[184:187], v[160:163], v[40:43]
    ds_read_b128 v[216:219], v10 offset:0
    v_mfma_f32_16x16x32_bf16 v[96:99], v[192:195], v[160:163], v[96:99]
    ds_read_b128 v[220:223], v10 offset:1024
    v_mfma_f32_16x16x32_bf16 v[96:99], v[196:199], v[164:167], v[96:99]
    ds_read_b128 v[224:227], v11 offset:0
    v_mfma_f32_16x16x32_bf16 v[100:103], v[196:199], v[172:175], v[100:103]
    ds_read_b128 v[228:231], v11 offset:1024
    v_mfma_f32_16x16x32_bf16 v[100:103], v[192:195], v[168:171], v[100:103]
    ds_read_b128 v[232:235], v10 offset:2048
    v_mfma_f32_16x16x32_bf16 v[108:111], v[200:203], v[168:171], v[108:111]
    ds_read_b128 v[236:239], v10 offset:3072
    v_mfma_f32_16x16x32_bf16 v[108:111], v[204:207], v[172:175], v[108:111]
    ds_read_b128 v[240:243], v11 offset:2048
    v_mfma_f32_16x16x32_bf16 v[104:107], v[204:207], v[164:167], v[104:107]
    ds_read_b128 v[244:247], v11 offset:3072
    v_mfma_f32_16x16x32_bf16 v[104:107], v[200:203], v[160:163], v[104:107]
    s_and_b32 s69, s58, 3
    s_cmp_eq_u32 s69, 3
    s_cbranch_scc1 L_qt
    s_waitcnt lgkmcnt(10)
    v_mfma_f32_16x16x32_bf16 v[48:51], v[176:179], v[144:147], v[48:51]
    ds_read_b128 v[160:163], v248 offset:12288
    v_mfma_f32_16x16x32_bf16 v[48:51], v[180:183], v[148:151], v[48:51]
    v_mfma_f32_16x16x32_bf16 v[52:55], v[180:183], v[156:159], v[52:55]
    ds_read_b128 v[164:167], v249 offset:12288
    v_mfma_f32_16x16x32_bf16 v[52:55], v[176:179], v[152:155], v[52:55]
    v_mfma_f32_16x16x32_bf16 v[60:63], v[184:187], v[152:155], v[60:63]
    ds_read_b128 v[168:171], v248 offset:14336
    v_mfma_f32_16x16x32_bf16 v[60:63], v[188:191], v[156:159], v[60:63]
    v_mfma_f32_16x16x32_bf16 v[56:59], v[188:191], v[148:151], v[56:59]
    ds_read_b128 v[172:175], v249 offset:14336
    v_mfma_f32_16x16x32_bf16 v[56:59], v[184:187], v[144:147], v[56:59]
    v_mfma_f32_16x16x32_bf16 v[112:115], v[192:195], v[144:147], v[112:115]
    v_mfma_f32_16x16x32_bf16 v[112:115], v[196:199], v[148:151], v[112:115]
    v_mfma_f32_16x16x32_bf16 v[116:119], v[196:199], v[156:159], v[116:119]
    v_mfma_f32_16x16x32_bf16 v[116:119], v[192:195], v[152:155], v[116:119]
    v_mfma_f32_16x16x32_bf16 v[124:127], v[200:203], v[152:155], v[124:127]
    v_mfma_f32_16x16x32_bf16 v[124:127], v[204:207], v[156:159], v[124:127]
    v_mfma_f32_16x16x32_bf16 v[120:123], v[204:207], v[148:151], v[120:123]
    v_mfma_f32_16x16x32_bf16 v[120:123], v[200:203], v[144:147], v[120:123]
    s_waitcnt lgkmcnt(0)
    v_mfma_f32_16x16x32_bf16 v[136:139], v[200:203], v[160:163], v[136:139]
    v_mfma_f32_16x16x32_bf16 v[136:139], v[204:207], v[164:167], v[136:139]
    v_mfma_f32_16x16x32_bf16 v[140:143], v[204:207], v[172:175], v[140:143]
    v_mfma_f32_16x16x32_bf16 v[140:143], v[200:203], v[168:171], v[140:143]
    v_mfma_f32_32x32x16_bf16 v[16:31], v[2:5], v[218:221], v[16:31]
    v_mfma_f32_16x16x32_bf16 v[132:135], v[192:195], v[168:171], v[132:135]
    v_mfma_f32_16x16x32_bf16 v[132:135], v[196:199], v[172:175], v[132:135]
    v_mfma_f32_16x16x32_bf16 v[128:131], v[196:199], v[164:167], v[128:131]
    v_mfma_f32_16x16x32_bf16 v[128:131], v[192:195], v[160:163], v[128:131]
    v_mfma_f32_16x16x32_bf16 v[72:75], v[184:187], v[160:163], v[72:75]
    ds_read_b128 v[192:195], v10 offset:4096
    v_mfma_f32_16x16x32_bf16 v[72:75], v[188:191], v[164:167], v[72:75]
    ds_read_b128 v[196:199], v10 offset:5120
    v_mfma_f32_16x16x32_bf16 v[76:79], v[188:191], v[172:175], v[76:79]
    ds_read_b128 v[200:203], v11 offset:4096
    v_mfma_f32_16x16x32_bf16 v[76:79], v[184:187], v[168:171], v[76:79]
    ds_read_b128 v[204:207], v11 offset:5120
    v_mfma_f32_16x16x32_bf16 v[68:71], v[176:179], v[168:171], v[68:71]
    v_mfma_f32_16x16x32_bf16 v[68:71], v[180:183], v[172:175], v[68:71]
    v_mfma_f32_16x16x32_bf16 v[64:67], v[180:183], v[164:167], v[64:67]
    v_mfma_f32_16x16x32_bf16 v[64:67], v[176:179], v[160:163], v[64:67]
.p2align 3
    v_pk_mul_f32 v[144:145], v[16:17], v[16:17]
    v_pk_mul_f32 v[146:147], v[18:19], v[18:19]
    v_pk_mul_f32 v[148:149], v[20:21], v[20:21]
    v_pk_mul_f32 v[150:151], v[22:23], v[22:23]
    v_pk_fma_f32 v[144:145], v[144:145], v[226:227], v[224:225]
    v_pk_fma_f32 v[146:147], v[146:147], v[226:227], v[224:225]
    v_pk_fma_f32 v[148:149], v[148:149], v[230:231], v[228:229]
    v_pk_fma_f32 v[150:151], v[150:151], v[230:231], v[228:229]
    v_pk_mul_f32 v[144:145], v[144:145], v[16:17]
    v_pk_mul_f32 v[146:147], v[146:147], v[18:19]
    v_pk_mul_f32 v[148:149], v[148:149], v[20:21]
    v_pk_mul_f32 v[150:151], v[150:151], v[22:23]
    v_mfma_f32_32x32x16_bf16 v[80:95], v[6:9], v[218:221], v[80:95]
    v_exp_f32 v144, v144
    v_exp_f32 v145, v145
    v_exp_f32 v146, v146
    v_exp_f32 v147, v147
    v_exp_f32 v148, v148
    v_exp_f32 v149, v149
    v_exp_f32 v150, v150
    v_exp_f32 v151, v151
    v_pk_mul_f32 v[152:153], v[16:17], v[24:25]
    v_pk_mul_f32 v[154:155], v[18:19], v[26:27]
    v_pk_mul_f32 v[156:157], v[20:21], v[28:29]
    v_pk_mul_f32 v[158:159], v[22:23], v[30:31]
    v_pk_fma_f32 v[144:145], v[144:145], v[216:217], v[216:217]
    v_pk_fma_f32 v[146:147], v[146:147], v[216:217], v[216:217]
    v_pk_fma_f32 v[148:149], v[148:149], v[222:223], v[222:223]
    v_pk_fma_f32 v[150:151], v[150:151], v[222:223], v[222:223]
    v_rcp_f32 v144, v144
    v_rcp_f32 v145, v145
    v_rcp_f32 v146, v146
    v_rcp_f32 v147, v147
    v_rcp_f32 v148, v148
    v_rcp_f32 v149, v149
    v_rcp_f32 v150, v150
    v_rcp_f32 v151, v151
    v_pk_mul_f32 v[152:153], v[152:153], v[144:145]
    v_pk_mul_f32 v[154:155], v[154:155], v[146:147]
    v_pk_mul_f32 v[156:157], v[156:157], v[148:149]
    v_pk_mul_f32 v[158:159], v[158:159], v[150:151]
    v_cvt_pk_bf16_f32 v160, v152, v153
    v_cvt_pk_bf16_f32 v161, v154, v155
    v_cvt_pk_bf16_f32 v162, v156, v157
    v_cvt_pk_bf16_f32 v163, v158, v159
    s_branch L_pg34
.p2align 12
L_stub34:
    s_nop 0
    s_setpc_b64 s[0:1]
L_pg34:
.p2align 3
    v_pk_mul_f32 v[144:145], v[80:81], v[80:81]
    v_pk_mul_f32 v[146:147], v[82:83], v[82:83]
    v_pk_mul_f32 v[148:149], v[84:85], v[84:85]
    v_pk_mul_f32 v[150:151], v[86:87], v[86:87]
    v_permlane16_swap_b32 v160, v162
    v_permlane16_swap_b32 v161, v163
    v_pk_fma_f32 v[144:145], v[144:145], v[226:227], v[224:225]
    v_pk_fma_f32 v[146:147], v[146:147], v[226:227], v[224:225]
    v_pk_fma_f32 v[148:149], v[148:149], v[230:231], v[228:229]
    v_pk_fma_f32 v[150:151], v[150:151], v[230:231], v[228:229]
    v_pk_mul_f32 v[144:145], v[144:145], v[80:81]
    v_pk_mul_f32 v[146:147], v[146:147], v[82:83]
    v_pk_mul_f32 v[148:149], v[148:149], v[84:85]
    v_pk_mul_f32 v[150:151], v[150:151], v[86:87]
    v_mfma_f32_32x32x16_bf16 v[32:47], v[2:5], v[234:237], v[32:47]
    v_exp_f32 v144, v144
    v_exp_f32 v145, v145
    v_exp_f32 v146, v146
    v_exp_f32 v147, v147
    v_exp_f32 v148, v148
    v_exp_f32 v149, v149
    v_exp_f32 v150, v150
    v_exp_f32 v151, v151
    v_pk_mul_f32 v[152:153], v[80:81], v[88:89]
    v_pk_mul_f32 v[154:155], v[82:83], v[90:91]
    v_pk_mul_f32 v[156:157], v[84:85], v[92:93]
    v_pk_mul_f32 v[158:159], v[86:87], v[94:95]
    v_pk_fma_f32 v[144:145], v[144:145], v[216:217], v[216:217]
    v_pk_fma_f32 v[146:147], v[146:147], v[216:217], v[216:217]
    v_pk_fma_f32 v[148:149], v[148:149], v[222:223], v[222:223]
    v_pk_fma_f32 v[150:151], v[150:151], v[222:223], v[222:223]
    v_rcp_f32 v144, v144
    v_rcp_f32 v145, v145
    v_rcp_f32 v146, v146
    v_rcp_f32 v147, v147
    v_rcp_f32 v148, v148
    v_rcp_f32 v149, v149
    v_rcp_f32 v150, v150
    v_rcp_f32 v151, v151
    v_pk_mul_f32 v[152:153], v[152:153], v[144:145]
    v_pk_mul_f32 v[154:155], v[154:155], v[146:147]
    v_pk_mul_f32 v[156:157], v[156:157], v[148:149]
    v_pk_mul_f32 v[158:159], v[158:159], v[150:151]
    v_cvt_pk_bf16_f32 v176, v152, v153
    v_cvt_pk_bf16_f32 v177, v154, v155
    v_cvt_pk_bf16_f32 v178, v156, v157
    v_cvt_pk_bf16_f32 v179, v158, v159
    ds_read_b128 v[216:219], v10 offset:6144
    ds_read_b128 v[220:223], v10 offset:7168
    ds_read_b128 v[224:227], v11 offset:6144
    ds_read_b128 v[228:231], v11 offset:7168
.p2align 3
    v_pk_mul_f32 v[144:145], v[32:33], v[32:33]
    v_pk_mul_f32 v[146:147], v[34:35], v[34:35]
    v_pk_mul_f32 v[148:149], v[36:37], v[36:37]
    v_pk_mul_f32 v[150:151], v[38:39], v[38:39]
    v_permlane16_swap_b32 v176, v178
    v_permlane16_swap_b32 v177, v179
    v_pk_fma_f32 v[144:145], v[144:145], v[242:243], v[240:241]
    v_pk_fma_f32 v[146:147], v[146:147], v[242:243], v[240:241]
    v_pk_fma_f32 v[148:149], v[148:149], v[246:247], v[244:245]
    v_pk_fma_f32 v[150:151], v[150:151], v[246:247], v[244:245]
    v_pk_mul_f32 v[144:145], v[144:145], v[32:33]
    v_pk_mul_f32 v[146:147], v[146:147], v[34:35]
    v_pk_mul_f32 v[148:149], v[148:149], v[36:37]
    v_pk_mul_f32 v[150:151], v[150:151], v[38:39]
    v_mfma_f32_32x32x16_bf16 v[96:111], v[6:9], v[234:237], v[96:111]
    v_exp_f32 v144, v144
    v_exp_f32 v145, v145
    v_exp_f32 v146, v146
    v_exp_f32 v147, v147
    v_exp_f32 v148, v148
    v_exp_f32 v149, v149
    v_exp_f32 v150, v150
    v_exp_f32 v151, v151
    v_pk_mul_f32 v[152:153], v[32:33], v[40:41]
    v_pk_mul_f32 v[154:155], v[34:35], v[42:43]
    v_pk_mul_f32 v[156:157], v[36:37], v[44:45]
    v_pk_mul_f32 v[158:159], v[38:39], v[46:47]
    v_pk_fma_f32 v[144:145], v[144:145], v[232:233], v[232:233]
    v_pk_fma_f32 v[146:147], v[146:147], v[232:233], v[232:233]
    v_pk_fma_f32 v[148:149], v[148:149], v[238:239], v[238:239]
    v_pk_fma_f32 v[150:151], v[150:151], v[238:239], v[238:239]
    v_rcp_f32 v144, v144
    v_rcp_f32 v145, v145
    v_rcp_f32 v146, v146
    v_rcp_f32 v147, v147
    v_rcp_f32 v148, v148
    v_rcp_f32 v149, v149
    v_rcp_f32 v150, v150
    v_rcp_f32 v151, v151
    v_pk_mul_f32 v[152:153], v[152:153], v[144:145]
    v_pk_mul_f32 v[154:155], v[154:155], v[146:147]
    v_pk_mul_f32 v[156:157], v[156:157], v[148:149]
    v_pk_mul_f32 v[158:159], v[158:159], v[150:151]
    v_cvt_pk_bf16_f32 v164, v152, v153
    v_cvt_pk_bf16_f32 v165, v154, v155
    v_cvt_pk_bf16_f32 v166, v156, v157
    v_cvt_pk_bf16_f32 v167, v158, v159
    s_waitcnt lgkmcnt(0)
.p2align 3
    v_pk_mul_f32 v[144:145], v[96:97], v[96:97]
    v_pk_mul_f32 v[146:147], v[98:99], v[98:99]
    v_pk_mul_f32 v[148:149], v[100:101], v[100:101]
    v_pk_mul_f32 v[150:151], v[102:103], v[102:103]
    v_permlane16_swap_b32 v164, v166
    v_permlane16_swap_b32 v165, v167
    v_pk_fma_f32 v[144:145], v[144:145], v[242:243], v[240:241]
    v_pk_fma_f32 v[146:147], v[146:147], v[242:243], v[240:241]
    v_pk_fma_f32 v[148:149], v[148:149], v[246:247], v[244:245]
    v_pk_fma_f32 v[150:151], v[150:151], v[246:247], v[244:245]
    v_pk_mul_f32 v[144:145], v[144:145], v[96:97]
    v_pk_mul_f32 v[146:147], v[146:147], v[98:99]
    v_pk_mul_f32 v[148:149], v[148:149], v[100:101]
    v_pk_mul_f32 v[150:151], v[150:151], v[102:103]
    v_mfma_f32_32x32x16_bf16 v[48:63], v[2:5], v[194:197], v[48:63]
    v_exp_f32 v144, v144
    v_exp_f32 v145, v145
    v_exp_f32 v146, v146
    v_exp_f32 v147, v147
    v_exp_f32 v148, v148
    v_exp_f32 v149, v149
    v_exp_f32 v150, v150
    v_exp_f32 v151, v151
    v_pk_mul_f32 v[152:153], v[96:97], v[104:105]
    v_pk_mul_f32 v[154:155], v[98:99], v[106:107]
    v_pk_mul_f32 v[156:157], v[100:101], v[108:109]
    v_pk_mul_f32 v[158:159], v[102:103], v[110:111]
    v_pk_fma_f32 v[144:145], v[144:145], v[232:233], v[232:233]
    v_pk_fma_f32 v[146:147], v[146:147], v[232:233], v[232:233]
    v_pk_fma_f32 v[148:149], v[148:149], v[238:239], v[238:239]
    v_pk_fma_f32 v[150:151], v[150:151], v[238:239], v[238:239]
    v_rcp_f32 v144, v144
    v_rcp_f32 v145, v145
    v_rcp_f32 v146, v146
    v_rcp_f32 v147, v147
    v_rcp_f32 v148, v148
    v_rcp_f32 v149, v149
    v_rcp_f32 v150, v150
    v_rcp_f32 v151, v151
    v_pk_mul_f32 v[152:153], v[152:153], v[144:145]
    v_pk_mul_f32 v[154:155], v[154:155], v[146:147]
    v_pk_mul_f32 v[156:157], v[156:157], v[148:149]
    v_pk_mul_f32 v[158:159], v[158:159], v[150:151]
    v_cvt_pk_bf16_f32 v180, v152, v153
    v_cvt_pk_bf16_f32 v181, v154, v155
    v_cvt_pk_bf16_f32 v182, v156, v157
    v_cvt_pk_bf16_f32 v183, v158, v159
.p2align 3
    v_pk_mul_f32 v[144:145], v[48:49], v[48:49]
    v_pk_mul_f32 v[146:147], v[50:51], v[50:51]
    v_pk_mul_f32 v[148:149], v[52:53], v[52:53]
    v_pk_mul_f32 v[150:151], v[54:55], v[54:55]
    v_permlane16_swap_b32 v180, v182
    v_permlane16_swap_b32 v181, v183
    v_pk_fma_f32 v[144:145], v[144:145], v[202:203], v[200:201]
    v_pk_fma_f32 v[146:147], v[146:147], v[202:203], v[200:201]
    v_pk_fma_f32 v[148:149], v[148:149], v[206:207], v[204:205]
    v_pk_fma_f32 v[150:151], v[150:151], v[206:207], v[204:205]
    v_pk_mul_f32 v[144:145], v[144:145], v[48:49]
    v_pk_mul_f32 v[146:147], v[146:147], v[50:51]
    v_pk_mul_f32 v[148:149], v[148:149], v[52:53]
    v_pk_mul_f32 v[150:151], v[150:151], v[54:55]
    v_mfma_f32_32x32x16_bf16 v[112:127], v[6:9], v[194:197], v[112:127]
    v_exp_f32 v144, v144
    v_exp_f32 v145, v145
    v_exp_f32 v146, v146
    v_exp_f32 v147, v147
    v_exp_f32 v148, v148
    v_exp_f32 v149, v149
    v_exp_f32 v150, v150
    v_exp_f32 v151, v151
    v_pk_mul_f32 v[152:153], v[48:49], v[56:57]
    v_pk_mul_f32 v[154:155], v[50:51], v[58:59]
    v_pk_mul_f32 v[156:157], v[52:53], v[60:61]
    v_pk_mul_f32 v[158:159], v[54:55], v[62:63]
    v_pk_fma_f32 v[144:145], v[144:145], v[192:193], v[192:193]
    v_pk_fma_f32 v[146:147], v[146:147], v[192:193], v[192:193]
    v_pk_fma_f32 v[148:149], v[148:149], v[198:199], v[198:199]
    v_pk_fma_f32 v[150:151], v[150:151], v[198:199], v[198:199]
    v_rcp_f32 v144, v144
    v_rcp_f32 v145, v145
    v_rcp_f32 v146, v146
    v_rcp_f32 v147, v147
    v_rcp_f32 v148, v148
    v_rcp_f32 v149, v149
    v_rcp_f32 v150, v150
    v_rcp_f32 v151, v151
    v_pk_mul_f32 v[152:153], v[152:153], v[144:145]
    v_pk_mul_f32 v[154:155], v[154:155], v[146:147]
    v_pk_mul_f32 v[156:157], v[156:157], v[148:149]
    v_pk_mul_f32 v[158:159], v[158:159], v[150:151]
    v_cvt_pk_bf16_f32 v168, v152, v153
    v_cvt_pk_bf16_f32 v169, v154, v155
    v_cvt_pk_bf16_f32 v170, v156, v157
    v_cvt_pk_bf16_f32 v171, v158, v159
    s_waitcnt lgkmcnt(0)
    s_barrier
.p2align 3
    v_pk_mul_f32 v[144:145], v[112:113], v[112:113]
    v_pk_mul_f32 v[146:147], v[114:115], v[114:115]
    v_pk_mul_f32 v[148:149], v[116:117], v[116:117]
    v_pk_mul_f32 v[150:151], v[118:119], v[118:119]
    v_permlane16_swap_b32 v168, v170
    v_permlane16_swap_b32 v169, v171
    v_pk_fma_f32 v[144:145], v[144:145], v[202:203], v[200:201]
    v_pk_fma_f32 v[146:147], v[146:147], v[202:203], v[200:201]
    v_pk_fma_f32 v[148:149], v[148:149], v[206:207], v[204:205]
    v_pk_fma_f32 v[150:151], v[150:151], v[206:207], v[204:205]
    v_pk_mul_f32 v[144:145], v[144:145], v[112:113]
    v_pk_mul_f32 v[146:147], v[146:147], v[114:115]
    v_pk_mul_f32 v[148:149], v[148:149], v[116:117]
    v_pk_mul_f32 v[150:151], v[150:151], v[118:119]
    v_mfma_f32_32x32x16_bf16 v[64:79], v[2:5], v[218:221], v[64:79]
    v_exp_f32 v144, v144
    v_exp_f32 v145, v145
    v_exp_f32 v146, v146
    v_exp_f32 v147, v147
    v_exp_f32 v148, v148
    v_exp_f32 v149, v149
    v_exp_f32 v150, v150
    v_exp_f32 v151, v151
    v_pk_mul_f32 v[152:153], v[112:113], v[120:121]
    v_pk_mul_f32 v[154:155], v[114:115], v[122:123]
    v_pk_mul_f32 v[156:157], v[116:117], v[124:125]
    v_pk_mul_f32 v[158:159], v[118:119], v[126:127]
    v_pk_fma_f32 v[144:145], v[144:145], v[192:193], v[192:193]
    v_pk_fma_f32 v[146:147], v[146:147], v[192:193], v[192:193]
    v_pk_fma_f32 v[148:149], v[148:149], v[198:199], v[198:199]
    v_pk_fma_f32 v[150:151], v[150:151], v[198:199], v[198:199]
    v_rcp_f32 v144, v144
    v_rcp_f32 v145, v145
    v_rcp_f32 v146, v146
    v_rcp_f32 v147, v147
    v_rcp_f32 v148, v148
    v_rcp_f32 v149, v149
    v_rcp_f32 v150, v150
    v_rcp_f32 v151, v151
    v_pk_mul_f32 v[152:153], v[152:153], v[144:145]
    v_pk_mul_f32 v[154:155], v[154:155], v[146:147]
    v_pk_mul_f32 v[156:157], v[156:157], v[148:149]
    v_pk_mul_f32 v[158:159], v[158:159], v[150:151]
    v_cvt_pk_bf16_f32 v184, v152, v153
    v_cvt_pk_bf16_f32 v185, v154, v155
    v_cvt_pk_bf16_f32 v186, v156, v157
    v_cvt_pk_bf16_f32 v187, v158, v159
.p2align 3
    v_pk_mul_f32 v[144:145], v[64:65], v[64:65]
    v_pk_mul_f32 v[146:147], v[66:67], v[66:67]
    v_pk_mul_f32 v[148:149], v[68:69], v[68:69]
    v_pk_mul_f32 v[150:151], v[70:71], v[70:71]
    v_permlane16_swap_b32 v184, v186
    v_permlane16_swap_b32 v185, v187
    v_pk_fma_f32 v[144:145], v[144:145], v[226:227], v[224:225]
    v_pk_fma_f32 v[146:147], v[146:147], v[226:227], v[224:225]
    v_pk_fma_f32 v[148:149], v[148:149], v[230:231], v[228:229]
    v_pk_fma_f32 v[150:151], v[150:151], v[230:231], v[228:229]
    v_pk_mul_f32 v[144:145], v[144:145], v[64:65]
    v_pk_mul_f32 v[146:147], v[146:147], v[66:67]
    v_pk_mul_f32 v[148:149], v[148:149], v[68:69]
    v_pk_mul_f32 v[150:151], v[150:151], v[70:71]
    v_mfma_f32_32x32x16_bf16 v[128:143], v[6:9], v[218:221], v[128:143]
    v_exp_f32 v144, v144
    v_exp_f32 v145, v145
    v_exp_f32 v146, v146
    v_exp_f32 v147, v147
    v_exp_f32 v148, v148
    v_exp_f32 v149, v149
    v_exp_f32 v150, v150
    v_exp_f32 v151, v151
    v_pk_mul_f32 v[152:153], v[64:65], v[72:73]
    v_pk_mul_f32 v[154:155], v[66:67], v[74:75]
    v_pk_mul_f32 v[156:157], v[68:69], v[76:77]
    v_pk_mul_f32 v[158:159], v[70:71], v[78:79]
    v_pk_fma_f32 v[144:145], v[144:145], v[216:217], v[216:217]
    v_pk_fma_f32 v[146:147], v[146:147], v[216:217], v[216:217]
    v_pk_fma_f32 v[148:149], v[148:149], v[222:223], v[222:223]
    v_pk_fma_f32 v[150:151], v[150:151], v[222:223], v[222:223]
    v_rcp_f32 v144, v144
    v_rcp_f32 v145, v145
    v_rcp_f32 v146, v146
    v_rcp_f32 v147, v147
    v_rcp_f32 v148, v148
    v_rcp_f32 v149, v149
    v_rcp_f32 v150, v150
    v_rcp_f32 v151, v151
    v_pk_mul_f32 v[152:153], v[152:153], v[144:145]
    v_pk_mul_f32 v[154:155], v[154:155], v[146:147]
    v_pk_mul_f32 v[156:157], v[156:157], v[148:149]
    v_pk_mul_f32 v[158:159], v[158:159], v[150:151]
    v_cvt_pk_bf16_f32 v172, v152, v153
    v_cvt_pk_bf16_f32 v173, v154, v155
    v_cvt_pk_bf16_f32 v174, v156, v157
    v_cvt_pk_bf16_f32 v175, v158, v159
.p2align 3
    v_pk_mul_f32 v[144:145], v[128:129], v[128:129]
    v_pk_mul_f32 v[146:147], v[130:131], v[130:131]
    v_pk_mul_f32 v[148:149], v[132:133], v[132:133]
    v_pk_mul_f32 v[150:151], v[134:135], v[134:135]
    v_permlane16_swap_b32 v172, v174
    v_permlane16_swap_b32 v173, v175
    v_pk_fma_f32 v[144:145], v[144:145], v[226:227], v[224:225]
    v_pk_fma_f32 v[146:147], v[146:147], v[226:227], v[224:225]
    v_pk_fma_f32 v[148:149], v[148:149], v[230:231], v[228:229]
    v_pk_fma_f32 v[150:151], v[150:151], v[230:231], v[228:229]
    v_pk_mul_f32 v[144:145], v[144:145], v[128:129]
    v_pk_mul_f32 v[146:147], v[146:147], v[130:131]
    v_pk_mul_f32 v[148:149], v[148:149], v[132:133]
    v_pk_mul_f32 v[150:151], v[150:151], v[134:135]
    v_exp_f32 v144, v144
    v_exp_f32 v145, v145
    v_exp_f32 v146, v146
    v_exp_f32 v147, v147
    v_exp_f32 v148, v148
    v_exp_f32 v149, v149
    v_exp_f32 v150, v150
    v_exp_f32 v151, v151
    v_pk_mul_f32 v[152:153], v[128:129], v[136:137]
    v_pk_mul_f32 v[154:155], v[130:131], v[138:139]
    v_pk_mul_f32 v[156:157], v[132:133], v[140:141]
    v_pk_mul_f32 v[158:159], v[134:135], v[142:143]
    v_pk_fma_f32 v[144:145], v[144:145], v[216:217], v[216:217]
    v_pk_fma_f32 v[146:147], v[146:147], v[216:217], v[216:217]
    v_pk_fma_f32 v[148:149], v[148:149], v[222:223], v[222:223]
    v_pk_fma_f32 v[150:151], v[150:151], v[222:223], v[222:223]
    v_rcp_f32 v144, v144
    v_rcp_f32 v145, v145
    v_rcp_f32 v146, v146
    v_rcp_f32 v147, v147
    v_rcp_f32 v148, v148
    v_rcp_f32 v149, v149
    v_rcp_f32 v150, v150
    v_rcp_f32 v151, v151
    v_pk_mul_f32 v[152:153], v[152:153], v[144:145]
    v_pk_mul_f32 v[154:155], v[154:155], v[146:147]
    v_pk_mul_f32 v[156:157], v[156:157], v[148:149]
    v_pk_mul_f32 v[158:159], v[158:159], v[150:151]
    v_cvt_pk_bf16_f32 v188, v152, v153
    v_cvt_pk_bf16_f32 v189, v154, v155
    v_cvt_pk_bf16_f32 v190, v156, v157
    v_cvt_pk_bf16_f32 v191, v158, v159
    s_nop 1
    v_permlane16_swap_b32 v188, v190
    v_permlane16_swap_b32 v189, v191
    s_branch L_joinA
L_qt:
    ds_read_b128 v[160:163], v248 offset:12288
    ds_read_b128 v[164:167], v249 offset:12288
    ds_read_b128 v[168:171], v248 offset:14336
    ds_read_b128 v[172:175], v249 offset:14336
    s_waitcnt lgkmcnt(4)
    s_nop 0
    v_mfma_f32_32x32x16_bf16 v[80:95], v[6:9], v[218:221], v[80:95]
    v_mfma_f32_32x32x16_bf16 v[96:111], v[6:9], v[234:237], v[96:111]
    s_nop 4
    v_mul_f32 v12, 0xbe206c99, v224
    v_mul_f32 v13, 0xbe206c99, v224
    v_mul_f32 v14, 0xbe206c99, v228
    v_mul_f32 v15, 0xbe206c99, v228
    s_add_u32 s68, s14, 0
    s_add_u32 s69, s68, 4096
    v_pk_mul_f32 v[80:81], v[80:81], v[12:13]
    v_pk_mul_f32 v[82:83], v[82:83], v[12:13]
    v_pk_mul_f32 v[84:85], v[84:85], v[14:15]
    v_pk_mul_f32 v[86:87], v[86:87], v[14:15]
    v_cvt_pk_bf16_f32 v80, v80, v81
    v_cvt_pk_bf16_f32 v81, v82, v83
    v_cvt_pk_bf16_f32 v82, v84, v85
    v_cvt_pk_bf16_f32 v83, v86, v87
    v_min_u32 v80, -2, v80
    v_min_u32 v82, -2, v82
    v_min_u32 v81, -2, v81
    v_min_u32 v83, -2, v83
    v_permlane16_swap_b32 v80, v82
    s_nop 0
    v_permlane16_swap_b32 v81, v83
    buffer_store_dwordx4 v[80:83], v208, s[52:55], s68 offen sc1
    v_pk_mul_f32 v[88:89], v[88:89], v[12:13]
    v_pk_mul_f32 v[90:91], v[90:91], v[12:13]
    v_pk_mul_f32 v[92:93], v[92:93], v[14:15]
    v_pk_mul_f32 v[94:95], v[94:95], v[14:15]
    v_cvt_pk_bf16_f32 v88, v88, v89
    v_cvt_pk_bf16_f32 v89, v90, v91
    v_cvt_pk_bf16_f32 v90, v92, v93
    v_cvt_pk_bf16_f32 v91, v94, v95
    v_min_u32 v88, -2, v88
    v_min_u32 v90, -2, v90
    v_min_u32 v89, -2, v89
    v_min_u32 v91, -2, v91
    v_permlane16_swap_b32 v88, v90
    s_nop 0
    v_permlane16_swap_b32 v89, v91
    buffer_store_dwordx4 v[88:91], v208, s[52:55], s69 offen sc1
    v_mul_f32 v12, 0xbe206c99, v240
    v_mul_f32 v13, 0xbe206c99, v240
    v_mul_f32 v14, 0xbe206c99, v244
    v_mul_f32 v15, 0xbe206c99, v244
    s_add_u32 s68, s14, 32768
    s_add_u32 s69, s68, 4096
    v_pk_mul_f32 v[96:97], v[96:97], v[12:13]
    v_pk_mul_f32 v[98:99], v[98:99], v[12:13]
    v_pk_mul_f32 v[100:101], v[100:101], v[14:15]
    v_pk_mul_f32 v[102:103], v[102:103], v[14:15]
    v_cvt_pk_bf16_f32 v96, v96, v97
    v_cvt_pk_bf16_f32 v97, v98, v99
    v_cvt_pk_bf16_f32 v98, v100, v101
    v_cvt_pk_bf16_f32 v99, v102, v103
    v_min_u32 v96, -2, v96
    v_min_u32 v98, -2, v98
    v_min_u32 v97, -2, v97
    v_min_u32 v99, -2, v99
    v_permlane16_swap_b32 v96, v98
    s_nop 0
    v_permlane16_swap_b32 v97, v99
    buffer_store_dwordx4 v[96:99], v208, s[52:55], s68 offen sc1
    v_pk_mul_f32 v[104:105], v[104:105], v[12:13]
    v_pk_mul_f32 v[106:107], v[106:107], v[12:13]
    v_pk_mul_f32 v[108:109], v[108:109], v[14:15]
    v_pk_mul_f32 v[110:111], v[110:111], v[14:15]
    v_cvt_pk_bf16_f32 v104, v104, v105
    v_cvt_pk_bf16_f32 v105, v106, v107
    v_cvt_pk_bf16_f32 v106, v108, v109
    v_cvt_pk_bf16_f32 v107, v110, v111
    v_min_u32 v104, -2, v104
    v_min_u32 v106, -2, v106
    v_min_u32 v105, -2, v105
    v_min_u32 v107, -2, v107
    v_permlane16_swap_b32 v104, v106
    s_nop 0
    v_permlane16_swap_b32 v105, v107
    buffer_store_dwordx4 v[104:107], v208, s[52:55], s69 offen sc1
    s_waitcnt lgkmcnt(0)
    v_mfma_f32_16x16x32_bf16 v[112:115], v[192:195], v[144:147], v[112:115]
    ds_read_b128 v[80:83], v10 offset:4096
    v_mfma_f32_16x16x32_bf16 v[112:115], v[196:199], v[148:151], v[112:115]
    ds_read_b128 v[84:87], v10 offset:5120
    v_mfma_f32_16x16x32_bf16 v[116:119], v[196:199], v[156:159], v[116:119]
    ds_read_b128 v[88:91], v11 offset:4096
    v_mfma_f32_16x16x32_bf16 v[116:119], v[192:195], v[152:155], v[116:119]
    ds_read_b128 v[92:95], v11 offset:5120
    v_mfma_f32_16x16x32_bf16 v[124:127], v[200:203], v[152:155], v[124:127]
    ds_read_b128 v[96:99], v10 offset:6144
    v_mfma_f32_16x16x32_bf16 v[124:127], v[204:207], v[156:159], v[124:127]
    ds_read_b128 v[100:103], v10 offset:7168
    v_mfma_f32_16x16x32_bf16 v[120:123], v[204:207], v[148:151], v[120:123]
    ds_read_b128 v[104:107], v11 offset:6144
    v_mfma_f32_16x16x32_bf16 v[120:123], v[200:203], v[144:147], v[120:123]
    ds_read_b128 v[108:111], v11 offset:7168
    v_mfma_f32_16x16x32_bf16 v[128:131], v[192:195], v[160:163], v[128:131]
    v_mfma_f32_16x16x32_bf16 v[128:131], v[196:199], v[164:167], v[128:131]
    v_mfma_f32_16x16x32_bf16 v[132:135], v[196:199], v[172:175], v[132:135]
    v_mfma_f32_16x16x32_bf16 v[132:135], v[192:195], v[168:171], v[132:135]
    v_mfma_f32_16x16x32_bf16 v[140:143], v[200:203], v[168:171], v[140:143]
    v_mfma_f32_16x16x32_bf16 v[140:143], v[204:207], v[172:175], v[140:143]
    v_mfma_f32_16x16x32_bf16 v[136:139], v[204:207], v[164:167], v[136:139]
    v_mfma_f32_16x16x32_bf16 v[136:139], v[200:203], v[160:163], v[136:139]
    s_waitcnt lgkmcnt(0)
    s_nop 4
    v_mfma_f32_32x32x16_bf16 v[112:127], v[6:9], v[82:85], v[112:127]
    v_mfma_f32_32x32x16_bf16 v[128:143], v[6:9], v[98:101], v[128:143]
    s_nop 4
    v_mul_f32 v12, 0xbe206c99, v88
    v_mul_f32 v13, 0xbe206c99, v88
    v_mul_f32 v14, 0xbe206c99, v92
    v_mul_f32 v15, 0xbe206c99, v92
    s_add_u32 s68, s14, 65536
    s_add_u32 s69, s68, 4096
    v_pk_mul_f32 v[112:113], v[112:113], v[12:13]
    v_pk_mul_f32 v[114:115], v[114:115], v[12:13]
    v_pk_mul_f32 v[116:117], v[116:117], v[14:15]
    v_pk_mul_f32 v[118:119], v[118:119], v[14:15]
    v_cvt_pk_bf16_f32 v112, v112, v113
    v_cvt_pk_bf16_f32 v113, v114, v115
    v_cvt_pk_bf16_f32 v114, v116, v117
    v_cvt_pk_bf16_f32 v115, v118, v119
    v_min_u32 v112, -2, v112
    v_min_u32 v114, -2, v114
    v_min_u32 v113, -2, v113
    v_min_u32 v115, -2, v115
    v_permlane16_swap_b32 v112, v114
    s_nop 0
    v_permlane16_swap_b32 v113, v115
    buffer_store_dwordx4 v[112:115], v208, s[52:55], s68 offen sc1
    v_pk_mul_f32 v[120:121], v[120:121], v[12:13]
    v_pk_mul_f32 v[122:123], v[122:123], v[12:13]
    v_pk_mul_f32 v[124:125], v[124:125], v[14:15]
    v_pk_mul_f32 v[126:127], v[126:127], v[14:15]
    v_cvt_pk_bf16_f32 v120, v120, v121
    v_cvt_pk_bf16_f32 v121, v122, v123
    v_cvt_pk_bf16_f32 v122, v124, v125
    v_cvt_pk_bf16_f32 v123, v126, v127
    v_min_u32 v120, -2, v120
    v_min_u32 v122, -2, v122
    v_min_u32 v121, -2, v121
    v_min_u32 v123, -2, v123
    v_permlane16_swap_b32 v120, v122
    s_nop 0
    v_permlane16_swap_b32 v121, v123
    buffer_store_dwordx4 v[120:123], v208, s[52:55], s69 offen sc1
    v_mul_f32 v12, 0xbe206c99, v104
    v_mul_f32 v13, 0xbe206c99, v104
    v_mul_f32 v14, 0xbe206c99, v108
    v_mul_f32 v15, 0xbe206c99, v108
    s_add_u32 s68, s14, 98304
    s_add_u32 s69, s68, 4096
    v_pk_mul_f32 v[128:129], v[128:129], v[12:13]
    v_pk_mul_f32 v[130:131], v[130:131], v[12:13]
    v_pk_mul_f32 v[132:133], v[132:133], v[14:15]
    v_pk_mul_f32 v[134:135], v[134:135], v[14:15]
    v_cvt_pk_bf16_f32 v128, v128, v129
    v_cvt_pk_bf16_f32 v129, v130, v131
    v_cvt_pk_bf16_f32 v130, v132, v133
    v_cvt_pk_bf16_f32 v131, v134, v135
    v_min_u32 v128, -2, v128
    v_min_u32 v130, -2, v130
    v_min_u32 v129, -2, v129
    v_min_u32 v131, -2, v131
    v_permlane16_swap_b32 v128, v130
    s_nop 0
    v_permlane16_swap_b32 v129, v131
    buffer_store_dwordx4 v[128:131], v208, s[52:55], s68 offen sc1
    v_pk_mul_f32 v[136:137], v[136:137], v[12:13]
    v_pk_mul_f32 v[138:139], v[138:139], v[12:13]
    v_pk_mul_f32 v[140:141], v[140:141], v[14:15]
    v_pk_mul_f32 v[142:143], v[142:143], v[14:15]
    v_cvt_pk_bf16_f32 v136, v136, v137
    v_cvt_pk_bf16_f32 v137, v138, v139
    v_cvt_pk_bf16_f32 v138, v140, v141
    v_cvt_pk_bf16_f32 v139, v142, v143
    v_min_u32 v136, -2, v136
    v_min_u32 v138, -2, v138
    v_min_u32 v137, -2, v137
    v_min_u32 v139, -2, v139
    v_permlane16_swap_b32 v136, v138
    s_nop 0
    v_permlane16_swap_b32 v137, v139
    buffer_store_dwordx4 v[136:139], v208, s[52:55], s69 offen sc1
    v_mfma_f32_32x32x16_bf16 v[16:31], v[2:5], v[218:221], v[16:31]
    v_mfma_f32_16x16x32_bf16 v[48:51], v[176:179], v[144:147], v[48:51]
    v_mfma_f32_16x16x32_bf16 v[48:51], v[180:183], v[148:151], v[48:51]
    v_mfma_f32_16x16x32_bf16 v[52:55], v[180:183], v[156:159], v[52:55]
    v_mfma_f32_16x16x32_bf16 v[52:55], v[176:179], v[152:155], v[52:55]
    v_mfma_f32_16x16x32_bf16 v[60:63], v[184:187], v[152:155], v[60:63]
    v_mfma_f32_16x16x32_bf16 v[60:63], v[188:191], v[156:159], v[60:63]
    v_mfma_f32_16x16x32_bf16 v[56:59], v[188:191], v[148:151], v[56:59]
    v_mfma_f32_16x16x32_bf16 v[56:59], v[184:187], v[144:147], v[56:59]
    v_mfma_f32_16x16x32_bf16 v[64:67], v[176:179], v[160:163], v[64:67]
    v_mfma_f32_16x16x32_bf16 v[64:67], v[180:183], v[164:167], v[64:67]
    v_mfma_f32_16x16x32_bf16 v[68:71], v[180:183], v[172:175], v[68:71]
    v_mfma_f32_16x16x32_bf16 v[68:71], v[176:179], v[168:171], v[68:71]
    v_mfma_f32_16x16x32_bf16 v[76:79], v[184:187], v[168:171], v[76:79]
    v_mfma_f32_16x16x32_bf16 v[76:79], v[188:191], v[172:175], v[76:79]
    v_mfma_f32_16x16x32_bf16 v[72:75], v[188:191], v[164:167], v[72:75]
    v_mfma_f32_16x16x32_bf16 v[72:75], v[184:187], v[160:163], v[72:75]
    s_mov_b32 s14, 16777216
    v_mov_b32 v12, -1
    v_mov_b32 v13, -1
    v_mov_b32 v14, -1
    v_mov_b32 v15, -1
.p2align 3
    v_pk_mul_f32 v[144:145], v[16:17], v[16:17]
    v_pk_mul_f32 v[146:147], v[18:19], v[18:19]
    v_pk_mul_f32 v[148:149], v[20:21], v[20:21]
    v_pk_mul_f32 v[150:151], v[22:23], v[22:23]
    v_pk_fma_f32 v[144:145], v[144:145], v[226:227], v[224:225]
    v_pk_fma_f32 v[146:147], v[146:147], v[226:227], v[224:225]
    v_pk_fma_f32 v[148:149], v[148:149], v[230:231], v[228:229]
    v_pk_fma_f32 v[150:151], v[150:151], v[230:231], v[228:229]
    v_pk_mul_f32 v[144:145], v[144:145], v[16:17]
    v_pk_mul_f32 v[146:147], v[146:147], v[18:19]
    v_pk_mul_f32 v[148:149], v[148:149], v[20:21]
    v_pk_mul_f32 v[150:151], v[150:151], v[22:23]
    v_mfma_f32_32x32x16_bf16 v[32:47], v[2:5], v[234:237], v[32:47]
    v_exp_f32 v144, v144
    v_exp_f32 v145, v145
    v_exp_f32 v146, v146
    v_exp_f32 v147, v147
    v_exp_f32 v148, v148
    v_exp_f32 v149, v149
    v_exp_f32 v150, v150
    v_exp_f32 v151, v151
    v_pk_mul_f32 v[152:153], v[16:17], v[24:25]
    v_pk_mul_f32 v[154:155], v[18:19], v[26:27]
    v_pk_mul_f32 v[156:157], v[20:21], v[28:29]
    v_pk_mul_f32 v[158:159], v[22:23], v[30:31]
    v_pk_fma_f32 v[144:145], v[144:145], v[216:217], v[216:217]
    v_pk_fma_f32 v[146:147], v[146:147], v[216:217], v[216:217]
    v_pk_fma_f32 v[148:149], v[148:149], v[222:223], v[222:223]
    v_pk_fma_f32 v[150:151], v[150:151], v[222:223], v[222:223]
    v_rcp_f32 v144, v144
    v_rcp_f32 v145, v145
    v_rcp_f32 v146, v146
    v_rcp_f32 v147, v147
    v_rcp_f32 v148, v148
    v_rcp_f32 v149, v149
    v_rcp_f32 v150, v150
    v_rcp_f32 v151, v151
    v_pk_mul_f32 v[152:153], v[152:153], v[144:145]
    v_pk_mul_f32 v[154:155], v[154:155], v[146:147]
    v_pk_mul_f32 v[156:157], v[156:157], v[148:149]
    v_pk_mul_f32 v[158:159], v[158:159], v[150:151]
    v_cvt_pk_bf16_f32 v160, v152, v153
    v_cvt_pk_bf16_f32 v161, v154, v155
    v_cvt_pk_bf16_f32 v162, v156, v157
    v_cvt_pk_bf16_f32 v163, v158, v159
    s_branch L_pg46
.p2align 12
L_stub46:
    s_nop 0
    s_setpc_b64 s[0:1]
L_pg46:
.p2align 3
    v_pk_mul_f32 v[144:145], v[32:33], v[32:33]
    v_pk_mul_f32 v[146:147], v[34:35], v[34:35]
    v_pk_mul_f32 v[148:149], v[36:37], v[36:37]
    v_pk_mul_f32 v[150:151], v[38:39], v[38:39]
    v_permlane16_swap_b32 v160, v162
    v_permlane16_swap_b32 v161, v163
    v_pk_fma_f32 v[144:145], v[144:145], v[242:243], v[240:241]
    v_pk_fma_f32 v[146:147], v[146:147], v[242:243], v[240:241]
    v_pk_fma_f32 v[148:149], v[148:149], v[246:247], v[244:245]
    v_pk_fma_f32 v[150:151], v[150:151], v[246:247], v[244:245]
    v_pk_mul_f32 v[144:145], v[144:145], v[32:33]
    v_pk_mul_f32 v[146:147], v[146:147], v[34:35]
    v_pk_mul_f32 v[148:149], v[148:149], v[36:37]
    v_pk_mul_f32 v[150:151], v[150:151], v[38:39]
    v_mfma_f32_32x32x16_bf16 v[48:63], v[2:5], v[82:85], v[48:63]
    v_exp_f32 v144, v144
    v_exp_f32 v145, v145
    v_exp_f32 v146, v146
    v_exp_f32 v147, v147
    v_exp_f32 v148, v148
    v_exp_f32 v149, v149
    v_exp_f32 v150, v150
    v_exp_f32 v151, v151
    v_pk_mul_f32 v[152:153], v[32:33], v[40:41]
    v_pk_mul_f32 v[154:155], v[34:35], v[42:43]
    v_pk_mul_f32 v[156:157], v[36:37], v[44:45]
    v_pk_mul_f32 v[158:159], v[38:39], v[46:47]
    v_pk_fma_f32 v[144:145], v[144:145], v[232:233], v[232:233]
    v_pk_fma_f32 v[146:147], v[146:147], v[232:233], v[232:233]
    v_pk_fma_f32 v[148:149], v[148:149], v[238:239], v[238:239]
    v_pk_fma_f32 v[150:151], v[150:151], v[238:239], v[238:239]
    v_rcp_f32 v144, v144
    v_rcp_f32 v145, v145
    v_rcp_f32 v146, v146
    v_rcp_f32 v147, v147
    v_rcp_f32 v148, v148
    v_rcp_f32 v149, v149
    v_rcp_f32 v150, v150
    v_rcp_f32 v151, v151
    v_pk_mul_f32 v[152:153], v[152:153], v[144:145]
    v_pk_mul_f32 v[154:155], v[154:155], v[146:147]
    v_pk_mul_f32 v[156:157], v[156:157], v[148:149]
    v_pk_mul_f32 v[158:159], v[158:159], v[150:151]
    v_cvt_pk_bf16_f32 v164, v152, v153
    v_cvt_pk_bf16_f32 v165, v154, v155
    v_cvt_pk_bf16_f32 v166, v156, v157
    v_cvt_pk_bf16_f32 v167, v158, v159
    s_barrier
.p2align 3
    v_pk_mul_f32 v[144:145], v[48:49], v[48:49]
    v_pk_mul_f32 v[146:147], v[50:51], v[50:51]
    v_pk_mul_f32 v[148:149], v[52:53], v[52:53]
    v_pk_mul_f32 v[150:151], v[54:55], v[54:55]
    v_permlane16_swap_b32 v164, v166
    v_permlane16_swap_b32 v165, v167
    v_pk_fma_f32 v[144:145], v[144:145], v[90:91], v[88:89]
    v_pk_fma_f32 v[146:147], v[146:147], v[90:91], v[88:89]
    v_pk_fma_f32 v[148:149], v[148:149], v[94:95], v[92:93]
    v_pk_fma_f32 v[150:151], v[150:151], v[94:95], v[92:93]
    v_pk_mul_f32 v[144:145], v[144:145], v[48:49]
    v_pk_mul_f32 v[146:147], v[146:147], v[50:51]
    v_pk_mul_f32 v[148:149], v[148:149], v[52:53]
    v_pk_mul_f32 v[150:151], v[150:151], v[54:55]
    v_mfma_f32_32x32x16_bf16 v[64:79], v[2:5], v[98:101], v[64:79]
    v_exp_f32 v144, v144
    v_exp_f32 v145, v145
    v_exp_f32 v146, v146
    v_exp_f32 v147, v147
    v_exp_f32 v148, v148
    v_exp_f32 v149, v149
    v_exp_f32 v150, v150
    v_exp_f32 v151, v151
    v_pk_mul_f32 v[152:153], v[48:49], v[56:57]
    v_pk_mul_f32 v[154:155], v[50:51], v[58:59]
    v_pk_mul_f32 v[156:157], v[52:53], v[60:61]
    v_pk_mul_f32 v[158:159], v[54:55], v[62:63]
    v_pk_fma_f32 v[144:145], v[144:145], v[80:81], v[80:81]
    v_pk_fma_f32 v[146:147], v[146:147], v[80:81], v[80:81]
    v_pk_fma_f32 v[148:149], v[148:149], v[86:87], v[86:87]
    v_pk_fma_f32 v[150:151], v[150:151], v[86:87], v[86:87]
    v_rcp_f32 v144, v144
    v_rcp_f32 v145, v145
    v_rcp_f32 v146, v146
    v_rcp_f32 v147, v147
    v_rcp_f32 v148, v148
    v_rcp_f32 v149, v149
    v_rcp_f32 v150, v150
    v_rcp_f32 v151, v151
    v_pk_mul_f32 v[152:153], v[152:153], v[144:145]
    v_pk_mul_f32 v[154:155], v[154:155], v[146:147]
    v_pk_mul_f32 v[156:157], v[156:157], v[148:149]
    v_pk_mul_f32 v[158:159], v[158:159], v[150:151]
    v_cvt_pk_bf16_f32 v168, v152, v153
    v_cvt_pk_bf16_f32 v169, v154, v155
    v_cvt_pk_bf16_f32 v170, v156, v157
    v_cvt_pk_bf16_f32 v171, v158, v159
.p2align 3
    v_pk_mul_f32 v[144:145], v[64:65], v[64:65]
    v_pk_mul_f32 v[146:147], v[66:67], v[66:67]
    v_pk_mul_f32 v[148:149], v[68:69], v[68:69]
    v_pk_mul_f32 v[150:151], v[70:71], v[70:71]
    v_permlane16_swap_b32 v168, v170
    v_permlane16_swap_b32 v169, v171
    v_pk_fma_f32 v[144:145], v[144:145], v[106:107], v[104:105]
    v_pk_fma_f32 v[146:147], v[146:147], v[106:107], v[104:105]
    v_pk_fma_f32 v[148:149], v[148:149], v[110:111], v[108:109]
    v_pk_fma_f32 v[150:151], v[150:151], v[110:111], v[108:109]
    v_pk_mul_f32 v[144:145], v[144:145], v[64:65]
    v_pk_mul_f32 v[146:147], v[146:147], v[66:67]
    v_pk_mul_f32 v[148:149], v[148:149], v[68:69]
    v_pk_mul_f32 v[150:151], v[150:151], v[70:71]
    v_exp_f32 v144, v144
    v_exp_f32 v145, v145
    v_exp_f32 v146, v146
    v_exp_f32 v147, v147
    v_exp_f32 v148, v148
    v_exp_f32 v149, v149
    v_exp_f32 v150, v150
    v_exp_f32 v151, v151
    v_pk_mul_f32 v[152:153], v[64:65], v[72:73]
    v_pk_mul_f32 v[154:155], v[66:67], v[74:75]
    v_pk_mul_f32 v[156:157], v[68:69], v[76:77]
    v_pk_mul_f32 v[158:159], v[70:71], v[78:79]
    v_pk_fma_f32 v[144:145], v[144:145], v[96:97], v[96:97]
    v_pk_fma_f32 v[146:147], v[146:147], v[96:97], v[96:97]
    v_pk_fma_f32 v[148:149], v[148:149], v[102:103], v[102:103]
    v_pk_fma_f32 v[150:151], v[150:151], v[102:103], v[102:103]
    v_rcp_f32 v144, v144
    v_rcp_f32 v145, v145
    v_rcp_f32 v146, v146
    v_rcp_f32 v147, v147
    v_rcp_f32 v148, v148
    v_rcp_f32 v149, v149
    v_rcp_f32 v150, v150
    v_rcp_f32 v151, v151
    v_pk_mul_f32 v[152:153], v[152:153], v[144:145]
    v_pk_mul_f32 v[154:155], v[154:155], v[146:147]
    v_pk_mul_f32 v[156:157], v[156:157], v[148:149]
    v_pk_mul_f32 v[158:159], v[158:159], v[150:151]
    v_cvt_pk_bf16_f32 v172, v152, v153
    v_cvt_pk_bf16_f32 v173, v154, v155
    v_cvt_pk_bf16_f32 v174, v156, v157
    v_cvt_pk_bf16_f32 v175, v158, v159
    s_nop 1
    v_permlane16_swap_b32 v172, v174
    v_permlane16_swap_b32 v173, v175
L_joinA:
    v_and_b32 v5, 27, v1
    v_cmp_eq_u32 vcc, 16, v5
    v_mov_b32 v6, 0x47804780
    v_mov_b32 v124, 0xdddddddd
    v_mov_b32 v11, 1
    v_cndmask_b32 v108, 0, v6, vcc
    v_mov_b32 v109, v108
    v_mov_b64 v[110:111], v[108:109]
    v_mov_b64 v[112:113], v[108:109]
    v_mov_b64 v[114:115], v[108:109]
    v_mov_b64 v[116:117], v[108:109]
    v_mov_b64 v[118:119], v[108:109]
    v_mov_b64 v[120:121], v[108:109]
    v_mov_b64 v[122:123], v[108:109]
    v_mov_b64 v[64:65], 0
    v_mov_b64 v[66:67], 0
    v_mov_b64 v[68:69], 0
    v_mov_b64 v[70:71], 0
    v_mov_b64 v[72:73], 0
    v_mov_b64 v[74:75], 0
    v_mov_b64 v[76:77], 0
    v_mov_b64 v[78:79], 0
    v_mov_b64 v[224:225], 0
    v_mov_b64 v[226:227], 0
    v_mov_b64 v[228:229], 0
    v_mov_b64 v[230:231], 0
    v_mov_b64 v[232:233], 0
    v_mov_b64 v[234:235], 0
    v_mov_b64 v[236:237], 0
    v_mov_b64 v[238:239], 0
    s_lshl_b32 s68, s66, 11
    v_add_u32 v125, s68, v208
    s_lshl_b32 s68, s75, 13
    s_add_u32 s68, s68, 32768
    v_add_u32 v126, s68, v212
    v_xor_b32 v127, 64, v126
    ds_read_b128 v[100:103], v209 offset:16384
    s_mov_b64 exec, s[62:63]
    ds_read_b128 v[108:111], v211 offset:16384
    ds_read_b128 v[112:115], v211 offset:16896
    s_mov_b64 exec, -1
    s_barrier
    ds_read_b128 v[220:223], v254 offset:49152
    ds_read_b128 v[80:83], v254 offset:50176
    ds_read_b128 v[84:87], v254 offset:50176
    ds_read_b128 v[88:91], v254 offset:50176
    ds_read_b128 v[92:95], v254 offset:50176
    ds_read_b128 v[96:99], v254 offset:57344
    ds_read_b128 v[48:51], v254 offset:58368
    ds_read_b128 v[52:55], v254 offset:58368
    ds_read_b128 v[56:59], v254 offset:58368
    ds_read_b128 v[60:63], v254 offset:58368
    s_waitcnt lgkmcnt(5)
    v_mfma_f32_32x32x16_bf16 v[16:31], v[100:103], v[220:223], v[80:95]
    s_nop 3
    s_nop 3
    s_branch L_attA
L_csld:
    s_and_b32 s88, s57, 3
    s_lshr_b32 s68, s58, 2
    s_and_b32 s69, s58, 3
    s_mul_i32 s65, s68, 896
    s_lshl_b32 s70, s69, 8
    s_add_u32 s65, s65, s70
    s_lshr_b32 s70, s88, 1
    s_lshl_b32 s69, s69, 1
    s_add_u32 s69, s69, s70
    s_lshl_b32 s70, s70, 7
    s_add_u32 s65, s65, s70
    s_lshl_b32 s68, s68, 1
    s_and_b32 s70, s88, 1
    s_add_u32 s68, s68, s70
    s_lshl_b32 s68, s68, 7
    s_movk_i32 s89, 3584
    s_cmp_eq_u32 s69, 7
    s_cselect_b32 s65, s68, s65
    s_cselect_b32 s89, 1024, s89
    s_and_b32 s68, s57, 4
    s_and_b32 s71, s57, 8
    s_lshl_b32 s71, s71, 2
    s_add_u32 s68, s68, s71
    s_lshl_b32 s68, s68, 3
    s_mul_i32 s68, s68, s89
    s_add_u32 s65, s68, s65
    v_mul_u32_u24 v8, s89, v7
    v_lshl_add_u32 v219, v4, 4, v8
    s_waitcnt lgkmcnt(0)
    s_mov_b32 s28, s4
    s_and_b32 s29, s5, 0xffff
    s_cmp_eq_u32 s70, 0
    s_cselect_b32 s96, s16, s18
    s_cselect_b32 s97, s17, s19
    s_cmp_eq_u32 s69, 7
    s_cselect_b32 s96, s6, s96
    s_cselect_b32 s97, s7, s97
    s_and_b32 s97, s97, 0xffff
    s_lshl_b32 s98, s89, 9
    s_mov_b32 s99, 0x20000
    s_lshl_b32 s89, s89, 3
    s_add_u32 s68, s66, -1
    s_and_b32 s69, s68, 28
    s_add_u32 s69, s69, s68
    s_mul_i32 s69, s69, s89
    s_add_u32 s69, s69, s65
    buffer_load_dwordx4 v[16:19], v219, s[96:99], s69 offen
    s_add_u32 s68, s66, 2
    s_and_b32 s69, s68, 28
    s_add_u32 s69, s69, s68
    s_mul_i32 s69, s69, s89
    s_add_u32 s69, s69, s65
    buffer_load_dwordx4 v[20:23], v219, s[96:99], s69 offen
    s_add_u32 s68, s66, 5
    s_and_b32 s69, s68, 28
    s_add_u32 s69, s69, s68
    s_mul_i32 s69, s69, s89
    s_add_u32 s69, s69, s65
    buffer_load_dwordx4 v[24:27], v219, s[96:99], s69 offen
    s_add_u32 s68, s66, 8
    s_and_b32 s69, s68, 28
    s_add_u32 s69, s69, s68
    s_mul_i32 s69, s69, s89
    s_add_u32 s69, s69, s65
    buffer_load_dwordx4 v[28:31], v219, s[96:99], s69 offen
    s_add_u32 s68, s66, 11
    s_and_b32 s69, s68, 28
    s_add_u32 s69, s69, s68
    s_mul_i32 s69, s69, s89
    s_add_u32 s69, s69, s65
    buffer_load_dwordx4 v[32:35], v219, s[96:99], s69 offen
    s_add_u32 s68, s66, 14
    s_and_b32 s69, s68, 28
    s_add_u32 s69, s69, s68
    s_mul_i32 s69, s69, s89
    s_add_u32 s69, s69, s65
    s_cmp_gt_u32 s68, 15
    s_cselect_b32 s69, s98, s69
    buffer_load_dwordx4 v[36:39], v219, s[96:99], s69 offen
    s_barrier
    s_branch L_ld_done
L_helper:
    s_lshl_b32 s64, s57, 17
    s_lshl_b32 s68, s66, 15
    s_add_u32 s64, s64, s68
    v_and_b32 v5, 15, v1
    v_lshrrev_b32 v6, 4, v1
    v_lshrrev_b32 v7, 3, v1
    v_and_b32 v63, 7, v1
    v_xor_b32 v62, v6, v63
    v_lshlrev_b32 v62, 4, v62
    v_lshl_add_u32 v192, v7, 10, v62
    v_xor_b32 v193, 64, v192
    v_add_u32 v193, 7168, v193
    s_lshr_b32 s68, s58, 2
    s_and_b32 s69, s58, 3
    s_mul_i32 s65, s68, 896
    s_lshl_b32 s70, s69, 8
    s_add_u32 s65, s65, s70
    s_lshr_b32 s70, s66, 1
    s_lshl_b32 s69, s69, 1
    s_add_u32 s69, s69, s70
    s_lshl_b32 s70, s70, 7
    s_add_u32 s65, s65, s70
    s_lshl_b32 s68, s68, 1
    s_and_b32 s70, s66, 1
    s_add_u32 s68, s68, s70
    s_lshl_b32 s68, s68, 7
    s_movk_i32 s89, 3584
    s_cmp_eq_u32 s69, 7
    s_cselect_b32 s65, s68, s65
    s_cselect_b32 s89, 1024, s89
    v_and_b32 v62, 1, v6
    v_lshlrev_b32 v62, 1, v62
    v_xor_b32 v62, v62, v63
    v_lshlrev_b32 v62, 4, v62
    v_mul_u32_u24 v194, s89, v7
    v_add_u32 v194, v194, v62
    v_xor_b32 v195, 64, v194
    s_waitcnt lgkmcnt(0)
    s_mov_b32 s28, s4
    s_and_b32 s29, s5, 0xffff
    s_cmp_eq_u32 s70, 0
    s_cselect_b32 s92, s16, s18
    s_cselect_b32 s93, s17, s19
    s_cmp_eq_u32 s69, 7
    s_cselect_b32 s92, s6, s92
    s_cselect_b32 s93, s7, s93
    s_and_b32 s93, s93, 0xffff
    s_lshl_b32 s94, s89, 9
    s_mov_b32 s95, 0x20000
    s_and_b32 s74, s57, 8
    s_lshl_b32 s68, s74, 6
    s_add_u32 s64, s64, s68
    s_mul_i32 s68, s68, s89
    s_lshr_b32 s68, s68, 1
    s_add_u32 s65, s65, s68
    s_lshl_b32 s89, s89, 3
    s_mul_i32 s15, s66, 24576
    s_add_u32 s15, s15, 49152
    s_mov_b32 s52, s26
    s_and_b32 s53, s27, 0xffff
    s_mov_b32 s54, 0x1000000
    s_mov_b32 s55, 0x20000
    s_lshr_b32 s75, s56, 1
    s_and_b32 s76, s56, 1
    s_lshl_b32 s70, s59, 1
    s_add_u32 s70, s70, s76
    s_lshl_b32 s68, s70, 3
    s_add_u32 s68, s68, s60
    s_lshl_b32 s68, s68, 2
    s_add_u32 s68, s68, s75
    s_lshl_b32 s68, s68, 10
    s_add_u32 s72, s68, 1048576
    s_lshl_b32 s68, s2, 7
    s_lshl_b32 s69, s56, 2
    s_add_u32 s68, s68, s69
    s_add_u32 s73, s68, 163840
    v_mov_b32 v12, -1
    v_mov_b32 v13, -1
    v_mov_b32 v14, -1
    v_mov_b32 v15, -1
    v_mov_b32 v10, 0
    v_mov_b32 v11, 1
    s_sub_u32 s71, s73, 16
    s_mov_b64 exec, 7
    buffer_store_dword v10, v208, s[52:55], s71 offen sc1
    s_mov_b64 exec, -1
    s_barrier
    s_add_u32 m0, s3, 32768
    s_add_u32 s88, s64, 0
    buffer_load_dwordx4 v192, s[28:31], s88 offen offset:0  lds
    s_add_u32 m0, s3, 32768
    s_add_u32 s88, s64, 0
    buffer_load_dwordx4 v193, s[28:31], s88 offen offset:1024  lds
    s_add_u32 m0, s3, 32768
    s_add_u32 s88, s64, 14336
    buffer_load_dwordx4 v192, s[28:31], s88 offen offset:2048  lds
    s_add_u32 m0, s3, 32768
    s_add_u32 s88, s64, 14336
    buffer_load_dwordx4 v193, s[28:31], s88 offen offset:3072  lds
    s_add_u32 m0, s15, 16384
    s_nop 0
    buffer_load_dwordx4 v194, s[92:95], s65 offen  lds
    s_add_u32 m0, s15, 17408
    s_add_u32 s65, s65, s89
    buffer_load_dwordx4 v195, s[92:95], s65 offen  lds
    s_add_u32 m0, s15, 18432
    s_add_u32 s65, s65, s89
    buffer_load_dwordx4 v194, s[92:95], s65 offen  lds
    s_add_u32 m0, s15, 19456
    s_add_u32 s65, s65, s89
    buffer_load_dwordx4 v195, s[92:95], s65 offen  lds
    s_add_u32 m0, s15, 20480
    s_add_u32 s65, s65, s89
    buffer_load_dwordx4 v194, s[92:95], s65 offen  lds
    s_add_u32 m0, s15, 21504
    s_add_u32 s65, s65, s89
    buffer_load_dwordx4 v195, s[92:95], s65 offen  lds
    s_add_u32 m0, s15, 22528
    s_add_u32 s65, s65, s89
    buffer_load_dwordx4 v194, s[92:95], s65 offen  lds
    s_add_u32 m0, s15, 23552
    s_add_u32 s65, s65, s89
    buffer_load_dwordx4 v195, s[92:95], s65 offen  lds
    s_add_u32 m0, s15, 0
    s_add_u32 s65, s65, s89
    buffer_load_dwordx4 v194, s[92:95], s65 offen  lds
    s_add_u32 m0, s15, 1024
    s_add_u32 s65, s65, s89
    buffer_load_dwordx4 v195, s[92:95], s65 offen  lds
    s_add_u32 m0, s15, 2048
    s_add_u32 s65, s65, s89
    buffer_load_dwordx4 v194, s[92:95], s65 offen  lds
    s_add_u32 m0, s15, 3072
    s_add_u32 s65, s65, s89
    buffer_load_dwordx4 v195, s[92:95], s65 offen  lds
    s_add_u32 m0, s15, 4096
    s_add_u32 s65, s65, s89
    buffer_load_dwordx4 v194, s[92:95], s65 offen  lds
    s_add_u32 m0, s15, 5120
    s_add_u32 s65, s65, s89
    buffer_load_dwordx4 v195, s[92:95], s65 offen  lds
    s_add_u32 m0, s15, 6144
    s_add_u32 s65, s65, s89
    buffer_load_dwordx4 v194, s[92:95], s65 offen  lds
    s_add_u32 m0, s15, 7168
    s_add_u32 s65, s65, s89
    buffer_load_dwordx4 v195, s[92:95], s65 offen  lds
    s_add_u32 m0, s3, 0
    s_add_u32 s88, s64, 128
    buffer_load_dwordx4 v192, s[28:31], s88 offen offset:0  lds
    s_add_u32 m0, s3, 0
    s_add_u32 s88, s64, 128
    buffer_load_dwordx4 v193, s[28:31], s88 offen offset:1024  lds
    s_waitcnt vmcnt(10)
    s_barrier
    s_add_u32 m0, s3, 0
    s_add_u32 s88, s64, 14464
    buffer_load_dwordx4 v192, s[28:31], s88 offen offset:2048  lds
    s_add_u32 m0, s3, 0
    s_add_u32 s88, s64, 14464
    buffer_load_dwordx4 v193, s[28:31], s88 offen offset:3072  lds
    s_add_u32 m0, s15, 8192
    s_add_u32 s65, s65, s89
    buffer_load_dwordx4 v194, s[92:95], s65 offen  lds
    s_add_u32 m0, s15, 9216
    s_add_u32 s65, s65, s89
    buffer_load_dwordx4 v195, s[92:95], s65 offen  lds
    s_add_u32 m0, s15, 10240
    s_add_u32 s65, s65, s89
    buffer_load_dwordx4 v194, s[92:95], s65 offen  lds
    s_add_u32 m0, s15, 11264
    s_add_u32 s65, s65, s89
    buffer_load_dwordx4 v195, s[92:95], s65 offen  lds
    s_add_u32 m0, s15, 12288
    s_add_u32 s65, s65, s89
    buffer_load_dwordx4 v194, s[92:95], s65 offen  lds
    s_add_u32 m0, s15, 13312
    s_add_u32 s65, s65, s89
    buffer_load_dwordx4 v195, s[92:95], s65 offen  lds
    s_add_u32 m0, s15, 14336
    s_add_u32 s65, s65, s89
    buffer_load_dwordx4 v194, s[92:95], s65 offen  lds
    s_add_u32 m0, s15, 15360
    s_add_u32 s65, s65, s89
    buffer_load_dwordx4 v195, s[92:95], s65 offen  lds
    s_waitcnt vmcnt(8)
    s_barrier
    s_add_u32 m0, s3, 16384
    s_add_u32 s88, s64, 256
    buffer_load_dwordx4 v192, s[28:31], s88 offen offset:0  lds
    s_add_u32 m0, s3, 16384
    s_add_u32 s88, s64, 256
    buffer_load_dwordx4 v193, s[28:31], s88 offen offset:1024  lds
    s_add_u32 m0, s3, 16384
    s_add_u32 s88, s64, 14592
    buffer_load_dwordx4 v192, s[28:31], s88 offen offset:2048  lds
    s_add_u32 m0, s3, 16384
    s_add_u32 s88, s64, 14592
    buffer_load_dwordx4 v193, s[28:31], s88 offen offset:3072  lds
    s_add_u32 m0, s15, 16384
    s_add_u32 s65, s65, s89
    buffer_load_dwordx4 v194, s[92:95], s65 offen  lds
    s_add_u32 m0, s15, 17408
    s_add_u32 s65, s65, s89
    buffer_load_dwordx4 v195, s[92:95], s65 offen  lds
    s_add_u32 m0, s15, 18432
    s_add_u32 s65, s65, s89
    buffer_load_dwordx4 v194, s[92:95], s65 offen  lds
    s_add_u32 m0, s15, 19456
    s_add_u32 s65, s65, s89
    buffer_load_dwordx4 v195, s[92:95], s65 offen  lds
    s_add_u32 m0, s15, 20480
    s_add_u32 s65, s65, s89
    buffer_load_dwordx4 v194, s[92:95], s65 offen  lds
    s_add_u32 m0, s15, 21504
    s_add_u32 s65, s65, s89
    buffer_load_dwordx4 v195, s[92:95], s65 offen  lds
    s_add_u32 m0, s15, 22528
    s_add_u32 s65, s65, s89
    buffer_load_dwordx4 v194, s[92:95], s65 offen  lds
    s_add_u32 m0, s15, 23552
    s_add_u32 s65, s65, s89
    buffer_load_dwordx4 v195, s[92:95], s65 offen  lds
    s_add_u32 m0, s3, 32768
    s_add_u32 s88, s64, 384
    buffer_load_dwordx4 v192, s[28:31], s88 offen offset:0  lds
    s_add_u32 m0, s3, 32768
    s_add_u32 s88, s64, 384
    buffer_load_dwordx4 v193, s[28:31], s88 offen offset:1024  lds
    s_waitcnt vmcnt(46)
    s_waitcnt vmcnt(10)
    s_barrier
    s_cmp_lg_u32 s66, 0
    s_cbranch_scc1 L_noarr
    s_and_b32 s84, s2, 7
    s_lshl_b32 s84, s84, 5
    s_mov_b32 s85, 1
    s_atomic_add s85, s[24:25], s84
L_noarr:
    s_add_u32 m0, s3, 32768
    s_add_u32 s88, s64, 14720
    buffer_load_dwordx4 v192, s[28:31], s88 offen offset:2048  lds
    s_mov_b32 s48, s24
    s_and_b32 s49, s25, 0xffff
    s_mov_b32 s50, 0x100
    s_mov_b32 s51, 0x20000
    s_mov_b32 s67, 0x3f803f80
    s_add_u32 m0, s3, 32768
    s_add_u32 s88, s64, 14720
    buffer_load_dwordx4 v193, s[28:31], s88 offen offset:3072  lds
    s_mov_b32 s36, s20
    s_and_b32 s37, s21, 0xffff
    s_mov_b32 s38, 0x1c0000
    s_mov_b32 s39, 0x20000
    s_mov_b32 s40, s12
    s_add_u32 m0, s15, 0
    s_add_u32 s65, s65, s89
    s_cmp_eq_u32 s74, 8
    s_cselect_b32 s88, s94, 0
    s_cselect_b32 s14, 1024, 0
    s_sub_u32 s65, s65, s88
    s_sub_u32 s64, s64, s14
    buffer_load_dwordx4 v194, s[92:95], s65 offen  lds
    s_and_b32 s41, s13, 0xffff
    s_mov_b32 s42, 0x80000
    s_mov_b32 s43, 0x20000
    s_mov_b32 s44, s22
    s_add_u32 m0, s15, 1024
    s_add_u32 s65, s65, s89
    buffer_load_dwordx4 v195, s[92:95], s65 offen  lds
    s_and_b32 s45, s23, 0xffff
    s_mov_b32 s46, 0x200000
    s_mov_b32 s47, 0x20000
    s_lshl_b32 s79, s56, 12
    s_lshl_b32 s80, s56, 11
    s_add_u32 m0, s15, 2048
    s_add_u32 s65, s65, s89
    buffer_load_dwordx4 v194, s[92:95], s65 offen  lds
    s_mov_b32 s62, 0xffff
    s_mov_b32 s63, 0xffff
    s_lshl_b32 s70, s59, 1
    s_add_u32 s70, s70, s76
    s_add_u32 m0, s15, 3072
    s_add_u32 s65, s65, s89
    buffer_load_dwordx4 v195, s[92:95], s65 offen  lds
    s_mul_i32 s68, s75, 458752
    s_lshl_b32 s69, s76, 15
    s_add_u32 s68, s68, s69
    s_lshl_b32 s69, s60, 7
    s_add_u32 s77, s68, s69
    s_add_u32 m0, s15, 4096
    s_add_u32 s65, s65, s89
    buffer_load_dwordx4 v194, s[92:95], s65 offen  lds
    s_lshl_b32 s68, s56, 15
    s_add_u32 s82, s68, s69
    s_and_b32 s68, s60, 0
    s_lshl_b32 s61, s68, 18
    s_add_u32 m0, s15, 5120
    s_add_u32 s65, s65, s89
    buffer_load_dwordx4 v195, s[92:95], s65 offen  lds
    s_add_u32 s82, s82, s61
    s_mul_i32 s68, s70, 112
    s_mul_i32 s71, s75, 28
    s_add_u32 s68, s68, s71
    s_lshl_b32 s68, s68, 10
    s_add_u32 m0, s15, 6144
    s_add_u32 s65, s65, s89
    buffer_load_dwordx4 v194, s[92:95], s65 offen  lds
    s_add_u32 s78, s68, 4194304
    s_lshl_b32 s68, s70, 15
    s_lshl_b32 s71, s75, 13
    s_add_u32 s71, s68, s71
    s_lshr_b32 s68, s61, 4
    s_add_u32 m0, s15, 7168
    s_add_u32 s65, s65, s89
    buffer_load_dwordx4 v195, s[92:95], s65 offen  lds
    s_xor_b32 s83, s71, s68
    s_add_u32 s83, s83, 1048576
    s_add_u32 s68, s71, s69
    v_lshrrev_b32 v3, 5, v1
    s_add_u32 m0, s3, 0
    s_add_u32 s88, s64, 512
    buffer_load_dwordx4 v192, s[28:31], s88 offen offset:0  lds
    v_bfe_u32 v5, v1, 3, 1
    v_lshl_add_u32 v2, v3, 1, v5
    v_bfe_u32 v7, v1, 4, 1
    v_lshl_add_u32 v4, v7, 2, v2
    v_and_b32 v6, 7, v1
    s_add_u32 m0, s3, 0
    s_add_u32 s88, s64, 512
    buffer_load_dwordx4 v193, s[28:31], s88 offen offset:1024  lds
    v_lshlrev_b32 v8, 4, v6
    v_lshl_add_u32 v4, v4, 10, v8
    v_add_u32 v215, s68, v4
    v_lshlrev_b32 v2, 8, v2
    s_add_u32 m0, s3, 0
    s_add_u32 s88, s64, 14848
    buffer_load_dwordx4 v192, s[28:31], s88 offen offset:2048  lds
    v_lshl_add_u32 v2, v7, 7, v2
    v_lshl_add_u32 v2, v5, 4, v2
    v_and_b32 v4, 3, v6
    v_lshl_add_u32 v2, v4, 5, v2
    v_lshrrev_b32 v4, 2, v6
    s_add_u32 m0, s3, 0
    s_add_u32 s88, s64, 14848
    buffer_load_dwordx4 v193, s[28:31], s88 offen offset:3072  lds
    v_lshl_add_u32 v2, v4, 12, v2
    s_lshl_b32 s68, s76, 13
    s_lshl_b32 s69, s75, 10
    s_add_u32 s68, s68, s69
    s_add_u32 s88, s72, 13629440
    buffer_store_dwordx4 v[12:15], v208, s[52:55], s88 offen sc1
    buffer_store_dwordx4 v[12:15], v208, s[52:55], s88 offen offset:2048 sc1
    s_waitcnt vmcnt(14)
    s_branch L_pg52
.p2align 12
L_stub52:
    s_nop 0
    s_setpc_b64 s[0:1]
L_pg52:
    s_barrier
    s_add_u32 m0, s15, 8192
    s_add_u32 s65, s65, s89
    buffer_load_dwordx4 v194, s[92:95], s65 offen  lds
    v_add_u32 v0, s68, v2
    v_add_u32 v209, 0, v208
    v_and_b32 v2, 15, v1
    v_lshl_add_u32 v2, v3, 4, v2
    v_lshlrev_b32 v2, 4, v2
    v_add_u32 v211, 1024, v2
    v_lshrrev_b32 v5, 3, v1
    v_and_b32 v6, 7, v1
    s_add_u32 m0, s15, 9216
    s_add_u32 s65, s65, s89
    buffer_load_dwordx4 v195, s[92:95], s65 offen  lds
    v_bfe_u32 v7, v1, 4, 1
    v_lshlrev_b32 v8, 2, v7
    v_xor_b32 v6, v6, v8
    v_lshlrev_b32 v6, 4, v6
    v_lshl_add_u32 v210, v5, 10, v6
    v_and_b32 v2, 1, v1
    v_bfe_u32 v4, v1, 1, 1
    s_add_u32 m0, s15, 10240
    s_add_u32 s65, s65, s89
    buffer_load_dwordx4 v194, s[92:95], s65 offen  lds
    v_lshl_add_u32 v2, v2, 1, v4
    v_bfe_u32 v5, v1, 2, 2
    v_lshl_add_u32 v4, v3, 3, v5
    v_lshlrev_b32 v4, 7, v4
    v_and_b32 v6, 2, v5
    v_xor_b32 v6, v6, v7
    v_lshl_add_u32 v6, v6, 5, v4
    s_add_u32 m0, s15, 11264
    s_add_u32 s65, s65, s89
    buffer_load_dwordx4 v195, s[92:95], s65 offen  lds
    v_and_b32 v8, 3, v1
    v_lshl_add_u32 v6, v8, 3, v6
    v_lshl_add_u32 v4, v2, 3, v4
    s_lshl_b32 s68, s75, 13
    s_add_u32 s68, s68, 65536
    v_add_u32 v212, s68, v6
    v_xor_b32 v213, 64, v212
    s_add_u32 m0, s15, 12288
    s_add_u32 s65, s65, s89
    buffer_load_dwordx4 v194, s[92:95], s65 offen  lds
    s_lshr_b32 s68, s59, 4
    s_lshl_b32 s69, s75, 1
    s_add_u32 s68, s68, s69
    s_bfe_u32 s70, s59, 0x30001
    s_lshl_b32 s70, s70, 3
    s_add_u32 s68, s68, s70
    s_lshl_b32 s68, s68, 7
    s_add_u32 m0, s15, 13312
    s_add_u32 s65, s65, s89
    buffer_load_dwordx4 v195, s[92:95], s65 offen  lds
    v_and_b32 v2, 3, v1
    v_lshlrev_b32 v6, 2, v2
    v_lshl_add_u32 v6, v5, 13, v6
    v_add_u32 v6, s68, v6
    s_lshr_b32 s68, s61, 16
    s_xor_b32 s69, s69, s68
    s_and_b32 s68, s2, 0xc7
    s_add_u32 m0, s15, 14336
    s_add_u32 s65, s65, s89
    buffer_load_dwordx4 v194, s[92:95], s65 offen  lds
    s_lshl_b32 s69, s69, 3
    s_add_u32 s68, s68, s69
    s_lshl_b32 s68, s68, 7
    s_lshl_b32 s69, s76, 2
    s_add_u32 s68, s68, s69
    v_and_b32 v8, 1, v5
    v_lshlrev_b32 v8, 10, v8
    s_add_u32 m0, s15, 15360
    s_add_u32 s65, s65, s89
    buffer_load_dwordx4 v195, s[92:95], s65 offen  lds
    v_lshl_add_u32 v8, v2, 3, v8
    v_cmp_gt_u32 vcc, 16, v1
    v_add_u32 v8, s68, v8
    s_nop 0
    v_cndmask_b32 v214, v8, v6, vcc
    v_lshrrev_b32 v6, 4, v1
    v_bfe_u32 v2, v1, 1, 1
    s_add_u32 m0, s3, 16384
    s_add_u32 s88, s64, 640
    buffer_load_dwordx4 v192, s[28:31], s88 offen offset:0  lds
    v_lshl_add_u32 v6, v2, 2, v6
    v_and_b32 v2, 1, v1
    v_mad_u32_u24 v6, v2, 33, v6
    v_lshlrev_b32 v6, 4, v6
    v_bfe_u32 v2, v1, 2, 2
    v_mul_u32_u24 v2, 2208, v2
    v_add_u32 v6, v6, v2
    s_waitcnt vmcnt(11)
    s_barrier
    s_waitcnt vmcnt(9)
    s_mov_b64 exec, 1
    buffer_store_dword v11, off, s[52:55], s73 offset:16 sc1
    s_mov_b64 exec, -1
    s_add_u32 m0, s3, 16384
    s_add_u32 s88, s64, 640
    buffer_load_dwordx4 v193, s[28:31], s88 offen offset:1024  lds
    s_lshr_b32 s68, s66, 1
    s_mul_i32 s68, s68, 1056
    s_and_b32 s69, s66, 1
    s_lshl_b32 s69, s69, 8
    s_add_u32 s68, s68, s69
    s_add_u32 m0, s3, 16384
    s_add_u32 s88, s64, 14976
    buffer_load_dwordx4 v192, s[28:31], s88 offen offset:2048  lds
    v_add_u32 v204, s68, v6
    s_lshr_b32 s68, s57, 1
    s_and_b32 s69, s58, 12
    s_lshl_b32 s69, s69, 2
    s_add_u32 m0, s3, 16384
    s_add_u32 s88, s64, 14976
    buffer_load_dwordx4 v193, s[28:31], s88 offen offset:3072  lds
    s_add_u32 s68, s68, s69
    s_and_b32 s69, s57, 1
    s_lshl_b32 s69, s69, 7
    s_add_u32 s68, s68, s69
    s_add_u32 m0, s15, 16384
    s_add_u32 s65, s65, s89
    buffer_load_dwordx4 v194, s[92:95], s65 offen  lds
    s_lshl_b32 s68, s68, 7
    s_add_u32 s68, s68, 163872
    v_and_b32 v6, 3, v1
    v_lshlrev_b32 v6, 2, v6
    v_bfe_u32 v2, v1, 2, 1
    s_add_u32 m0, s15, 17408
    s_add_u32 s65, s65, s89
    buffer_load_dwordx4 v195, s[92:95], s65 offen  lds
    v_lshl_add_u32 v6, v2, 10, v6
    v_bfe_u32 v2, v1, 3, 1
    v_lshl_add_u32 v6, v2, 13, v6
    v_add_u32 v205, s68, v6
    s_add_u32 m0, s15, 18432
    s_add_u32 s65, s65, s89
    buffer_load_dwordx4 v194, s[92:95], s65 offen  lds
    v_mov_b32 v240, 0
    v_mov_b32 v241, 0
    v_mov_b32 v244, 0
    v_mov_b32 v245, 0
    s_add_u32 m0, s15, 19456
    s_add_u32 s65, s65, s89
    buffer_load_dwordx4 v195, s[92:95], s65 offen  lds
    v_and_b32 v5, 27, v1
    v_cmp_eq_u32 vcc, 16, v5
    v_mov_b32 v6, 0x47804780
    v_mov_b32 v124, 0xdddddddd
    s_add_u32 m0, s15, 20480
    s_add_u32 s65, s65, s89
    buffer_load_dwordx4 v194, s[92:95], s65 offen  lds
    v_mov_b32 v11, 1
    v_cndmask_b32 v108, 0, v6, vcc
    v_mov_b32 v109, v108
    v_mov_b64 v[110:111], v[108:109]
    v_mov_b64 v[112:113], v[108:109]
    s_add_u32 m0, s15, 21504
    s_add_u32 s65, s65, s89
    buffer_load_dwordx4 v195, s[92:95], s65 offen  lds
    v_mov_b64 v[114:115], v[108:109]
    v_mov_b64 v[116:117], v[108:109]
    v_mov_b64 v[118:119], v[108:109]
    v_mov_b64 v[120:121], v[108:109]
    s_add_u32 m0, s15, 22528
    s_add_u32 s65, s65, s89
    buffer_load_dwordx4 v194, s[92:95], s65 offen  lds
    v_mov_b64 v[122:123], v[108:109]
    v_mov_b64 v[64:65], 0
    v_mov_b64 v[66:67], 0
    v_mov_b64 v[68:69], 0
    s_add_u32 m0, s15, 23552
    s_add_u32 s65, s65, s89
    buffer_load_dwordx4 v195, s[92:95], s65 offen  lds
    v_mov_b64 v[70:71], 0
    v_mov_b64 v[72:73], 0
    v_mov_b64 v[74:75], 0
    v_mov_b64 v[76:77], 0
    s_add_u32 m0, s3, 32768
    s_add_u32 s88, s64, 768
    buffer_load_dwordx4 v192, s[28:31], s88 offen offset:0  lds
    v_mov_b64 v[78:79], 0
    v_mov_b64 v[224:225], 0
    v_mov_b64 v[226:227], 0
    v_mov_b64 v[228:229], 0
    v_mov_b64 v[230:231], 0
    s_add_u32 m0, s3, 32768
    s_add_u32 s88, s64, 768
    buffer_load_dwordx4 v193, s[28:31], s88 offen offset:1024  lds
    v_mov_b64 v[232:233], 0
    v_mov_b64 v[234:235], 0
    v_mov_b64 v[236:237], 0
    v_mov_b64 v[238:239], 0
    s_add_u32 m0, s3, 32768
    s_add_u32 s88, s64, 15104
    buffer_load_dwordx4 v192, s[28:31], s88 offen offset:2048  lds
    s_lshl_b32 s68, s66, 11
    v_add_u32 v125, s68, v208
    s_lshl_b32 s68, s75, 13
    s_add_u32 s68, s68, 32768
    s_add_u32 m0, s3, 32768
    s_add_u32 s88, s64, 15104
    buffer_load_dwordx4 v193, s[28:31], s88 offen offset:3072  lds
    v_add_u32 v126, s68, v212
    v_xor_b32 v127, 64, v126
    s_lshl_b32 s68, s66, 11
    v_add_u32 v7, s68, v208
    s_waitcnt vmcnt(12)
    s_barrier
    v_and_b32 v6, 7, v1
    v_lshlrev_b32 v6, 5, v6
    s_lshl_b32 s70, s66, 8
    buffer_load_dword v8, v6, s[48:51], s70 offen sc1
    s_add_u32 m0, s15, 0
    s_add_u32 s65, s65, s89
    buffer_load_dwordx4 v194, s[92:95], s65 offen  lds
    s_add_u32 m0, s15, 1024
    s_add_u32 s65, s65, s89
    buffer_load_dwordx4 v195, s[92:95], s65 offen  lds
    s_add_u32 m0, s15, 2048
    s_add_u32 s65, s65, s89
    buffer_load_dwordx4 v194, s[92:95], s65 offen  lds
    s_add_u32 m0, s15, 3072
    s_add_u32 s65, s65, s89
    buffer_load_dwordx4 v195, s[92:95], s65 offen  lds
    s_add_u32 m0, s15, 4096
    s_add_u32 s65, s65, s89
    buffer_load_dwordx4 v194, s[92:95], s65 offen  lds
    s_add_u32 m0, s15, 5120
    s_add_u32 s65, s65, s89
    buffer_load_dwordx4 v195, s[92:95], s65 offen  lds
    s_add_u32 m0, s15, 6144
    s_add_u32 s65, s65, s89
    buffer_load_dwordx4 v194, s[92:95], s65 offen  lds
    s_add_u32 m0, s15, 7168
    s_add_u32 s65, s65, s89
    buffer_load_dwordx4 v195, s[92:95], s65 offen  lds
    s_add_u32 m0, s3, 0
    s_add_u32 s88, s64, 896
    buffer_load_dwordx4 v192, s[28:31], s88 offen offset:0  lds
    s_add_u32 m0, s3, 0
    s_add_u32 s88, s64, 896
    buffer_load_dwordx4 v193, s[28:31], s88 offen offset:1024  lds
    s_add_u32 m0, s3, 0
    s_add_u32 s88, s64, 15232
    buffer_load_dwordx4 v192, s[28:31], s88 offen offset:2048  lds
    s_add_u32 m0, s3, 0
    s_add_u32 s88, s64, 15232
    buffer_load_dwordx4 v193, s[28:31], s88 offen offset:3072  lds
    s_waitcnt vmcnt(12)
    s_cmp_lg_u32 s66, 0
    s_cbranch_scc1 L_sync1
    s_mov_b32 s81, 0
L_sync1_chk:
    v_cmp_gt_u32 vcc, 32, v8
    s_add_u32 s81, s81, 1
    s_cbranch_vccz L_sync1
    s_cmp_ge_u32 s81, 262144
    s_cbranch_scc1 L_sync1
    s_sleep 4
    buffer_load_dword v8, v6, s[48:51], s70 offen sc1
    s_waitcnt vmcnt(0)
    s_branch L_sync1_chk
L_sync1:
    s_waitcnt vmcnt(13)
    s_barrier
    s_lshl_b32 s71, s66, 11
    s_add_u32 m0, s71, 147456
    s_lshl_b32 s84, s57, 13
    s_add_u32 s84, s84, s71
    s_add_u32 s84, s84, 524288
    s_lshl_b32 s71, s66, 10
    s_lshl_b32 s85, s58, 14
    s_add_u32 s85, s85, s71
    s_add_u32 s85, s85, 262144
    buffer_load_dwordx4 v[132:135], v208, s[52:55], s85 offen sc1
    s_add_u32 s85, s85, 4096
    buffer_load_dwordx4 v[136:139], v208, s[52:55], s85 offen sc1
    s_add_u32 s85, s85, 4096
    buffer_load_dwordx4 v[140:143], v208, s[52:55], s85 offen sc1
    s_add_u32 s85, s85, 4096
    buffer_load_dwordx4 v[144:147], v208, s[52:55], s85 offen sc1
    buffer_load_dwordx4 v208, s[52:55], s84 offen offset:0 sc1 lds
    buffer_load_dwordx4 v208, s[52:55], s84 offen offset:1024 sc1 lds
    s_and_b32 s70, s58, 3
    s_sub_u32 s70, s70, s3
    s_cmp_eq_u32 s70, 3
    s_cselect_b32 s70, 0, 16777216
    buffer_load_dword v9, v205, s[52:55], s70 offen sc1
    s_mul_i32 s68, s2, 7168
    s_lshl_b32 s69, s66, 11
    s_add_u32 s68, s68, s69
    buffer_load_dwordx4 v[176:179], v208, s[36:39], s68 offen
    buffer_load_dwordx4 v[180:183], v208, s[36:39], s68 offen offset:1024
    s_lshl_b32 s69, s2, 11
    s_lshl_b32 s71, s66, 9
    s_add_u32 s69, s69, s71
    s_mov_b32 exec_hi, 0
    buffer_load_dwordx4 v[184:187], v208, s[40:43], s69 offen
    s_mov_b64 exec, -1
    s_cmp_eq_u32 s66, 0
    s_cbranch_scc0 L_nt34
    s_call_b64 s[0:1], L_stub34
L_nt34:
    s_cmp_eq_u32 s66, 1
    s_cbranch_scc0 L_nt46
    s_call_b64 s[0:1], L_stub46
L_nt46:
    s_waitcnt vmcnt(10)
    s_barrier
    s_setprio 0
    s_waitcnt vmcnt(6)
    v_add_f32 v132, v132, v136
    v_add_f32 v134, v134, v138
    v_add_f32 v133, v133, v137
    v_add_f32 v135, v135, v139
    v_add_f32 v132, v132, v140
    v_add_f32 v134, v134, v142
    v_add_f32 v133, v133, v141
    v_add_f32 v135, v135, v143
    v_add_f32 v132, v132, v144
    v_add_f32 v134, v134, v146
    v_add_f32 v133, v133, v145
    v_add_f32 v135, v135, v147
    v_permlane32_swap_b32 v132, v134
    s_nop 0
    v_permlane32_swap_b32 v133, v135
    v_add_f32 v132, v132, v134
    v_add_f32 v133, v133, v135
    s_nop 1
    v_permlane16_swap_b32 v132, v133
    v_add_f32 v132, v132, v133
    v_cvt_pk_bf16_f32 v242, v132, v132
    v_and_b32 v2, 0xffff0000, v242
    v_sub_f32 v2, v132, v2
    v_cvt_pk_bf16_f32 v243, v2, v2
    ds_write_b128 v204, v[242:245] offset:57344
    ds_write_b128 v204, v[240:243] offset:57472
    s_waitcnt vmcnt(3)
    s_cmp_lg_u32 s70, 0
    s_cbranch_scc1 L_qrdy
    s_mov_b32 s81, 0
L_qrchk:
    v_cmp_ne_u32 vcc, 1, v9
    s_add_u32 s81, s81, 1
    s_cbranch_vccz L_qrdy
    s_cmp_ge_u32 s81, 262144
    s_cbranch_scc1 L_qrdy
    buffer_load_dword v9, v205, s[52:55], s70 offen sc1
    s_waitcnt vmcnt(0)
    s_branch L_qrchk
L_qrdy:
    s_setprio 0
    s_waitcnt lgkmcnt(0)
    s_barrier
    s_add_u32 m0, s3, 16384
    s_add_u32 s68, s3, 0
    buffer_load_dwordx4 v208, s[52:55], s68 offen offset:0 sc1 lds
    buffer_load_dwordx4 v208, s[52:55], s68 offen offset:1024 sc1 lds
    buffer_load_dwordx4 v208, s[52:55], s68 offen offset:2048 sc1 lds
    buffer_load_dwordx4 v208, s[52:55], s68 offen offset:3072 sc1 lds
    s_add_u32 m0, s3, 32768
    s_add_u32 s68, s3, 16384
    buffer_load_dwordx4 v208, s[52:55], s68 offen offset:0 sc1 lds
    buffer_load_dwordx4 v208, s[52:55], s68 offen offset:1024 sc1 lds
    buffer_load_dwordx4 v208, s[52:55], s68 offen offset:2048 sc1 lds
    buffer_load_dwordx4 v208, s[52:55], s68 offen offset:3072 sc1 lds
    s_cmp_eq_u32 s66, 0
    s_cbranch_scc0 L_nt65
    s_call_b64 s[0:1], L_stub65
L_nt65:
    s_cmp_eq_u32 s66, 1
    s_cbranch_scc0 L_nt88
    s_call_b64 s[0:1], L_stub88
L_nt88:
    s_cmp_eq_u32 s66, 2
    s_cbranch_scc0 L_nt109
    s_call_b64 s[0:1], L_stub109
L_nt109:
    s_cmp_eq_u32 s66, 3
    s_cbranch_scc0 L_nt121
    s_call_b64 s[0:1], L_stub121
L_nt121:
    s_cmp_eq_u32 s66, 0
    s_cbranch_scc0 L_nt145
    s_call_b64 s[0:1], L_stub145
L_nt145:
    s_cmp_eq_u32 s66, 1
    s_cbranch_scc0 L_nt166
    s_call_b64 s[0:1], L_stub166
L_nt166:
    s_cmp_eq_u32 s66, 2
    s_cbranch_scc0 L_nt183
    s_call_b64 s[0:1], L_stub183
L_nt183:
    s_cmp_eq_u32 s66, 3
    s_cbranch_scc0 L_ntL_attA
    s_call_b64 s[0:1], L_stubL_attA
L_ntL_attA:
    s_cmp_eq_u32 s66, 0
    s_cbranch_scc0 L_ntL_attB
    s_call_b64 s[0:1], L_stubL_attB
L_ntL_attB:
    s_add_u32 s70, s72, 13629440
    s_mov_b32 s81, 0
    s_waitcnt vmcnt(0)
    s_barrier
    s_setprio 2
    buffer_load_dwordx4 v[96:99], v208, s[52:55], s70 offen sc1
    buffer_load_dwordx4 v[220:223], v208, s[52:55], s70 offen offset:2048 sc1
    ds_read_b128 v[100:103], v209 offset:18432
    ds_read_b128 v[104:107], v209 offset:16384
    s_mov_b64 exec, s[62:63]
    ds_read_b128 v[108:111], v211 offset:18432
    ds_read_b128 v[112:115], v211 offset:18944
    s_mov_b64 exec, -1
L_qchk:
    s_waitcnt vmcnt(0) lgkmcnt(0)
    v_max3_u32 v8, v220, v221, v222
    v_max3_u32 v8, v8, v223, v96
    v_max3_u32 v8, v8, v97, v98
    v_max_u32 v8, v8, v99
    v_cmp_eq_u32 vcc, -1, v8
    s_add_u32 s81, s81, 1
    s_cbranch_vccz L_qok
    s_cmp_ge_u32 s81, 262144
    s_cbranch_scc1 L_qok
    s_sleep 2
    buffer_load_dwordx4 v[96:99], v208, s[52:55], s70 offen sc1
    buffer_load_dwordx4 v[220:223], v208, s[52:55], s70 offen offset:2048 sc1
    s_branch L_qchk
L_qok:
    v_mfma_f32_32x32x16_bf16 v[16:31], v[104:107], v[96:99], 0
    v_mfma_f32_32x32x16_bf16 v[32:47], v[104:107], v[220:223], 0
    ds_write_b128 v7, v[96:99] offset:49152
    ds_write_b128 v7, v[220:223] offset:57344
    s_nop 8
    v_max3_f32 v8, v16, v17, v18
    v_max_f32 v8, v19, v8
    v_max3_f32 v8, v20, v21, v8
    v_max3_f32 v8, v22, v23, v8
    v_max3_f32 v8, v24, v25, v8
    v_max3_f32 v8, v26, v27, v8
    v_max3_f32 v8, v28, v29, v8
    v_max3_f32 v8, v30, v31, v8
    v_mov_b32 v9, v8
    s_nop 1
    v_permlane32_swap_b32 v8, v9
    v_max_f32 v8, v8, v9
    v_sub_f32 v48, 0xc2ca0000, v8
    v_mov_b32 v49, v48
    v_mov_b64 v[50:51], v[48:49]
    ds_write_b128 v7, v[48:51] offset:50176
    ds_read_b128 v[52:55], v7 offset:50176
    ds_read_b128 v[56:59], v7 offset:50176
    ds_read_b128 v[60:63], v7 offset:50176
    v_max3_f32 v8, v32, v33, v34
    v_max_f32 v8, v35, v8
    v_max3_f32 v8, v36, v37, v8
    v_max3_f32 v8, v38, v39, v8
    v_max3_f32 v8, v40, v41, v8
    v_max3_f32 v8, v42, v43, v8
    v_max3_f32 v8, v44, v45, v8
    v_max3_f32 v8, v46, v47, v8
    v_mov_b32 v9, v8
    s_nop 1
    v_permlane32_swap_b32 v8, v9
    v_max_f32 v8, v8, v9
    v_sub_f32 v80, 0xc2ca0000, v8
    v_mov_b32 v81, v80
    v_mov_b64 v[82:83], v[80:81]
    ds_write_b128 v7, v[80:83] offset:58368
    ds_read_b128 v[84:87], v7 offset:58368
    ds_read_b128 v[88:91], v7 offset:58368
    ds_read_b128 v[92:95], v7 offset:58368
    s_waitcnt lgkmcnt(3)
    s_barrier
    s_setprio 1
    v_mfma_f32_32x32x16_bf16 v[16:31], v[100:103], v[96:99], v[48:63]
    s_nop 3
    s_nop 5
    s_branch L_attB
.p2align 6
L_stubL_attA:
    s_nop 0
    s_setpc_b64 s[0:1]
L_attA:
    s_waitcnt lgkmcnt(0)
    s_add_u32 s71, s74, 0
    buffer_store_dwordx4 v[160:163], v208, s[52:55], s71 offen sc1 nt
    ds_read_b128 v[104:107], v209 offset:20480
    s_add_u32 s71, s14, 0
    buffer_store_dwordx4 v[176:179], v208, s[52:55], s71 offen sc1 nt
.p2align 3
    v_exp_f32 v16, v16
    v_exp_f32 v17, v17
    v_exp_f32 v18, v18
    s_setprio 3
    v_exp_f32 v19, v19
    v_exp_f32 v20, v20
    v_exp_f32_e64 v21, v21
    v_mfma_f32_32x32x16_bf16 v[32:47], v[100:103], v[96:99], v[48:63]
    v_exp_f32 v22, v22
    v_exp_f32 v23, v23
    v_exp_f32 v24, v24
    v_exp_f32 v25, v25
    v_exp_f32 v26, v26
    v_exp_f32 v27, v27
    v_smfmac_f32_32x32x32_bf16 v[64:79], v[108:111], v[16:23], v124
    v_exp_f32 v28, v28
    v_exp_f32 v29, v29
    v_exp_f32 v30, v30
    v_exp_f32 v31, v31
    s_setprio 2
    s_waitcnt lgkmcnt(0)
    s_add_u32 s71, s74, 114688
    buffer_store_dwordx4 v[164:167], v208, s[52:55], s71 offen sc1 nt
    s_mov_b64 exec, s[62:63]
    ds_read_b128 v[116:119], v211 offset:20480
    ds_read_b128 v[120:123], v211 offset:20992
    s_mov_b64 exec, -1
    s_add_u32 s71, s14, 114688
    buffer_store_dwordx4 v[180:183], v208, s[52:55], s71 offen sc1 nt
.p2align 3
    v_exp_f32 v32, v32
    v_exp_f32 v33, v33
    v_smfmac_f32_32x32x32_bf16 v[64:79], v[112:115], v[24:31], v124
    v_exp_f32 v34, v34
    v_exp_f32 v35, v35
    v_exp_f32 v36, v36
    v_exp_f32 v37, v37
    v_mfma_f32_32x32x16_bf16 v[16:31], v[104:107], v[220:223], v[80:95]
    v_exp_f32 v38, v38
    v_exp_f32 v39, v39
    v_exp_f32 v40, v40
    v_exp_f32 v41, v41
    v_exp_f32 v42, v42
    v_exp_f32 v43, v43
    v_smfmac_f32_32x32x32_bf16 v[224:239], v[108:111], v[32:39], v124
    v_exp_f32 v44, v44
    v_exp_f32 v45, v45
    v_exp_f32 v46, v46
    v_exp_f32 v47, v47
    s_setprio 1
    s_waitcnt lgkmcnt(0)
    s_add_u32 s71, s74, 229376
    buffer_store_dwordx4 v[168:171], v208, s[52:55], s71 offen sc1 nt
    ds_read_b128 v[100:103], v209 offset:24576
    s_add_u32 s71, s14, 229376
    buffer_store_dwordx4 v[184:187], v208, s[52:55], s71 offen sc1 nt
.p2align 3
    v_exp_f32 v16, v16
    v_exp_f32 v17, v17
    v_smfmac_f32_32x32x32_bf16 v[224:239], v[112:115], v[40:47], v124
    v_exp_f32 v18, v18
    v_exp_f32 v19, v19
    v_exp_f32 v20, v20
    v_exp_f32 v21, v21
    v_mfma_f32_32x32x16_bf16 v[32:47], v[104:107], v[96:99], v[48:63]
    v_exp_f32 v22, v22
    v_exp_f32 v23, v23
    v_exp_f32 v24, v24
    v_exp_f32 v25, v25
    v_exp_f32 v26, v26
    v_exp_f32 v27, v27
    v_smfmac_f32_32x32x32_bf16 v[64:79], v[116:119], v[16:23], v124
    v_exp_f32 v28, v28
    v_exp_f32 v29, v29
    v_exp_f32 v30, v30
    v_exp_f32 v31, v31
    s_setprio 0
    s_waitcnt lgkmcnt(0)
    s_add_u32 s71, s74, 344064
    buffer_store_dwordx4 v[172:175], v208, s[52:55], s71 offen sc1 nt
    s_mov_b64 exec, s[62:63]
    ds_read_b128 v[108:111], v211 offset:24576
    ds_read_b128 v[112:115], v211 offset:25088
    s_mov_b64 exec, -1
    s_add_u32 s71, s14, 344064
    buffer_store_dwordx4 v[188:191], v208, s[52:55], s71 offen sc1 nt
.p2align 3
    v_exp_f32 v32, v32
    v_exp_f32 v33, v33
    v_smfmac_f32_32x32x32_bf16 v[64:79], v[120:123], v[24:31], v124
    v_exp_f32 v34, v34
    s_setprio 3
    v_exp_f32 v35, v35
    v_exp_f32 v36, v36
    v_exp_f32_e64 v37, v37
    v_mfma_f32_32x32x16_bf16 v[16:31], v[100:103], v[220:223], v[80:95]
    v_exp_f32 v38, v38
    v_exp_f32 v39, v39
    v_exp_f32 v40, v40
    v_exp_f32 v41, v41
    v_exp_f32 v42, v42
    v_exp_f32 v43, v43
    v_smfmac_f32_32x32x32_bf16 v[224:239], v[116:119], v[32:39], v124
    v_exp_f32 v44, v44
    v_exp_f32 v45, v45
    v_exp_f32 v46, v46
    v_exp_f32 v47, v47
    s_setprio 2
    s_waitcnt lgkmcnt(0)
    buffer_store_dwordx4 v[12:15], v208, s[52:55], s72 offen sc1
    ds_read_b128 v[104:107], v209 offset:28672
.p2align 3
    v_exp_f32 v16, v16
    v_exp_f32 v17, v17
    v_smfmac_f32_32x32x32_bf16 v[224:239], v[120:123], v[40:47], v124
    v_exp_f32 v18, v18
    v_exp_f32 v19, v19
    v_exp_f32 v20, v20
    v_exp_f32 v21, v21
    v_mfma_f32_32x32x16_bf16 v[32:47], v[100:103], v[96:99], v[48:63]
    v_exp_f32 v22, v22
    v_exp_f32 v23, v23
    v_exp_f32 v24, v24
    v_exp_f32 v25, v25
    v_exp_f32 v26, v26
    v_exp_f32 v27, v27
    v_smfmac_f32_32x32x32_bf16 v[64:79], v[108:111], v[16:23], v124
    v_exp_f32 v28, v28
    v_exp_f32 v29, v29
    v_exp_f32 v30, v30
    v_exp_f32 v31, v31
    s_setprio 1
    s_waitcnt lgkmcnt(0)
    s_mov_b64 exec, s[62:63]
    ds_read_b128 v[116:119], v211 offset:28672
    ds_read_b128 v[120:123], v211 offset:29184
    s_mov_b64 exec, -1
.p2align 3
    v_exp_f32 v32, v32
    v_exp_f32 v33, v33
    v_smfmac_f32_32x32x32_bf16 v[64:79], v[112:115], v[24:31], v124
    v_exp_f32 v34, v34
    v_exp_f32 v35, v35
    v_exp_f32 v36, v36
    v_exp_f32 v37, v37
    v_mfma_f32_32x32x16_bf16 v[16:31], v[104:107], v[220:223], v[80:95]
    v_exp_f32 v38, v38
    v_exp_f32 v39, v39
    v_exp_f32 v40, v40
    v_exp_f32 v41, v41
    v_exp_f32 v42, v42
    v_exp_f32 v43, v43
    v_smfmac_f32_32x32x32_bf16 v[224:239], v[108:111], v[32:39], v124
    v_exp_f32 v44, v44
    v_exp_f32 v45, v45
    v_exp_f32 v46, v46
    v_exp_f32 v47, v47
    s_setprio 0
    s_waitcnt vmcnt(63) lgkmcnt(0)
    s_barrier
    s_add_u32 m0, s80, 0
    s_add_u32 s68, s80, 32768
    buffer_load_dwordx4 v208, s[52:55], s68 offen sc1 lds
    ds_read_b128 v[100:103], v209 offset:32768
    buffer_load_dwordx4 v208, s[52:55], s68 offen offset:1024 sc1 lds
.p2align 3
    v_exp_f32 v16, v16
    v_exp_f32 v17, v17
    v_smfmac_f32_32x32x32_bf16 v[224:239], v[112:115], v[40:47], v124
    v_exp_f32 v18, v18
    s_setprio 3
    v_exp_f32 v19, v19
    v_exp_f32 v20, v20
    v_exp_f32_e64 v21, v21
    v_mfma_f32_32x32x16_bf16 v[32:47], v[104:107], v[96:99], v[48:63]
    v_exp_f32 v22, v22
    v_exp_f32 v23, v23
    v_exp_f32 v24, v24
    v_exp_f32 v25, v25
    v_exp_f32 v26, v26
    v_exp_f32 v27, v27
    v_smfmac_f32_32x32x32_bf16 v[64:79], v[116:119], v[16:23], v124
    v_exp_f32 v28, v28
    v_exp_f32 v29, v29
    v_exp_f32 v30, v30
    v_exp_f32 v31, v31
    s_setprio 2
    s_waitcnt lgkmcnt(0)
    s_mov_b64 exec, s[62:63]
    ds_read_b128 v[108:111], v211 offset:32768
    ds_read_b128 v[112:115], v211 offset:33280
    s_mov_b64 exec, -1
.p2align 3
    v_exp_f32 v32, v32
    v_exp_f32 v33, v33
    v_smfmac_f32_32x32x32_bf16 v[64:79], v[120:123], v[24:31], v124
    v_exp_f32 v34, v34
    v_exp_f32 v35, v35
    v_exp_f32 v36, v36
    v_exp_f32 v37, v37
    v_mfma_f32_32x32x16_bf16 v[16:31], v[100:103], v[220:223], v[80:95]
    v_exp_f32 v38, v38
    v_exp_f32 v39, v39
    v_exp_f32 v40, v40
    v_exp_f32 v41, v41
    v_exp_f32 v42, v42
    v_exp_f32 v43, v43
    v_smfmac_f32_32x32x32_bf16 v[224:239], v[116:119], v[32:39], v124
    v_exp_f32 v44, v44
    v_exp_f32 v45, v45
    v_exp_f32 v46, v46
    v_exp_f32 v47, v47
    s_setprio 1
    s_waitcnt lgkmcnt(0)
    ds_read_b128 v[104:107], v209 offset:36864
.p2align 3
    v_exp_f32 v16, v16
    v_exp_f32 v17, v17
    v_smfmac_f32_32x32x32_bf16 v[224:239], v[120:123], v[40:47], v124
    v_exp_f32 v18, v18
    v_exp_f32 v19, v19
    v_exp_f32 v20, v20
    v_exp_f32 v21, v21
    v_mfma_f32_32x32x16_bf16 v[32:47], v[100:103], v[96:99], v[48:63]
    v_exp_f32 v22, v22
    v_exp_f32 v23, v23
    v_exp_f32 v24, v24
    v_exp_f32 v25, v25
    v_exp_f32 v26, v26
    v_exp_f32 v27, v27
    v_smfmac_f32_32x32x32_bf16 v[64:79], v[108:111], v[16:23], v124
    v_exp_f32 v28, v28
    v_exp_f32 v29, v29
    v_exp_f32 v30, v30
    v_exp_f32 v31, v31
    s_setprio 0
    s_branch L_pg65
.p2align 12
L_stub65:
    s_nop 0
    s_setpc_b64 s[0:1]
L_pg65:
    s_waitcnt lgkmcnt(0)
    s_mov_b64 exec, s[62:63]
    ds_read_b128 v[116:119], v211 offset:36864
    ds_read_b128 v[120:123], v211 offset:37376
    s_mov_b64 exec, -1
.p2align 3
    v_exp_f32 v32, v32
    v_exp_f32 v33, v33
    v_smfmac_f32_32x32x32_bf16 v[64:79], v[112:115], v[24:31], v124
    v_exp_f32 v34, v34
    s_setprio 3
    v_exp_f32 v35, v35
    v_exp_f32 v36, v36
    v_exp_f32_e64 v37, v37
    v_mfma_f32_32x32x16_bf16 v[16:31], v[104:107], v[220:223], v[80:95]
    v_exp_f32 v38, v38
    v_exp_f32 v39, v39
    v_exp_f32 v40, v40
    v_exp_f32 v41, v41
    v_exp_f32 v42, v42
    v_exp_f32 v43, v43
    v_smfmac_f32_32x32x32_bf16 v[224:239], v[108:111], v[32:39], v124
    v_exp_f32 v44, v44
    v_exp_f32 v45, v45
    v_exp_f32 v46, v46
    v_exp_f32 v47, v47
    s_setprio 2
    s_waitcnt lgkmcnt(0)
    s_waitcnt vmcnt(2)
    s_mov_b64 exec, 1
    buffer_store_dword v11, off, s[52:55], s73 sc1
    s_mov_b64 exec, -1
    ds_read_b128 v[100:103], v209 offset:40960
    s_mov_b64 exec, 3
    global_load_dword v2, v[252:253], off
    s_mov_b64 exec, -1
.p2align 3
    v_exp_f32 v16, v16
    v_exp_f32 v17, v17
    v_smfmac_f32_32x32x32_bf16 v[224:239], v[112:115], v[40:47], v124
    v_exp_f32 v18, v18
    v_exp_f32 v19, v19
    v_exp_f32 v20, v20
    v_exp_f32 v21, v21
    v_mfma_f32_32x32x16_bf16 v[32:47], v[104:107], v[96:99], v[48:63]
    v_exp_f32 v22, v22
    v_exp_f32 v23, v23
    v_exp_f32 v24, v24
    v_exp_f32 v25, v25
    v_exp_f32 v26, v26
    v_exp_f32 v27, v27
    v_smfmac_f32_32x32x32_bf16 v[64:79], v[116:119], v[16:23], v124
    v_exp_f32 v28, v28
    v_exp_f32 v29, v29
    v_exp_f32 v30, v30
    v_exp_f32 v31, v31
    s_setprio 1
    s_waitcnt lgkmcnt(0)
    s_mov_b64 exec, s[62:63]
    ds_read_b128 v[108:111], v211 offset:40960
    ds_read_b128 v[112:115], v211 offset:41472
    s_mov_b64 exec, -1
.p2align 3
    v_exp_f32 v32, v32
    v_exp_f32 v33, v33
    v_smfmac_f32_32x32x32_bf16 v[64:79], v[120:123], v[24:31], v124
    v_exp_f32 v34, v34
    v_exp_f32 v35, v35
    v_exp_f32 v36, v36
    v_exp_f32 v37, v37
    v_mfma_f32_32x32x16_bf16 v[16:31], v[100:103], v[220:223], v[80:95]
    v_exp_f32 v38, v38
    v_exp_f32 v39, v39
    v_exp_f32 v40, v40
    v_exp_f32 v41, v41
    v_exp_f32 v42, v42
    v_exp_f32 v43, v43
    v_smfmac_f32_32x32x32_bf16 v[224:239], v[116:119], v[32:39], v124
    v_exp_f32 v44, v44
    v_exp_f32 v45, v45
    v_exp_f32 v46, v46
    v_exp_f32 v47, v47
    s_setprio 0
    s_waitcnt lgkmcnt(0)
    s_add_u32 m0, s79, 65536
    s_add_u32 s68, s77, 0
    buffer_load_dwordx4 v210, s[36:39], s68 offen offset:0  lds
    ds_read_b128 v[104:107], v209 offset:45056
.p2align 3
    v_exp_f32 v16, v16
    v_exp_f32 v17, v17
    v_smfmac_f32_32x32x32_bf16 v[224:239], v[120:123], v[40:47], v124
    v_exp_f32 v18, v18
    s_setprio 3
    v_max_f32 v4, 0x15000000, v72
    v_frexp_exp_i32_f32_e64 v4, v4
    v_sub_u32 v4, -84, v4
    v_max_i32 v4, 0xffffff82, v4
    v_cvt_f32_i32 v5, v4
    v_add_f32 v6, v80, v5
    v_ldexp_f32 v4, 1.0, v4
    v_mov_b32 v7, v6
    v_mov_b64 v[8:9], v[6:7]
    v_exp_f32 v19, v19
    v_exp_f32 v20, v20
    v_exp_f32_e64 v21, v21
    v_mfma_f32_32x32x16_bf16 v[32:47], v[100:103], v[96:99], v[48:63]
    v_exp_f32 v22, v22
    v_exp_f32 v23, v23
    v_exp_f32 v24, v24
    v_exp_f32 v25, v25
    v_exp_f32 v26, v26
    v_exp_f32 v27, v27
    v_smfmac_f32_32x32x32_bf16 v[64:79], v[108:111], v[16:23], v124
    v_exp_f32 v28, v28
    v_exp_f32 v29, v29
    v_exp_f32 v30, v30
    v_exp_f32 v31, v31
    s_setprio 2
    s_waitcnt lgkmcnt(0)
    s_mov_b64 exec, s[62:63]
    ds_read_b128 v[116:119], v211 offset:45056
    ds_read_b128 v[120:123], v211 offset:45568
    s_mov_b64 exec, -1
    ds_write_b128 v125, v[6:9] offset:50176
    ds_write_b32 v125, v4 offset:49152
.p2align 3
    v_exp_f32 v32, v32
    v_exp_f32 v33, v33
    v_smfmac_f32_32x32x32_bf16 v[64:79], v[112:115], v[24:31], v124
    v_exp_f32 v34, v34
    v_exp_f32 v35, v35
    v_exp_f32 v36, v36
    v_exp_f32 v37, v37
    v_mfma_f32_32x32x16_bf16 v[16:31], v[104:107], v[220:223], v[80:95]
    v_exp_f32 v38, v38
    v_exp_f32 v39, v39
    v_exp_f32 v40, v40
    v_exp_f32 v41, v41
    v_exp_f32 v42, v42
    v_exp_f32 v43, v43
    v_smfmac_f32_32x32x32_bf16 v[224:239], v[108:111], v[32:39], v124
    v_exp_f32 v44, v44
    v_exp_f32 v45, v45
    v_exp_f32 v46, v46
    v_exp_f32 v47, v47
    s_setprio 1
    s_waitcnt vmcnt(3) lgkmcnt(0)
    s_barrier
    s_add_u32 m0, s80, 16384
    s_add_u32 s68, s80, 45056
    buffer_load_dwordx4 v208, s[52:55], s68 offen sc1 lds
    ds_read_b128 v[100:103], v209 offset:0
    ds_read_b32 v5, v125 offset:57344
    ds_read_b128 v[80:83], v125 offset:50176
    ds_read_b128 v[84:87], v125 offset:50176
    ds_read_b128 v[88:91], v125 offset:50176
    ds_read_b128 v[92:95], v125 offset:50176
    buffer_load_dwordx4 v208, s[52:55], s68 offen offset:1024 sc1 lds
.p2align 3
    v_exp_f32 v16, v16
    v_exp_f32 v17, v17
    v_smfmac_f32_32x32x32_bf16 v[224:239], v[112:115], v[40:47], v124
    v_exp_f32 v18, v18
    v_exp_f32 v19, v19
    v_exp_f32 v20, v20
    v_exp_f32 v21, v21
    v_mfma_f32_32x32x16_bf16 v[32:47], v[104:107], v[96:99], v[48:63]
    v_exp_f32 v22, v22
    v_exp_f32 v23, v23
    v_exp_f32 v24, v24
    v_exp_f32 v25, v25
    v_exp_f32 v26, v26
    v_exp_f32 v27, v27
    v_smfmac_f32_32x32x32_bf16 v[64:79], v[116:119], v[16:23], v124
    v_exp_f32 v28, v28
    v_exp_f32 v29, v29
    v_exp_f32 v30, v30
    v_exp_f32 v31, v31
    s_setprio 0
    s_waitcnt lgkmcnt(0)
    s_mov_b32 s70, 163840
    buffer_load_dword v3, v214, s[52:55], s70 offen sc1
    s_mov_b64 exec, s[62:63]
    ds_read_b128 v[108:111], v211 offset:0
    ds_read_b128 v[112:115], v211 offset:512
    s_mov_b64 exec, -1
    ds_read_b128 v[48:51], v125 offset:58368
    ds_read_b128 v[52:55], v125 offset:58368
    ds_read_b128 v[56:59], v125 offset:58368
    ds_read_b128 v[60:63], v125 offset:58368
    s_add_u32 m0, s79, 65536
    s_add_u32 s68, s77, 7168
    buffer_load_dwordx4 v210, s[36:39], s68 offen offset:1024  lds
.p2align 3
    v_exp_f32 v32, v32
    v_exp_f32 v33, v33
    v_smfmac_f32_32x32x32_bf16 v[64:79], v[120:123], v[24:31], v124
    v_exp_f32 v34, v34
    s_setprio 3
    v_exp_f32 v35, v35
    v_exp_f32 v36, v36
    v_exp_f32_e64 v37, v37
    v_mfma_f32_32x32x16_bf16 v[16:31], v[100:103], v[220:223], v[80:95]
    v_exp_f32 v38, v38
    v_exp_f32 v39, v39
    v_exp_f32 v40, v40
    v_exp_f32 v41, v41
    v_exp_f32 v42, v42
    v_exp_f32 v43, v43
    v_smfmac_f32_32x32x32_bf16 v[224:239], v[116:119], v[32:39], v124
    v_exp_f32 v44, v44
    v_exp_f32 v45, v45
    v_exp_f32 v46, v46
    v_exp_f32 v47, v47
    s_setprio 2
    s_waitcnt lgkmcnt(0)
    s_add_u32 m0, s79, 65536
    s_add_u32 s68, s77, 14336
    buffer_load_dwordx4 v210, s[36:39], s68 offen offset:2048  lds
    ds_read_b128 v[104:107], v209 offset:4096
    s_add_u32 m0, s79, 65536
    s_add_u32 s68, s77, 21504
    buffer_load_dwordx4 v210, s[36:39], s68 offen offset:3072  lds
.p2align 3
    v_exp_f32 v16, v16
    v_exp_f32 v17, v17
    v_smfmac_f32_32x32x32_bf16 v[224:239], v[120:123], v[40:47], v124
    v_exp_f32_e64 v18, v18
    v_mul_f32_e64 v64, v64, v4
    v_mul_f32 v65, v65, v4
    v_mul_f32 v66, v66, v4
    v_mul_f32 v67, v67, v4
    v_mul_f32 v68, v68, v4
    v_mul_f32 v69, v69, v4
    v_mul_f32 v70, v70, v4
    v_mul_f32 v71, v71, v4
    v_mul_f32 v72, v72, v4
    v_exp_f32 v19, v19
    v_exp_f32 v20, v20
    v_exp_f32_e64 v21, v21
    v_mfma_f32_32x32x16_bf16 v[32:47], v[100:103], v[96:99], v[48:63]
    v_exp_f32 v22, v22
    v_exp_f32 v23, v23
    v_exp_f32 v24, v24
    v_exp_f32 v25, v25
    v_exp_f32 v26, v26
    v_exp_f32 v27, v27
    v_smfmac_f32_32x32x32_bf16 v[64:79], v[108:111], v[16:23], v124
    v_exp_f32 v28, v28
    v_exp_f32 v29, v29
    v_exp_f32 v30, v30
    v_exp_f32 v31, v31
    s_setprio 1
    s_waitcnt lgkmcnt(0)
    s_waitcnt vmcnt(3)
    s_mov_b64 exec, s[62:63]
    ds_read_b128 v[116:119], v211 offset:4096
    ds_read_b128 v[120:123], v211 offset:4608
    s_mov_b64 exec, -1
.p2align 3
    v_exp_f32 v32, v32
    v_exp_f32 v33, v33
    v_smfmac_f32_32x32x32_bf16 v[64:79], v[112:115], v[24:31], v124
    v_exp_f32_e64 v34, v34
    v_mul_f32_e64 v224, v224, v5
    v_mul_f32 v225, v225, v5
    v_mul_f32 v226, v226, v5
    v_mul_f32 v227, v227, v5
    v_mul_f32 v228, v228, v5
    v_mul_f32 v229, v229, v5
    v_mul_f32 v230, v230, v5
    v_mul_f32 v231, v231, v5
    v_mul_f32 v232, v232, v5
    v_exp_f32 v35, v35
    v_exp_f32 v36, v36
    v_exp_f32_e64 v37, v37
    v_mfma_f32_32x32x16_bf16 v[16:31], v[104:107], v[220:223], v[80:95]
    v_exp_f32 v38, v38
    v_exp_f32 v39, v39
    v_exp_f32 v40, v40
    v_exp_f32 v41, v41
    v_exp_f32 v42, v42
    v_exp_f32 v43, v43
    v_smfmac_f32_32x32x32_bf16 v[224:239], v[108:111], v[32:39], v124
    v_exp_f32 v44, v44
    v_exp_f32 v45, v45
    v_exp_f32 v46, v46
    v_exp_f32 v47, v47
    v_cmp_ne_u32 vcc, 1, v3
    s_setprio 0
    s_waitcnt lgkmcnt(0)
    s_cbranch_vccnz L_hspinA
L_hokA:
    s_add_u32 s69, s78, 0
    buffer_load_dwordx4 v[160:163], v208, s[52:55], s69 offen offset:0 sc1
    ds_read_b128 v[100:103], v209 offset:8192
    buffer_load_dwordx4 v[164:167], v208, s[52:55], s69 offen offset:1024 sc1
.p2align 3
    v_exp_f32 v16, v16
    v_exp_f32 v17, v17
    v_smfmac_f32_32x32x32_bf16 v[224:239], v[112:115], v[40:47], v124
    v_exp_f32 v18, v18
    s_setprio 3
    v_exp_f32 v19, v19
    v_exp_f32 v20, v20
    v_exp_f32_e64 v21, v21
    v_mfma_f32_32x32x16_bf16 v[32:47], v[104:107], v[96:99], v[48:63]
    v_exp_f32 v22, v22
    v_exp_f32 v23, v23
    v_exp_f32 v24, v24
    v_exp_f32 v25, v25
    v_exp_f32 v26, v26
    v_exp_f32 v27, v27
    v_smfmac_f32_32x32x32_bf16 v[64:79], v[116:119], v[16:23], v124
    v_exp_f32 v28, v28
    v_exp_f32 v29, v29
    v_exp_f32 v30, v30
    v_exp_f32 v31, v31
    s_setprio 2
    s_waitcnt lgkmcnt(0)
    buffer_load_dwordx4 v[168:171], v208, s[52:55], s69 offen offset:2048 sc1
    s_mov_b64 exec, s[62:63]
    ds_read_b128 v[108:111], v211 offset:8192
    ds_read_b128 v[112:115], v211 offset:8704
    s_mov_b64 exec, -1
    buffer_load_dwordx4 v[172:175], v208, s[52:55], s69 offen offset:3072 sc1
.p2align 3
    v_exp_f32 v32, v32
    v_exp_f32 v33, v33
    v_smfmac_f32_32x32x32_bf16 v[64:79], v[120:123], v[24:31], v124
    v_exp_f32 v34, v34
    v_exp_f32 v35, v35
    v_exp_f32 v36, v36
    v_exp_f32 v37, v37
    v_mfma_f32_32x32x16_bf16 v[16:31], v[100:103], v[220:223], v[80:95]
    v_exp_f32 v38, v38
    v_exp_f32 v39, v39
    v_exp_f32 v40, v40
    v_exp_f32 v41, v41
    v_exp_f32 v42, v42
    v_exp_f32 v43, v43
    v_smfmac_f32_32x32x32_bf16 v[224:239], v[116:119], v[32:39], v124
    v_exp_f32 v44, v44
    v_exp_f32 v45, v45
    v_exp_f32 v46, v46
    v_exp_f32 v47, v47
    s_setprio 1
    s_waitcnt vmcnt(4) lgkmcnt(0)
    s_barrier
    s_add_u32 m0, s80, 32768
    s_add_u32 s68, s80, 57344
    buffer_load_dwordx4 v208, s[52:55], s68 offen sc1 lds
    ds_read_b128 v[104:107], v209 offset:16384
    ds_read_b64_tr_b16 v[192:193], v212 offset:0
    ds_read_b64_tr_b16 v[194:195], v212 offset:512
    buffer_load_dwordx4 v208, s[52:55], s68 offen offset:1024 sc1 lds
.p2align 3
    v_exp_f32 v16, v16
    v_exp_f32 v17, v17
    v_smfmac_f32_32x32x32_bf16 v[224:239], v[120:123], v[40:47], v124
    v_exp_f32 v18, v18
    v_exp_f32 v19, v19
    v_exp_f32 v20, v20
    v_exp_f32 v21, v21
    v_mfma_f32_32x32x16_bf16 v[32:47], v[100:103], v[96:99], v[48:63]
    v_exp_f32 v22, v22
    v_exp_f32 v23, v23
    v_exp_f32 v24, v24
    v_exp_f32 v25, v25
    v_exp_f32 v26, v26
    v_exp_f32 v27, v27
    v_smfmac_f32_32x32x32_bf16 v[64:79], v[108:111], v[16:23], v124
    v_exp_f32 v28, v28
    v_exp_f32 v29, v29
    v_exp_f32 v30, v30
    v_exp_f32 v31, v31
    s_setprio 0
    s_waitcnt lgkmcnt(0)
    s_add_u32 m0, s79, 98304
    s_add_u32 s68, s77, 65536
    buffer_load_dwordx4 v210, s[36:39], s68 offen offset:0  lds
    s_mov_b64 exec, s[62:63]
    ds_read_b128 v[116:119], v211 offset:16384
    ds_read_b128 v[120:123], v211 offset:16896
    s_mov_b64 exec, -1
    ds_read_b64_tr_b16 v[196:197], v213 offset:0
    ds_read_b64_tr_b16 v[198:199], v213 offset:512
    s_add_u32 m0, s79, 98304
    s_add_u32 s68, s77, 72704
    buffer_load_dwordx4 v210, s[36:39], s68 offen offset:1024  lds
.p2align 3
    v_exp_f32 v32, v32
    v_exp_f32 v33, v33
    v_smfmac_f32_32x32x32_bf16 v[64:79], v[112:115], v[24:31], v124
    v_exp_f32 v34, v34
    s_setprio 3
    v_exp_f32 v35, v35
    v_exp_f32 v36, v36
    v_exp_f32_e64 v37, v37
    v_mfma_f32_32x32x16_bf16 v[16:31], v[104:107], v[220:223], v[80:95]
    v_exp_f32 v38, v38
    v_exp_f32 v39, v39
    v_exp_f32 v40, v40
    v_exp_f32 v41, v41
    v_exp_f32 v42, v42
    v_exp_f32 v43, v43
    v_smfmac_f32_32x32x32_bf16 v[224:239], v[108:111], v[32:39], v124
    v_exp_f32 v44, v44
    v_exp_f32 v45, v45
    v_exp_f32 v46, v46
    v_exp_f32 v47, v47
    s_setprio 2
    s_waitcnt lgkmcnt(0)
    s_waitcnt vmcnt(7)
    s_add_u32 m0, s79, 98304
    s_add_u32 s68, s77, 79872
    buffer_load_dwordx4 v210, s[36:39], s68 offen offset:2048  lds
    ds_read_b128 v[100:103], v209 offset:20480
    ds_read_b64_tr_b16 v[200:201], v212 offset:2048
    ds_read_b64_tr_b16 v[202:203], v212 offset:2560
    ds_read_b64_tr_b16 v[204:205], v213 offset:2048
    ds_read_b64_tr_b16 v[206:207], v213 offset:2560
.p2align 3
    v_exp_f32 v16, v16
    v_exp_f32 v17, v17
    v_smfmac_f32_32x32x32_bf16 v[224:239], v[112:115], v[40:47], v124
    v_exp_f32 v18, v18
    v_exp_f32 v19, v19
    v_exp_f32 v20, v20
    v_exp_f32 v21, v21
    v_mfma_f32_32x32x16_bf16 v[32:47], v[104:107], v[96:99], v[48:63]
    v_exp_f32 v22, v22
    v_exp_f32 v23, v23
    v_exp_f32 v24, v24
    v_exp_f32 v25, v25
    v_mfma_f32_32x32x16_bf16 v[128:143], v[160:163], v[192:195], 0
    v_exp_f32 v26, v26
    v_exp_f32 v27, v27
    v_exp_f32 v28, v28
    v_exp_f32 v29, v29
    v_smfmac_f32_32x32x32_bf16 v[64:79], v[116:119], v[16:23], v124
    v_exp_f32 v30, v30
    v_exp_f32 v31, v31
    s_setprio 1
    s_waitcnt lgkmcnt(0)
    s_add_u32 m0, s79, 98304
    s_add_u32 s68, s77, 87040
    buffer_load_dwordx4 v210, s[36:39], s68 offen offset:3072  lds
    s_mov_b64 exec, s[62:63]
    ds_read_b128 v[108:111], v211 offset:20480
    ds_read_b128 v[112:115], v211 offset:20992
    s_mov_b64 exec, -1
    ds_read_b64_tr_b16 v[192:193], v212 offset:4096
    ds_read_b64_tr_b16 v[194:195], v212 offset:4608
    s_add_u32 s69, s78, 4096
    buffer_load_dwordx4 v[176:179], v208, s[52:55], s69 offen offset:0 sc1
.p2align 3
    v_exp_f32 v32, v32
    v_exp_f32 v33, v33
    v_smfmac_f32_32x32x32_bf16 v[64:79], v[120:123], v[24:31], v124
    v_exp_f32 v34, v34
    v_exp_f32 v35, v35
    v_exp_f32 v36, v36
    v_exp_f32 v37, v37
    v_mfma_f32_32x32x16_bf16 v[16:31], v[100:103], v[220:223], v[80:95]
    v_exp_f32 v38, v38
    v_exp_f32 v39, v39
    v_exp_f32 v40, v40
    v_exp_f32 v41, v41
    v_mfma_f32_32x32x16_bf16 v[144:159], v[160:163], v[196:199], 0
    v_exp_f32 v42, v42
    v_exp_f32 v43, v43
    v_exp_f32 v44, v44
    v_exp_f32 v45, v45
    v_smfmac_f32_32x32x32_bf16 v[224:239], v[116:119], v[32:39], v124
    v_exp_f32 v46, v46
    v_exp_f32 v47, v47
    s_setprio 0
    s_waitcnt lgkmcnt(0)
    s_waitcnt vmcnt(7)
    buffer_load_dwordx4 v[180:183], v208, s[52:55], s69 offen offset:1024 sc1
    ds_read_b128 v[104:107], v209 offset:24576
    ds_read_b64_tr_b16 v[196:197], v213 offset:4096
    ds_read_b64_tr_b16 v[198:199], v213 offset:4608
    buffer_load_dwordx4 v[184:187], v208, s[52:55], s69 offen offset:2048 sc1
.p2align 3
    v_exp_f32_e64 v16, v16
    v_smfmac_f32_32x32x32_bf16 v[224:239], v[120:123], v[40:47], v124
    v_exp_f32 v17, v17
    v_exp_f32 v18, v18
    s_setprio 3
    v_exp_f32 v19, v19
    v_mfma_f32_32x32x16_bf16 v[32:47], v[100:103], v[96:99], v[48:63]
    v_exp_f32 v20, v20
    v_exp_f32 v21, v21
    v_exp_f32_e64 v22, v22
    v_mfma_f32_32x32x16_bf16 v[128:143], v[164:167], v[200:203], v[128:143]
    v_exp_f32 v23, v23
    v_exp_f32 v24, v24
    v_exp_f32_e64 v25, v25
    v_smfmac_f32_32x32x32_bf16 v[64:79], v[108:111], v[16:23], v124
    v_exp_f32 v26, v26
    v_exp_f32 v27, v27
    v_exp_f32_e64 v28, v28
    v_mfma_f32_32x32x16_bf16 v[144:159], v[164:167], v[204:207], v[144:159]
    v_exp_f32 v29, v29
    v_exp_f32 v30, v30
    v_exp_f32 v31, v31
    s_setprio 2
    s_waitcnt lgkmcnt(0)
    buffer_load_dwordx4 v[188:191], v208, s[52:55], s69 offen offset:3072 sc1
    s_mov_b64 exec, s[62:63]
    ds_read_b128 v[116:119], v211 offset:24576
    ds_read_b128 v[120:123], v211 offset:25088
    s_mov_b64 exec, -1
    ds_read_b64_tr_b16 v[200:201], v212 offset:6144
    ds_read_b64_tr_b16 v[202:203], v212 offset:6656
    ds_read_b64_tr_b16 v[204:205], v213 offset:6144
    ds_read_b64_tr_b16 v[206:207], v213 offset:6656
.p2align 3
    v_exp_f32_e64 v32, v32
    v_smfmac_f32_32x32x32_bf16 v[64:79], v[112:115], v[24:31], v124
    v_exp_f32 v33, v33
    v_exp_f32 v34, v34
    v_exp_f32_e64 v35, v35
    v_mfma_f32_32x32x16_bf16 v[16:31], v[104:107], v[220:223], v[80:95]
    v_exp_f32 v36, v36
    v_exp_f32 v37, v37
    v_exp_f32_e64 v38, v38
    v_mfma_f32_32x32x16_bf16 v[128:143], v[168:171], v[192:195], v[128:143]
    v_exp_f32 v39, v39
    v_exp_f32 v40, v40
    v_exp_f32_e64 v41, v41
    v_smfmac_f32_32x32x32_bf16 v[224:239], v[108:111], v[32:39], v124
    v_exp_f32 v42, v42
    v_exp_f32 v43, v43
    v_exp_f32_e64 v44, v44
    v_mfma_f32_32x32x16_bf16 v[144:159], v[168:171], v[196:199], v[144:159]
    v_exp_f32 v45, v45
    v_exp_f32 v46, v46
    v_exp_f32 v47, v47
    s_setprio 1
    s_waitcnt vmcnt(4) lgkmcnt(0)
    s_barrier
    s_add_u32 m0, s80, 0
    s_add_u32 s68, s80, 69632
    buffer_load_dwordx4 v208, s[52:55], s68 offen sc1 lds
    ds_read_b128 v[100:103], v209 offset:32768
    ds_read_b64_tr_b16 v[192:193], v212 offset:32768
    ds_read_b64_tr_b16 v[194:195], v212 offset:33280
    buffer_load_dwordx4 v208, s[52:55], s68 offen offset:1024 sc1 lds
.p2align 3
    v_exp_f32_e64 v16, v16
    v_smfmac_f32_32x32x32_bf16 v[224:239], v[112:115], v[40:47], v124
    v_exp_f32 v17, v17
    v_exp_f32 v18, v18
    v_exp_f32_e64 v19, v19
    v_mfma_f32_32x32x16_bf16 v[32:47], v[104:107], v[96:99], v[48:63]
    v_exp_f32 v20, v20
    v_exp_f32 v21, v21
    v_exp_f32_e64 v22, v22
    v_mfma_f32_32x32x16_bf16 v[128:143], v[172:175], v[200:203], v[128:143]
    v_exp_f32 v23, v23
    v_exp_f32 v24, v24
    v_exp_f32_e64 v25, v25
    v_smfmac_f32_32x32x32_bf16 v[64:79], v[116:119], v[16:23], v124
    v_exp_f32 v26, v26
    v_exp_f32 v27, v27
    v_exp_f32_e64 v28, v28
    v_mfma_f32_32x32x16_bf16 v[144:159], v[172:175], v[204:207], v[144:159]
    v_exp_f32 v29, v29
    v_exp_f32 v30, v30
    v_exp_f32 v31, v31
    s_setprio 0
    s_waitcnt lgkmcnt(0)
    s_waitcnt vmcnt(5)
    s_add_u32 m0, s79, 65536
    s_add_u32 s68, s77, 131072
    buffer_load_dwordx4 v210, s[36:39], s68 offen offset:0  lds
    s_mov_b64 exec, s[62:63]
    ds_read_b128 v[108:111], v211 offset:32768
    ds_read_b128 v[112:115], v211 offset:33280
    s_mov_b64 exec, -1
    ds_read_b64_tr_b16 v[196:197], v213 offset:32768
    ds_read_b64_tr_b16 v[198:199], v213 offset:33280
    s_add_u32 m0, s79, 65536
    s_add_u32 s68, s77, 138240
    buffer_load_dwordx4 v210, s[36:39], s68 offen offset:1024  lds
.p2align 3
    v_exp_f32 v32, v32
    v_exp_f32 v33, v33
    v_smfmac_f32_32x32x32_bf16 v[64:79], v[120:123], v[24:31], v124
    v_exp_f32 v34, v34
    s_setprio 3
    v_exp_f32 v35, v35
    v_exp_f32 v36, v36
    v_exp_f32_e64 v37, v37
    v_mfma_f32_32x32x16_bf16 v[16:31], v[100:103], v[220:223], v[80:95]
    v_exp_f32 v38, v38
    v_exp_f32 v39, v39
    v_exp_f32 v40, v40
    v_exp_f32 v41, v41
    v_mfma_f32_32x32x16_bf16 v[128:143], v[176:179], v[192:195], v[128:143]
    v_exp_f32 v42, v42
    v_exp_f32 v43, v43
    v_exp_f32 v44, v44
    v_exp_f32 v45, v45
    v_smfmac_f32_32x32x32_bf16 v[224:239], v[116:119], v[32:39], v124
    v_exp_f32 v46, v46
    v_exp_f32 v47, v47
    s_setprio 2
    s_waitcnt lgkmcnt(0)
    s_add_u32 m0, s79, 65536
    s_add_u32 s68, s77, 145408
    buffer_load_dwordx4 v210, s[36:39], s68 offen offset:2048  lds
    ds_read_b128 v[104:107], v209 offset:36864
    ds_read_b64_tr_b16 v[200:201], v212 offset:34816
    ds_read_b64_tr_b16 v[202:203], v212 offset:35328
    ds_read_b64_tr_b16 v[204:205], v213 offset:34816
    ds_read_b64_tr_b16 v[206:207], v213 offset:35328
.p2align 3
    v_exp_f32 v16, v16
    v_exp_f32 v17, v17
    v_smfmac_f32_32x32x32_bf16 v[224:239], v[120:123], v[40:47], v124
    v_exp_f32 v18, v18
    v_exp_f32 v19, v19
    v_exp_f32 v20, v20
    v_exp_f32 v21, v21
    v_mfma_f32_32x32x16_bf16 v[32:47], v[100:103], v[96:99], v[48:63]
    v_exp_f32 v22, v22
    v_exp_f32 v23, v23
    v_exp_f32 v24, v24
    v_exp_f32 v25, v25
    v_mfma_f32_32x32x16_bf16 v[144:159], v[176:179], v[196:199], v[144:159]
    v_exp_f32 v26, v26
    v_exp_f32 v27, v27
    v_exp_f32 v28, v28
    v_exp_f32 v29, v29
    v_smfmac_f32_32x32x32_bf16 v[64:79], v[108:111], v[16:23], v124
    v_exp_f32 v30, v30
    v_exp_f32 v31, v31
    s_setprio 1
    s_waitcnt lgkmcnt(0)
    s_waitcnt vmcnt(5)
    s_add_u32 m0, s79, 65536
    s_add_u32 s68, s77, 152576
    buffer_load_dwordx4 v210, s[36:39], s68 offen offset:3072  lds
    s_mov_b64 exec, s[62:63]
    ds_read_b128 v[116:119], v211 offset:36864
    ds_read_b128 v[120:123], v211 offset:37376
    s_mov_b64 exec, -1
    ds_read_b64_tr_b16 v[192:193], v212 offset:36864
    ds_read_b64_tr_b16 v[194:195], v212 offset:37376
    s_add_u32 s69, s78, 8192
    buffer_load_dwordx4 v[160:163], v208, s[52:55], s69 offen offset:0 sc1
.p2align 3
    v_exp_f32 v32, v32
    v_exp_f32 v33, v33
    v_smfmac_f32_32x32x32_bf16 v[64:79], v[112:115], v[24:31], v124
    v_exp_f32 v34, v34
    v_exp_f32 v35, v35
    v_exp_f32 v36, v36
    v_exp_f32 v37, v37
    v_mfma_f32_32x32x16_bf16 v[16:31], v[104:107], v[220:223], v[80:95]
    v_exp_f32 v38, v38
    v_exp_f32 v39, v39
    v_exp_f32 v40, v40
    v_exp_f32 v41, v41
    v_mfma_f32_32x32x16_bf16 v[128:143], v[180:183], v[200:203], v[128:143]
    v_exp_f32 v42, v42
    v_exp_f32 v43, v43
    v_exp_f32 v44, v44
    v_exp_f32 v45, v45
    v_smfmac_f32_32x32x32_bf16 v[224:239], v[108:111], v[32:39], v124
    v_exp_f32 v46, v46
    v_exp_f32 v47, v47
    s_setprio 0
    s_waitcnt lgkmcnt(0)
    buffer_load_dwordx4 v[164:167], v208, s[52:55], s69 offen offset:1024 sc1
    ds_read_b128 v[100:103], v209 offset:40960
    ds_read_b64_tr_b16 v[196:197], v213 offset:36864
    ds_read_b64_tr_b16 v[198:199], v213 offset:37376
    buffer_load_dwordx4 v[168:171], v208, s[52:55], s69 offen offset:2048 sc1
.p2align 3
    v_exp_f32_e64 v16, v16
    v_smfmac_f32_32x32x32_bf16 v[224:239], v[112:115], v[40:47], v124
    v_exp_f32 v17, v17
    v_exp_f32 v18, v18
    s_setprio 3
    v_exp_f32 v19, v19
    v_mfma_f32_32x32x16_bf16 v[32:47], v[104:107], v[96:99], v[48:63]
    v_exp_f32 v20, v20
    v_exp_f32 v21, v21
    v_exp_f32_e64 v22, v22
    v_mfma_f32_32x32x16_bf16 v[144:159], v[180:183], v[204:207], v[144:159]
    v_exp_f32 v23, v23
    v_exp_f32 v24, v24
    v_exp_f32_e64 v25, v25
    v_smfmac_f32_32x32x32_bf16 v[64:79], v[116:119], v[16:23], v124
    v_exp_f32 v26, v26
    v_exp_f32 v27, v27
    v_exp_f32_e64 v28, v28
    v_mfma_f32_32x32x16_bf16 v[128:143], v[184:187], v[192:195], v[128:143]
    v_exp_f32 v29, v29
    v_exp_f32 v30, v30
    v_exp_f32 v31, v31
    s_setprio 2
    s_waitcnt lgkmcnt(0)
    buffer_load_dwordx4 v[172:175], v208, s[52:55], s69 offen offset:3072 sc1
    s_mov_b64 exec, s[62:63]
    ds_read_b128 v[108:111], v211 offset:40960
    ds_read_b128 v[112:115], v211 offset:41472
    s_mov_b64 exec, -1
    ds_read_b64_tr_b16 v[200:201], v212 offset:38912
    ds_read_b64_tr_b16 v[202:203], v212 offset:39424
    ds_read_b64_tr_b16 v[204:205], v213 offset:38912
    ds_read_b64_tr_b16 v[206:207], v213 offset:39424
.p2align 3
    v_exp_f32 v32, v32
    v_exp_f32 v33, v33
    v_smfmac_f32_32x32x32_bf16 v[64:79], v[120:123], v[24:31], v124
    v_exp_f32 v34, v34
    v_exp_f32 v35, v35
    v_exp_f32 v36, v36
    v_exp_f32 v37, v37
    v_mfma_f32_32x32x16_bf16 v[16:31], v[100:103], v[220:223], v[80:95]
    v_exp_f32 v38, v38
    v_exp_f32 v39, v39
    v_exp_f32 v40, v40
    v_exp_f32 v41, v41
    v_mfma_f32_32x32x16_bf16 v[144:159], v[184:187], v[196:199], v[144:159]
    v_exp_f32 v42, v42
    v_exp_f32 v43, v43
    v_exp_f32 v44, v44
    v_exp_f32 v45, v45
    v_smfmac_f32_32x32x32_bf16 v[224:239], v[116:119], v[32:39], v124
    v_exp_f32 v46, v46
    v_exp_f32 v47, v47
    s_setprio 1
    s_branch L_pg88
.p2align 12
L_stub88:
    s_nop 0
    s_setpc_b64 s[0:1]
L_pg88:
    s_waitcnt vmcnt(4) lgkmcnt(0)
    s_barrier
    s_add_u32 m0, s80, 16384
    s_add_u32 s68, s80, 81920
    buffer_load_dwordx4 v208, s[52:55], s68 offen sc1 lds
    ds_read_b128 v[104:107], v209 offset:0
    ds_read_b64_tr_b16 v[192:193], v212 offset:0
    ds_read_b64_tr_b16 v[194:195], v212 offset:512
    buffer_load_dwordx4 v208, s[52:55], s68 offen offset:1024 sc1 lds
.p2align 3
    v_exp_f32_e64 v16, v16
    v_smfmac_f32_32x32x32_bf16 v[224:239], v[120:123], v[40:47], v124
    v_exp_f32 v17, v17
    v_exp_f32 v18, v18
    v_exp_f32_e64 v19, v19
    v_mfma_f32_32x32x16_bf16 v[32:47], v[100:103], v[96:99], v[48:63]
    v_exp_f32 v20, v20
    v_exp_f32 v21, v21
    v_exp_f32_e64 v22, v22
    v_mfma_f32_32x32x16_bf16 v[128:143], v[188:191], v[200:203], v[128:143]
    v_exp_f32 v23, v23
    v_exp_f32 v24, v24
    v_exp_f32_e64 v25, v25
    v_smfmac_f32_32x32x32_bf16 v[64:79], v[108:111], v[16:23], v124
    v_exp_f32 v26, v26
    v_exp_f32 v27, v27
    v_exp_f32_e64 v28, v28
    v_mfma_f32_32x32x16_bf16 v[144:159], v[188:191], v[204:207], v[144:159]
    v_exp_f32 v29, v29
    v_exp_f32 v30, v30
    v_exp_f32 v31, v31
    s_setprio 0
    s_waitcnt lgkmcnt(0)
    s_waitcnt vmcnt(5)
    s_add_u32 m0, s79, 98304
    s_add_u32 s68, s77, 196608
    buffer_load_dwordx4 v210, s[36:39], s68 offen offset:0  lds
    s_mov_b64 exec, s[62:63]
    ds_read_b128 v[116:119], v211 offset:0
    ds_read_b128 v[120:123], v211 offset:512
    s_mov_b64 exec, -1
    ds_read_b64_tr_b16 v[196:197], v213 offset:0
    ds_read_b64_tr_b16 v[198:199], v213 offset:512
    s_add_u32 m0, s79, 98304
    s_add_u32 s68, s77, 203776
    buffer_load_dwordx4 v210, s[36:39], s68 offen offset:1024  lds
.p2align 3
    v_exp_f32 v32, v32
    v_exp_f32 v33, v33
    v_smfmac_f32_32x32x32_bf16 v[64:79], v[112:115], v[24:31], v124
    v_exp_f32 v34, v34
    s_setprio 3
    v_exp_f32 v35, v35
    v_exp_f32 v36, v36
    v_exp_f32_e64 v37, v37
    v_mfma_f32_32x32x16_bf16 v[16:31], v[104:107], v[220:223], v[80:95]
    v_exp_f32 v38, v38
    v_exp_f32 v39, v39
    v_exp_f32 v40, v40
    v_exp_f32 v41, v41
    v_mfma_f32_32x32x16_bf16 v[128:143], v[160:163], v[192:195], v[128:143]
    v_exp_f32 v42, v42
    v_exp_f32 v43, v43
    v_exp_f32 v44, v44
    v_exp_f32 v45, v45
    v_smfmac_f32_32x32x32_bf16 v[224:239], v[108:111], v[32:39], v124
    v_exp_f32 v46, v46
    v_exp_f32 v47, v47
    s_setprio 2
    s_waitcnt lgkmcnt(0)
    s_add_u32 m0, s79, 98304
    s_add_u32 s68, s77, 210944
    buffer_load_dwordx4 v210, s[36:39], s68 offen offset:2048  lds
    ds_read_b128 v[100:103], v209 offset:4096
    ds_read_b64_tr_b16 v[200:201], v212 offset:2048
    ds_read_b64_tr_b16 v[202:203], v212 offset:2560
    ds_read_b64_tr_b16 v[204:205], v213 offset:2048
    ds_read_b64_tr_b16 v[206:207], v213 offset:2560
.p2align 3
    v_exp_f32 v16, v16
    v_exp_f32 v17, v17
    v_smfmac_f32_32x32x32_bf16 v[224:239], v[112:115], v[40:47], v124
    v_exp_f32 v18, v18
    v_exp_f32 v19, v19
    v_exp_f32 v20, v20
    v_exp_f32 v21, v21
    v_mfma_f32_32x32x16_bf16 v[32:47], v[104:107], v[96:99], v[48:63]
    v_exp_f32 v22, v22
    v_exp_f32 v23, v23
    v_exp_f32 v24, v24
    v_exp_f32 v25, v25
    v_mfma_f32_32x32x16_bf16 v[144:159], v[160:163], v[196:199], v[144:159]
    v_exp_f32 v26, v26
    v_exp_f32 v27, v27
    v_exp_f32 v28, v28
    v_exp_f32 v29, v29
    v_smfmac_f32_32x32x32_bf16 v[64:79], v[116:119], v[16:23], v124
    v_exp_f32 v30, v30
    v_exp_f32 v31, v31
    s_setprio 1
    s_waitcnt lgkmcnt(0)
    s_waitcnt vmcnt(5)
    s_add_u32 m0, s79, 98304
    s_add_u32 s68, s77, 218112
    buffer_load_dwordx4 v210, s[36:39], s68 offen offset:3072  lds
    s_mov_b64 exec, s[62:63]
    ds_read_b128 v[108:111], v211 offset:4096
    ds_read_b128 v[112:115], v211 offset:4608
    s_mov_b64 exec, -1
    ds_read_b64_tr_b16 v[192:193], v212 offset:4096
    ds_read_b64_tr_b16 v[194:195], v212 offset:4608
    s_add_u32 s69, s78, 12288
    buffer_load_dwordx4 v[176:179], v208, s[52:55], s69 offen offset:0 sc1
.p2align 3
    v_exp_f32 v32, v32
    v_exp_f32 v33, v33
    v_smfmac_f32_32x32x32_bf16 v[64:79], v[120:123], v[24:31], v124
    v_exp_f32 v34, v34
    v_exp_f32 v35, v35
    v_exp_f32 v36, v36
    v_exp_f32 v37, v37
    v_mfma_f32_32x32x16_bf16 v[16:31], v[100:103], v[220:223], v[80:95]
    v_exp_f32 v38, v38
    v_exp_f32 v39, v39
    v_exp_f32 v40, v40
    v_exp_f32 v41, v41
    v_mfma_f32_32x32x16_bf16 v[128:143], v[164:167], v[200:203], v[128:143]
    v_exp_f32 v42, v42
    v_exp_f32 v43, v43
    v_exp_f32 v44, v44
    v_exp_f32 v45, v45
    v_smfmac_f32_32x32x32_bf16 v[224:239], v[116:119], v[32:39], v124
    v_exp_f32 v46, v46
    v_exp_f32 v47, v47
    s_setprio 0
    s_waitcnt lgkmcnt(0)
    buffer_load_dwordx4 v[180:183], v208, s[52:55], s69 offen offset:1024 sc1
    ds_read_b128 v[104:107], v209 offset:8192
    ds_read_b64_tr_b16 v[196:197], v213 offset:4096
    ds_read_b64_tr_b16 v[198:199], v213 offset:4608
    buffer_load_dwordx4 v[184:187], v208, s[52:55], s69 offen offset:2048 sc1
.p2align 3
    v_exp_f32_e64 v16, v16
    v_smfmac_f32_32x32x32_bf16 v[224:239], v[120:123], v[40:47], v124
    v_exp_f32 v17, v17
    v_exp_f32 v18, v18
    s_setprio 3
    v_exp_f32 v19, v19
    v_mfma_f32_32x32x16_bf16 v[32:47], v[100:103], v[96:99], v[48:63]
    v_exp_f32 v20, v20
    v_exp_f32 v21, v21
    v_exp_f32_e64 v22, v22
    v_mfma_f32_32x32x16_bf16 v[144:159], v[164:167], v[204:207], v[144:159]
    v_exp_f32 v23, v23
    v_exp_f32 v24, v24
    v_exp_f32_e64 v25, v25
    v_smfmac_f32_32x32x32_bf16 v[64:79], v[108:111], v[16:23], v124
    v_exp_f32 v26, v26
    v_exp_f32 v27, v27
    v_exp_f32_e64 v28, v28
    v_mfma_f32_32x32x16_bf16 v[128:143], v[168:171], v[192:195], v[128:143]
    v_exp_f32 v29, v29
    v_exp_f32 v30, v30
    v_exp_f32 v31, v31
    s_setprio 2
    s_waitcnt lgkmcnt(0)
    buffer_load_dwordx4 v[188:191], v208, s[52:55], s69 offen offset:3072 sc1
    s_mov_b64 exec, s[62:63]
    ds_read_b128 v[116:119], v211 offset:8192
    ds_read_b128 v[120:123], v211 offset:8704
    s_mov_b64 exec, -1
    ds_read_b64_tr_b16 v[200:201], v212 offset:6144
    ds_read_b64_tr_b16 v[202:203], v212 offset:6656
    ds_read_b64_tr_b16 v[204:205], v213 offset:6144
    ds_read_b64_tr_b16 v[206:207], v213 offset:6656
.p2align 3
    v_exp_f32 v32, v32
    v_exp_f32 v33, v33
    v_smfmac_f32_32x32x32_bf16 v[64:79], v[112:115], v[24:31], v124
    v_exp_f32 v34, v34
    v_exp_f32 v35, v35
    v_exp_f32 v36, v36
    v_exp_f32 v37, v37
    v_mfma_f32_32x32x16_bf16 v[16:31], v[104:107], v[220:223], v[80:95]
    v_exp_f32 v38, v38
    v_exp_f32 v39, v39
    v_exp_f32 v40, v40
    v_exp_f32 v41, v41
    v_mfma_f32_32x32x16_bf16 v[144:159], v[168:171], v[196:199], v[144:159]
    v_exp_f32 v42, v42
    v_exp_f32 v43, v43
    v_exp_f32 v44, v44
    v_exp_f32 v45, v45
    v_smfmac_f32_32x32x32_bf16 v[224:239], v[108:111], v[32:39], v124
    v_exp_f32 v46, v46
    v_exp_f32 v47, v47
    s_setprio 1
    s_waitcnt vmcnt(4) lgkmcnt(0)
    s_barrier
    s_add_u32 m0, s80, 32768
    s_add_u32 s68, s80, 94208
    buffer_load_dwordx4 v208, s[52:55], s68 offen sc1 lds
    ds_read_b128 v[100:103], v209 offset:16384
    ds_read_b64_tr_b16 v[192:193], v212 offset:32768
    ds_read_b64_tr_b16 v[194:195], v212 offset:33280
    buffer_load_dwordx4 v208, s[52:55], s68 offen offset:1024 sc1 lds
.p2align 3
    v_exp_f32_e64 v16, v16
    v_smfmac_f32_32x32x32_bf16 v[224:239], v[112:115], v[40:47], v124
    v_exp_f32 v17, v17
    v_exp_f32 v18, v18
    v_exp_f32_e64 v19, v19
    v_mfma_f32_32x32x16_bf16 v[32:47], v[104:107], v[96:99], v[48:63]
    v_exp_f32 v20, v20
    v_exp_f32 v21, v21
    v_exp_f32_e64 v22, v22
    v_mfma_f32_32x32x16_bf16 v[128:143], v[172:175], v[200:203], v[128:143]
    v_exp_f32 v23, v23
    v_exp_f32 v24, v24
    v_exp_f32_e64 v25, v25
    v_smfmac_f32_32x32x32_bf16 v[64:79], v[116:119], v[16:23], v124
    v_exp_f32 v26, v26
    v_exp_f32 v27, v27
    v_exp_f32_e64 v28, v28
    v_mfma_f32_32x32x16_bf16 v[144:159], v[172:175], v[204:207], v[144:159]
    v_exp_f32 v29, v29
    v_exp_f32 v30, v30
    v_exp_f32 v31, v31
    s_setprio 0
    s_waitcnt lgkmcnt(0)
    s_waitcnt vmcnt(5)
    s_add_u32 m0, s79, 65536
    s_add_u32 s68, s77, 262144
    buffer_load_dwordx4 v210, s[36:39], s68 offen offset:0  lds
    s_mov_b64 exec, s[62:63]
    ds_read_b128 v[108:111], v211 offset:16384
    ds_read_b128 v[112:115], v211 offset:16896
    s_mov_b64 exec, -1
    ds_read_b64_tr_b16 v[196:197], v213 offset:32768
    ds_read_b64_tr_b16 v[198:199], v213 offset:33280
    s_add_u32 m0, s79, 65536
    s_add_u32 s68, s77, 269312
    buffer_load_dwordx4 v210, s[36:39], s68 offen offset:1024  lds
.p2align 3
    v_exp_f32 v32, v32
    v_exp_f32 v33, v33
    v_smfmac_f32_32x32x32_bf16 v[64:79], v[120:123], v[24:31], v124
    v_exp_f32 v34, v34
    s_setprio 3
    v_exp_f32 v35, v35
    v_exp_f32 v36, v36
    v_exp_f32_e64 v37, v37
    v_mfma_f32_32x32x16_bf16 v[16:31], v[100:103], v[220:223], v[80:95]
    v_exp_f32 v38, v38
    v_exp_f32 v39, v39
    v_exp_f32 v40, v40
    v_exp_f32 v41, v41
    v_mfma_f32_32x32x16_bf16 v[128:143], v[176:179], v[192:195], v[128:143]
    v_exp_f32 v42, v42
    v_exp_f32 v43, v43
    v_exp_f32 v44, v44
    v_exp_f32 v45, v45
    v_smfmac_f32_32x32x32_bf16 v[224:239], v[116:119], v[32:39], v124
    v_exp_f32 v46, v46
    v_exp_f32 v47, v47
    s_setprio 2
    s_waitcnt lgkmcnt(0)
    s_add_u32 m0, s79, 65536
    s_add_u32 s68, s77, 276480
    buffer_load_dwordx4 v210, s[36:39], s68 offen offset:2048  lds
    ds_read_b128 v[104:107], v209 offset:20480
    ds_read_b64_tr_b16 v[200:201], v212 offset:34816
    ds_read_b64_tr_b16 v[202:203], v212 offset:35328
    ds_read_b64_tr_b16 v[204:205], v213 offset:34816
    ds_read_b64_tr_b16 v[206:207], v213 offset:35328
.p2align 3
    v_exp_f32 v16, v16
    v_exp_f32 v17, v17
    v_smfmac_f32_32x32x32_bf16 v[224:239], v[120:123], v[40:47], v124
    v_exp_f32 v18, v18
    v_exp_f32 v19, v19
    v_exp_f32 v20, v20
    v_exp_f32 v21, v21
    v_mfma_f32_32x32x16_bf16 v[32:47], v[100:103], v[96:99], v[48:63]
    v_exp_f32 v22, v22
    v_exp_f32 v23, v23
    v_exp_f32 v24, v24
    v_exp_f32 v25, v25
    v_mfma_f32_32x32x16_bf16 v[144:159], v[176:179], v[196:199], v[144:159]
    v_exp_f32 v26, v26
    v_exp_f32 v27, v27
    v_exp_f32 v28, v28
    v_exp_f32 v29, v29
    v_smfmac_f32_32x32x32_bf16 v[64:79], v[108:111], v[16:23], v124
    v_exp_f32 v30, v30
    v_exp_f32 v31, v31
    s_setprio 1
    s_waitcnt lgkmcnt(0)
    s_waitcnt vmcnt(5)
    s_add_u32 m0, s79, 65536
    s_add_u32 s68, s77, 283648
    buffer_load_dwordx4 v210, s[36:39], s68 offen offset:3072  lds
    s_mov_b64 exec, s[62:63]
    ds_read_b128 v[116:119], v211 offset:20480
    ds_read_b128 v[120:123], v211 offset:20992
    s_mov_b64 exec, -1
    ds_read_b64_tr_b16 v[192:193], v212 offset:36864
    ds_read_b64_tr_b16 v[194:195], v212 offset:37376
    s_add_u32 s69, s78, 16384
    buffer_load_dwordx4 v[160:163], v208, s[52:55], s69 offen offset:0 sc1
.p2align 3
    v_exp_f32 v32, v32
    v_exp_f32 v33, v33
    v_smfmac_f32_32x32x32_bf16 v[64:79], v[112:115], v[24:31], v124
    v_exp_f32 v34, v34
    v_exp_f32 v35, v35
    v_exp_f32 v36, v36
    v_exp_f32 v37, v37
    v_mfma_f32_32x32x16_bf16 v[16:31], v[104:107], v[220:223], v[80:95]
    v_exp_f32 v38, v38
    v_exp_f32 v39, v39
    v_exp_f32 v40, v40
    v_exp_f32 v41, v41
    v_mfma_f32_32x32x16_bf16 v[128:143], v[180:183], v[200:203], v[128:143]
    v_exp_f32 v42, v42
    v_exp_f32 v43, v43
    v_exp_f32 v44, v44
    v_exp_f32 v45, v45
    v_smfmac_f32_32x32x32_bf16 v[224:239], v[108:111], v[32:39], v124
    v_exp_f32 v46, v46
    v_exp_f32 v47, v47
    s_setprio 0
    s_waitcnt lgkmcnt(0)
    buffer_load_dwordx4 v[164:167], v208, s[52:55], s69 offen offset:1024 sc1
    ds_read_b128 v[100:103], v209 offset:24576
    ds_read_b64_tr_b16 v[196:197], v213 offset:36864
    ds_read_b64_tr_b16 v[198:199], v213 offset:37376
    buffer_load_dwordx4 v[168:171], v208, s[52:55], s69 offen offset:2048 sc1
    s_mov_b64 exec, 3
    global_load_dword v2, v[252:253], off
    s_mov_b64 exec, -1
.p2align 3
    v_exp_f32_e64 v16, v16
    v_smfmac_f32_32x32x32_bf16 v[224:239], v[112:115], v[40:47], v124
    v_exp_f32 v17, v17
    v_exp_f32 v18, v18
    s_setprio 3
    v_exp_f32 v19, v19
    v_mfma_f32_32x32x16_bf16 v[32:47], v[104:107], v[96:99], v[48:63]
    v_exp_f32 v20, v20
    v_exp_f32 v21, v21
    v_exp_f32_e64 v22, v22
    v_mfma_f32_32x32x16_bf16 v[144:159], v[180:183], v[204:207], v[144:159]
    v_exp_f32 v23, v23
    v_exp_f32 v24, v24
    v_exp_f32_e64 v25, v25
    v_smfmac_f32_32x32x32_bf16 v[64:79], v[116:119], v[16:23], v124
    v_exp_f32 v26, v26
    v_exp_f32 v27, v27
    v_exp_f32_e64 v28, v28
    v_mfma_f32_32x32x16_bf16 v[128:143], v[184:187], v[192:195], v[128:143]
    v_exp_f32 v29, v29
    v_exp_f32 v30, v30
    v_exp_f32 v31, v31
    s_setprio 2
    s_waitcnt lgkmcnt(0)
    buffer_load_dwordx4 v[172:175], v208, s[52:55], s69 offen offset:3072 sc1
    s_mov_b64 exec, s[62:63]
    ds_read_b128 v[108:111], v211 offset:24576
    ds_read_b128 v[112:115], v211 offset:25088
    s_mov_b64 exec, -1
    ds_read_b64_tr_b16 v[200:201], v212 offset:38912
    ds_read_b64_tr_b16 v[202:203], v212 offset:39424
    ds_read_b64_tr_b16 v[204:205], v213 offset:38912
    ds_read_b64_tr_b16 v[206:207], v213 offset:39424
.p2align 3
    v_exp_f32 v32, v32
    v_exp_f32 v33, v33
    v_smfmac_f32_32x32x32_bf16 v[64:79], v[120:123], v[24:31], v124
    v_exp_f32 v34, v34
    v_exp_f32 v35, v35
    v_exp_f32 v36, v36
    v_exp_f32 v37, v37
    v_mfma_f32_32x32x16_bf16 v[16:31], v[100:103], v[220:223], v[80:95]
    v_exp_f32 v38, v38
    v_exp_f32 v39, v39
    v_exp_f32 v40, v40
    v_exp_f32 v41, v41
    v_mfma_f32_32x32x16_bf16 v[144:159], v[184:187], v[196:199], v[144:159]
    v_exp_f32 v42, v42
    v_exp_f32 v43, v43
    v_exp_f32 v44, v44
    v_exp_f32 v45, v45
    v_smfmac_f32_32x32x32_bf16 v[224:239], v[116:119], v[32:39], v124
    v_exp_f32 v46, v46
    v_exp_f32 v47, v47
    s_setprio 1
    s_waitcnt vmcnt(5) lgkmcnt(0)
    s_barrier
    s_add_u32 m0, s80, 0
    s_add_u32 s68, s80, 106496
    buffer_load_dwordx4 v208, s[52:55], s68 offen sc1 lds
    ds_read_b128 v[104:107], v209 offset:32768
    ds_read_b64_tr_b16 v[192:193], v212 offset:0
    ds_read_b64_tr_b16 v[194:195], v212 offset:512
    buffer_load_dwordx4 v208, s[52:55], s68 offen offset:1024 sc1 lds
.p2align 3
    v_exp_f32_e64 v16, v16
    v_smfmac_f32_32x32x32_bf16 v[224:239], v[120:123], v[40:47], v124
    v_exp_f32 v17, v17
    v_exp_f32 v18, v18
    v_exp_f32_e64 v19, v19
    v_mfma_f32_32x32x16_bf16 v[32:47], v[100:103], v[96:99], v[48:63]
    v_exp_f32 v20, v20
    v_exp_f32 v21, v21
    v_exp_f32_e64 v22, v22
    v_mfma_f32_32x32x16_bf16 v[128:143], v[188:191], v[200:203], v[128:143]
    v_exp_f32 v23, v23
    v_exp_f32 v24, v24
    v_exp_f32_e64 v25, v25
    v_smfmac_f32_32x32x32_bf16 v[64:79], v[108:111], v[16:23], v124
    v_exp_f32 v26, v26
    v_exp_f32 v27, v27
    v_exp_f32_e64 v28, v28
    v_mfma_f32_32x32x16_bf16 v[144:159], v[188:191], v[204:207], v[144:159]
    v_exp_f32 v29, v29
    v_exp_f32 v30, v30
    v_exp_f32 v31, v31
    s_setprio 0
    s_waitcnt lgkmcnt(0)
    s_waitcnt vmcnt(6)
    s_add_u32 m0, s79, 98304
    s_add_u32 s68, s77, 327680
    buffer_load_dwordx4 v210, s[36:39], s68 offen offset:0  lds
    s_mov_b64 exec, s[62:63]
    ds_read_b128 v[116:119], v211 offset:32768
    ds_read_b128 v[120:123], v211 offset:33280
    s_mov_b64 exec, -1
    ds_read_b64_tr_b16 v[196:197], v213 offset:0
    ds_read_b64_tr_b16 v[198:199], v213 offset:512
    s_add_u32 m0, s79, 98304
    s_add_u32 s68, s77, 334848
    buffer_load_dwordx4 v210, s[36:39], s68 offen offset:1024  lds
.p2align 3
    v_exp_f32 v32, v32
    v_exp_f32 v33, v33
    v_smfmac_f32_32x32x32_bf16 v[64:79], v[112:115], v[24:31], v124
    v_exp_f32 v34, v34
    s_setprio 3
    v_exp_f32 v35, v35
    v_exp_f32 v36, v36
    v_exp_f32_e64 v37, v37
    v_mfma_f32_32x32x16_bf16 v[16:31], v[104:107], v[220:223], v[80:95]
    v_exp_f32 v38, v38
    v_exp_f32 v39, v39
    v_exp_f32 v40, v40
    v_exp_f32 v41, v41
    v_mfma_f32_32x32x16_bf16 v[128:143], v[160:163], v[192:195], v[128:143]
    v_exp_f32 v42, v42
    v_exp_f32 v43, v43
    v_exp_f32 v44, v44
    v_exp_f32 v45, v45
    v_smfmac_f32_32x32x32_bf16 v[224:239], v[108:111], v[32:39], v124
    v_exp_f32 v46, v46
    v_exp_f32 v47, v47
    s_setprio 2
    s_waitcnt lgkmcnt(0)
    s_add_u32 m0, s79, 98304
    s_add_u32 s68, s77, 342016
    buffer_load_dwordx4 v210, s[36:39], s68 offen offset:2048  lds
    ds_read_b128 v[100:103], v209 offset:36864
    ds_read_b64_tr_b16 v[200:201], v212 offset:2048
    ds_read_b64_tr_b16 v[202:203], v212 offset:2560
    ds_read_b64_tr_b16 v[204:205], v213 offset:2048
    ds_read_b64_tr_b16 v[206:207], v213 offset:2560
.p2align 3
    v_exp_f32 v16, v16
    v_exp_f32 v17, v17
    v_smfmac_f32_32x32x32_bf16 v[224:239], v[112:115], v[40:47], v124
    v_exp_f32 v18, v18
    v_exp_f32 v19, v19
    v_exp_f32 v20, v20
    v_exp_f32 v21, v21
    v_mfma_f32_32x32x16_bf16 v[32:47], v[104:107], v[96:99], v[48:63]
    v_exp_f32 v22, v22
    v_exp_f32 v23, v23
    v_exp_f32 v24, v24
    v_exp_f32 v25, v25
    v_mfma_f32_32x32x16_bf16 v[144:159], v[160:163], v[196:199], v[144:159]
    v_exp_f32 v26, v26
    v_exp_f32 v27, v27
    v_exp_f32 v28, v28
    v_exp_f32 v29, v29
    v_smfmac_f32_32x32x32_bf16 v[64:79], v[116:119], v[16:23], v124
    v_exp_f32 v30, v30
    v_exp_f32 v31, v31
    s_setprio 1
    s_waitcnt lgkmcnt(0)
    s_waitcnt vmcnt(5)
    s_add_u32 m0, s79, 98304
    s_add_u32 s68, s77, 349184
    buffer_load_dwordx4 v210, s[36:39], s68 offen offset:3072  lds
    s_mov_b64 exec, s[62:63]
    ds_read_b128 v[108:111], v211 offset:36864
    ds_read_b128 v[112:115], v211 offset:37376
    s_mov_b64 exec, -1
    ds_read_b64_tr_b16 v[192:193], v212 offset:4096
    ds_read_b64_tr_b16 v[194:195], v212 offset:4608
    s_add_u32 s69, s78, 20480
    buffer_load_dwordx4 v[176:179], v208, s[52:55], s69 offen offset:0 sc1
.p2align 3
    v_exp_f32 v32, v32
    v_exp_f32 v33, v33
    v_smfmac_f32_32x32x32_bf16 v[64:79], v[120:123], v[24:31], v124
    v_exp_f32 v34, v34
    v_exp_f32 v35, v35
    v_exp_f32 v36, v36
    v_exp_f32 v37, v37
    v_mfma_f32_32x32x16_bf16 v[16:31], v[100:103], v[220:223], v[80:95]
    v_exp_f32 v38, v38
    v_exp_f32 v39, v39
    v_exp_f32 v40, v40
    v_exp_f32 v41, v41
    v_mfma_f32_32x32x16_bf16 v[128:143], v[164:167], v[200:203], v[128:143]
    v_exp_f32 v42, v42
    v_exp_f32 v43, v43
    v_exp_f32 v44, v44
    v_exp_f32 v45, v45
    v_smfmac_f32_32x32x32_bf16 v[224:239], v[116:119], v[32:39], v124
    v_exp_f32 v46, v46
    v_exp_f32 v47, v47
    s_setprio 0
    s_waitcnt lgkmcnt(0)
    buffer_load_dwordx4 v[180:183], v208, s[52:55], s69 offen offset:1024 sc1
    ds_read_b128 v[104:107], v209 offset:40960
    ds_read_b64_tr_b16 v[196:197], v213 offset:4096
    ds_read_b64_tr_b16 v[198:199], v213 offset:4608
    buffer_load_dwordx4 v[184:187], v208, s[52:55], s69 offen offset:2048 sc1
.p2align 3
    v_exp_f32_e64 v16, v16
    v_smfmac_f32_32x32x32_bf16 v[224:239], v[120:123], v[40:47], v124
    v_exp_f32 v17, v17
    v_exp_f32 v18, v18
    s_setprio 3
    v_exp_f32 v19, v19
    v_mfma_f32_32x32x16_bf16 v[32:47], v[100:103], v[96:99], v[48:63]
    v_exp_f32 v20, v20
    v_exp_f32 v21, v21
    v_exp_f32_e64 v22, v22
    v_mfma_f32_32x32x16_bf16 v[144:159], v[164:167], v[204:207], v[144:159]
    v_exp_f32 v23, v23
    v_exp_f32 v24, v24
    v_exp_f32_e64 v25, v25
    v_smfmac_f32_32x32x32_bf16 v[64:79], v[108:111], v[16:23], v124
    v_exp_f32 v26, v26
    v_exp_f32 v27, v27
    v_exp_f32_e64 v28, v28
    v_mfma_f32_32x32x16_bf16 v[128:143], v[168:171], v[192:195], v[128:143]
    v_exp_f32 v29, v29
    v_exp_f32 v30, v30
    v_exp_f32 v31, v31
    s_setprio 2
    s_waitcnt lgkmcnt(0)
    buffer_load_dwordx4 v[188:191], v208, s[52:55], s69 offen offset:3072 sc1
    s_mov_b64 exec, s[62:63]
    ds_read_b128 v[116:119], v211 offset:40960
    ds_read_b128 v[120:123], v211 offset:41472
    s_mov_b64 exec, -1
    ds_read_b64_tr_b16 v[200:201], v212 offset:6144
    ds_read_b64_tr_b16 v[202:203], v212 offset:6656
    ds_read_b64_tr_b16 v[204:205], v213 offset:6144
    ds_read_b64_tr_b16 v[206:207], v213 offset:6656
.p2align 3
    v_exp_f32 v32, v32
    v_exp_f32 v33, v33
    v_smfmac_f32_32x32x32_bf16 v[64:79], v[112:115], v[24:31], v124
    v_exp_f32 v34, v34
    v_exp_f32 v35, v35
    v_exp_f32 v36, v36
    v_exp_f32 v37, v37
    v_mfma_f32_32x32x16_bf16 v[16:31], v[104:107], v[220:223], v[80:95]
    v_exp_f32 v38, v38
    v_exp_f32 v39, v39
    v_exp_f32 v40, v40
    v_exp_f32 v41, v41
    v_mfma_f32_32x32x16_bf16 v[144:159], v[168:171], v[196:199], v[144:159]
    v_exp_f32 v42, v42
    v_exp_f32 v43, v43
    v_exp_f32 v44, v44
    v_exp_f32 v45, v45
    v_smfmac_f32_32x32x32_bf16 v[224:239], v[108:111], v[32:39], v124
    v_exp_f32 v46, v46
    v_exp_f32 v47, v47
    s_setprio 1
    s_waitcnt vmcnt(4) lgkmcnt(0)
    s_barrier
    s_add_u32 m0, s80, 16384
    s_add_u32 s68, s80, 118784
    buffer_load_dwordx4 v208, s[52:55], s68 offen sc1 lds
    ds_read_b128 v[100:103], v209 offset:0
    ds_read_b64_tr_b16 v[192:193], v212 offset:32768
    ds_read_b64_tr_b16 v[194:195], v212 offset:33280
    buffer_load_dwordx4 v208, s[52:55], s68 offen offset:1024 sc1 lds
.p2align 3
    v_exp_f32_e64 v16, v16
    v_smfmac_f32_32x32x32_bf16 v[224:239], v[112:115], v[40:47], v124
    v_exp_f32 v17, v17
    v_exp_f32 v18, v18
    v_exp_f32_e64 v19, v19
    v_mfma_f32_32x32x16_bf16 v[32:47], v[104:107], v[96:99], v[48:63]
    v_exp_f32 v20, v20
    v_exp_f32 v21, v21
    v_exp_f32_e64 v22, v22
    v_mfma_f32_32x32x16_bf16 v[128:143], v[172:175], v[200:203], v[128:143]
    v_exp_f32 v23, v23
    v_exp_f32 v24, v24
    v_exp_f32_e64 v25, v25
    v_smfmac_f32_32x32x32_bf16 v[64:79], v[116:119], v[16:23], v124
    v_exp_f32 v26, v26
    v_exp_f32 v27, v27
    v_exp_f32_e64 v28, v28
    v_mfma_f32_32x32x16_bf16 v[144:159], v[172:175], v[204:207], v[144:159]
    v_exp_f32 v29, v29
    v_exp_f32 v30, v30
    v_exp_f32 v31, v31
    s_setprio 0
    s_waitcnt lgkmcnt(0)
    s_waitcnt vmcnt(5)
    s_add_u32 m0, s79, 65536
    s_add_u32 s68, s77, 393216
    buffer_load_dwordx4 v210, s[36:39], s68 offen offset:0  lds
    s_mov_b64 exec, s[62:63]
    ds_read_b128 v[108:111], v211 offset:0
    ds_read_b128 v[112:115], v211 offset:512
    s_mov_b64 exec, -1
    ds_read_b64_tr_b16 v[196:197], v213 offset:32768
    ds_read_b64_tr_b16 v[198:199], v213 offset:33280
    s_add_u32 m0, s79, 65536
    s_add_u32 s68, s77, 400384
    buffer_load_dwordx4 v210, s[36:39], s68 offen offset:1024  lds
.p2align 3
    v_exp_f32 v32, v32
    v_exp_f32 v33, v33
    v_smfmac_f32_32x32x32_bf16 v[64:79], v[120:123], v[24:31], v124
    v_exp_f32 v34, v34
    s_setprio 3
    v_exp_f32 v35, v35
    v_exp_f32 v36, v36
    v_exp_f32_e64 v37, v37
    v_mfma_f32_32x32x16_bf16 v[16:31], v[100:103], v[220:223], v[80:95]
    v_exp_f32 v38, v38
    v_exp_f32 v39, v39
    v_exp_f32 v40, v40
    v_exp_f32 v41, v41
    v_mfma_f32_32x32x16_bf16 v[128:143], v[176:179], v[192:195], v[128:143]
    v_exp_f32 v42, v42
    v_exp_f32 v43, v43
    v_exp_f32 v44, v44
    v_exp_f32 v45, v45
    v_smfmac_f32_32x32x32_bf16 v[224:239], v[116:119], v[32:39], v124
    v_exp_f32 v46, v46
    v_exp_f32 v47, v47
    s_setprio 2
    s_waitcnt lgkmcnt(0)
    s_add_u32 m0, s79, 65536
    s_add_u32 s68, s77, 407552
    buffer_load_dwordx4 v210, s[36:39], s68 offen offset:2048  lds
    ds_read_b128 v[104:107], v209 offset:4096
    ds_read_b64_tr_b16 v[200:201], v212 offset:34816
    ds_read_b64_tr_b16 v[202:203], v212 offset:35328
    ds_read_b64_tr_b16 v[204:205], v213 offset:34816
    ds_read_b64_tr_b16 v[206:207], v213 offset:35328
.p2align 3
    v_exp_f32 v16, v16
    v_exp_f32 v17, v17
    v_smfmac_f32_32x32x32_bf16 v[224:239], v[120:123], v[40:47], v124
    v_exp_f32 v18, v18
    v_exp_f32 v19, v19
    v_exp_f32 v20, v20
    v_exp_f32 v21, v21
    v_mfma_f32_32x32x16_bf16 v[32:47], v[100:103], v[96:99], v[48:63]
    v_exp_f32 v22, v22
    v_exp_f32 v23, v23
    v_exp_f32 v24, v24
    v_exp_f32 v25, v25
    v_mfma_f32_32x32x16_bf16 v[144:159], v[176:179], v[196:199], v[144:159]
    v_exp_f32 v26, v26
    v_exp_f32 v27, v27
    v_exp_f32 v28, v28
    v_exp_f32 v29, v29
    v_smfmac_f32_32x32x32_bf16 v[64:79], v[108:111], v[16:23], v124
    v_exp_f32 v30, v30
    v_exp_f32 v31, v31
    s_setprio 1
    s_branch L_pg109
.p2align 12
L_stub109:
    s_nop 0
    s_setpc_b64 s[0:1]
L_pg109:
    s_waitcnt lgkmcnt(0)
    s_waitcnt vmcnt(5)
    s_add_u32 m0, s79, 65536
    s_add_u32 s68, s77, 414720
    buffer_load_dwordx4 v210, s[36:39], s68 offen offset:3072  lds
    s_mov_b64 exec, s[62:63]
    ds_read_b128 v[116:119], v211 offset:4096
    ds_read_b128 v[120:123], v211 offset:4608
    s_mov_b64 exec, -1
    ds_read_b64_tr_b16 v[192:193], v212 offset:36864
    ds_read_b64_tr_b16 v[194:195], v212 offset:37376
    s_add_u32 s69, s78, 24576
    buffer_load_dwordx4 v[160:163], v208, s[52:55], s69 offen offset:0 sc1
.p2align 3
    v_exp_f32 v32, v32
    v_exp_f32 v33, v33
    v_smfmac_f32_32x32x32_bf16 v[64:79], v[112:115], v[24:31], v124
    v_exp_f32 v34, v34
    v_exp_f32 v35, v35
    v_exp_f32 v36, v36
    v_exp_f32 v37, v37
    v_mfma_f32_32x32x16_bf16 v[16:31], v[104:107], v[220:223], v[80:95]
    v_exp_f32 v38, v38
    v_exp_f32 v39, v39
    v_exp_f32 v40, v40
    v_exp_f32 v41, v41
    v_mfma_f32_32x32x16_bf16 v[128:143], v[180:183], v[200:203], v[128:143]
    v_exp_f32 v42, v42
    v_exp_f32 v43, v43
    v_exp_f32 v44, v44
    v_exp_f32 v45, v45
    v_smfmac_f32_32x32x32_bf16 v[224:239], v[108:111], v[32:39], v124
    v_exp_f32 v46, v46
    v_exp_f32 v47, v47
    s_setprio 0
    s_waitcnt lgkmcnt(0)
    buffer_load_dwordx4 v[164:167], v208, s[52:55], s69 offen offset:1024 sc1
    ds_read_b128 v[100:103], v209 offset:8192
    ds_read_b64_tr_b16 v[196:197], v213 offset:36864
    ds_read_b64_tr_b16 v[198:199], v213 offset:37376
    buffer_load_dwordx4 v[168:171], v208, s[52:55], s69 offen offset:2048 sc1
.p2align 3
    v_exp_f32_e64 v16, v16
    v_smfmac_f32_32x32x32_bf16 v[224:239], v[112:115], v[40:47], v124
    v_exp_f32 v17, v17
    v_exp_f32 v18, v18
    s_setprio 3
    v_exp_f32 v19, v19
    v_mfma_f32_32x32x16_bf16 v[32:47], v[104:107], v[96:99], v[48:63]
    v_exp_f32 v20, v20
    v_exp_f32 v21, v21
    v_exp_f32_e64 v22, v22
    v_mfma_f32_32x32x16_bf16 v[144:159], v[180:183], v[204:207], v[144:159]
    v_exp_f32 v23, v23
    v_exp_f32 v24, v24
    v_exp_f32_e64 v25, v25
    v_smfmac_f32_32x32x32_bf16 v[64:79], v[116:119], v[16:23], v124
    v_exp_f32 v26, v26
    v_exp_f32 v27, v27
    v_exp_f32_e64 v28, v28
    v_mfma_f32_32x32x16_bf16 v[128:143], v[184:187], v[192:195], v[128:143]
    v_exp_f32 v29, v29
    v_exp_f32 v30, v30
    v_exp_f32 v31, v31
    s_setprio 2
    s_waitcnt lgkmcnt(0)
    buffer_load_dwordx4 v[172:175], v208, s[52:55], s69 offen offset:3072 sc1
    s_mov_b64 exec, s[62:63]
    ds_read_b128 v[108:111], v211 offset:8192
    ds_read_b128 v[112:115], v211 offset:8704
    s_mov_b64 exec, -1
    ds_read_b64_tr_b16 v[200:201], v212 offset:38912
    ds_read_b64_tr_b16 v[202:203], v212 offset:39424
    ds_read_b64_tr_b16 v[204:205], v213 offset:38912
    ds_read_b64_tr_b16 v[206:207], v213 offset:39424
.p2align 3
    v_exp_f32 v32, v32
    v_exp_f32 v33, v33
    v_smfmac_f32_32x32x32_bf16 v[64:79], v[120:123], v[24:31], v124
    v_exp_f32 v34, v34
    v_exp_f32 v35, v35
    v_exp_f32 v36, v36
    v_exp_f32 v37, v37
    v_mfma_f32_32x32x16_bf16 v[16:31], v[100:103], v[220:223], v[80:95]
    v_exp_f32 v38, v38
    v_exp_f32 v39, v39
    v_exp_f32 v40, v40
    v_exp_f32 v41, v41
    v_mfma_f32_32x32x16_bf16 v[144:159], v[184:187], v[196:199], v[144:159]
    v_exp_f32 v42, v42
    v_exp_f32 v43, v43
    v_exp_f32 v44, v44
    v_exp_f32 v45, v45
    v_smfmac_f32_32x32x32_bf16 v[224:239], v[116:119], v[32:39], v124
    v_exp_f32 v46, v46
    v_exp_f32 v47, v47
    s_setprio 1
    s_waitcnt vmcnt(4) lgkmcnt(0)
    s_barrier
    s_add_u32 m0, s79, 98304
    s_add_u32 s68, s82, 0
    buffer_load_dwordx4 v210, s[40:43], s68 offen offset:0  lds
    ds_read_b128 v[104:107], v209 offset:16384
    ds_read_b64_tr_b16 v[192:193], v212 offset:0
    ds_read_b64_tr_b16 v[194:195], v212 offset:512
    s_add_u32 m0, s79, 98304
    s_add_u32 s68, s82, 7168
    buffer_load_dwordx4 v210, s[40:43], s68 offen offset:1024  lds
.p2align 3
    v_exp_f32_e64 v16, v16
    v_smfmac_f32_32x32x32_bf16 v[224:239], v[120:123], v[40:47], v124
    v_exp_f32 v17, v17
    v_exp_f32 v18, v18
    v_exp_f32_e64 v19, v19
    v_mfma_f32_32x32x16_bf16 v[32:47], v[100:103], v[96:99], v[48:63]
    v_exp_f32 v20, v20
    v_exp_f32 v21, v21
    v_exp_f32_e64 v22, v22
    v_mfma_f32_32x32x16_bf16 v[128:143], v[188:191], v[200:203], v[128:143]
    v_exp_f32 v23, v23
    v_exp_f32 v24, v24
    v_exp_f32_e64 v25, v25
    v_smfmac_f32_32x32x32_bf16 v[64:79], v[108:111], v[16:23], v124
    v_exp_f32 v26, v26
    v_exp_f32 v27, v27
    v_exp_f32_e64 v28, v28
    v_mfma_f32_32x32x16_bf16 v[144:159], v[188:191], v[204:207], v[144:159]
    v_exp_f32 v29, v29
    v_exp_f32 v30, v30
    v_exp_f32 v31, v31
    s_setprio 0
    s_waitcnt lgkmcnt(0)
    s_waitcnt vmcnt(5)
    s_add_u32 m0, s79, 98304
    s_add_u32 s68, s82, 14336
    buffer_load_dwordx4 v210, s[40:43], s68 offen offset:2048  lds
    s_mov_b64 exec, s[62:63]
    ds_read_b128 v[116:119], v211 offset:16384
    ds_read_b128 v[120:123], v211 offset:16896
    s_mov_b64 exec, -1
    ds_read_b64_tr_b16 v[196:197], v213 offset:0
    ds_read_b64_tr_b16 v[198:199], v213 offset:512
    s_add_u32 m0, s79, 98304
    s_add_u32 s68, s82, 21504
    buffer_load_dwordx4 v210, s[40:43], s68 offen offset:3072  lds
.p2align 3
    v_exp_f32 v32, v32
    v_exp_f32 v33, v33
    v_smfmac_f32_32x32x32_bf16 v[64:79], v[112:115], v[24:31], v124
    v_exp_f32 v34, v34
    s_setprio 3
    v_exp_f32 v35, v35
    v_exp_f32 v36, v36
    v_exp_f32_e64 v37, v37
    v_mfma_f32_32x32x16_bf16 v[16:31], v[104:107], v[220:223], v[80:95]
    v_exp_f32 v38, v38
    v_exp_f32 v39, v39
    v_exp_f32 v40, v40
    v_exp_f32 v41, v41
    v_mfma_f32_32x32x16_bf16 v[128:143], v[160:163], v[192:195], v[128:143]
    v_exp_f32 v42, v42
    v_exp_f32 v43, v43
    v_exp_f32 v44, v44
    v_exp_f32 v45, v45
    v_smfmac_f32_32x32x32_bf16 v[224:239], v[108:111], v[32:39], v124
    v_exp_f32 v46, v46
    v_exp_f32 v47, v47
    s_setprio 2
    s_waitcnt lgkmcnt(0)
    buffer_load_dwordx4 v[216:219], v215, s[28:31], 0 offen
    ds_read_b128 v[100:103], v209 offset:20480
    ds_read_b64_tr_b16 v[200:201], v212 offset:2048
    ds_read_b64_tr_b16 v[202:203], v212 offset:2560
    ds_read_b64_tr_b16 v[204:205], v213 offset:2048
    ds_read_b64_tr_b16 v[206:207], v213 offset:2560
.p2align 3
    v_exp_f32 v16, v16
    v_exp_f32 v17, v17
    v_smfmac_f32_32x32x32_bf16 v[224:239], v[112:115], v[40:47], v124
    v_exp_f32 v18, v18
    v_exp_f32 v19, v19
    v_exp_f32 v20, v20
    v_exp_f32 v21, v21
    v_mfma_f32_32x32x16_bf16 v[32:47], v[104:107], v[96:99], v[48:63]
    v_exp_f32 v22, v22
    v_exp_f32 v23, v23
    v_exp_f32 v24, v24
    v_exp_f32 v25, v25
    v_mfma_f32_32x32x16_bf16 v[144:159], v[160:163], v[196:199], v[144:159]
    v_exp_f32 v26, v26
    v_exp_f32 v27, v27
    v_exp_f32 v28, v28
    v_exp_f32 v29, v29
    v_smfmac_f32_32x32x32_bf16 v[64:79], v[116:119], v[16:23], v124
    v_exp_f32 v30, v30
    v_exp_f32 v31, v31
    s_setprio 1
    s_waitcnt lgkmcnt(0)
    s_waitcnt vmcnt(5)
    ds_read_b128 v[104:107], v209 offset:24576
    s_mov_b64 exec, s[62:63]
    ds_read_b128 v[108:111], v211 offset:20480
    ds_read_b128 v[112:115], v211 offset:20992
    s_mov_b64 exec, -1
    ds_read_b64_tr_b16 v[192:193], v212 offset:4096
    ds_read_b64_tr_b16 v[194:195], v212 offset:4608
.p2align 3
    v_exp_f32 v32, v32
    v_exp_f32 v33, v33
    v_smfmac_f32_32x32x32_bf16 v[64:79], v[120:123], v[24:31], v124
    v_exp_f32 v34, v34
    v_exp_f32 v35, v35
    v_exp_f32 v36, v36
    v_exp_f32 v37, v37
    v_mfma_f32_32x32x16_bf16 v[16:31], v[100:103], v[96:99], v[48:63]
    v_exp_f32 v38, v38
    v_exp_f32 v39, v39
    v_exp_f32 v40, v40
    v_exp_f32 v41, v41
    v_mfma_f32_32x32x16_bf16 v[128:143], v[164:167], v[200:203], v[128:143]
    v_exp_f32 v42, v42
    v_exp_f32 v43, v43
    v_exp_f32 v44, v44
    v_exp_f32 v45, v45
    v_smfmac_f32_32x32x32_bf16 v[224:239], v[116:119], v[32:39], v124
    v_exp_f32 v46, v46
    v_exp_f32 v47, v47
    s_setprio 0
    s_waitcnt lgkmcnt(0)
    s_mov_b64 exec, s[62:63]
    ds_read_b128 v[116:119], v211 offset:24576
    s_mov_b64 exec, -1
    ds_read_b64_tr_b16 v[196:197], v213 offset:4096
    ds_read_b64_tr_b16 v[198:199], v213 offset:4608
.p2align 3
    v_exp_f32_e64 v16, v16
    v_smfmac_f32_32x32x32_bf16 v[224:239], v[120:123], v[40:47], v124
    v_exp_f32 v17, v17
    v_exp_f32 v18, v18
    s_setprio 3
    v_exp_f32 v19, v19
    v_mfma_f32_32x32x16_bf16 v[32:47], v[104:107], v[96:99], v[48:63]
    v_exp_f32 v20, v20
    v_exp_f32 v21, v21
    v_exp_f32_e64 v22, v22
    v_mfma_f32_32x32x16_bf16 v[144:159], v[164:167], v[204:207], v[144:159]
    v_exp_f32 v23, v23
    v_exp_f32 v24, v24
    v_exp_f32_e64 v25, v25
    v_smfmac_f32_32x32x32_bf16 v[224:239], v[108:111], v[16:23], v124
    v_exp_f32 v26, v26
    v_exp_f32 v27, v27
    v_exp_f32_e64 v28, v28
    v_mfma_f32_32x32x16_bf16 v[128:143], v[168:171], v[192:195], v[128:143]
    v_exp_f32 v29, v29
    v_exp_f32 v30, v30
    v_exp_f32 v31, v31
    s_setprio 2
    s_waitcnt lgkmcnt(0)
    s_mov_b64 exec, s[62:63]
    ds_read_b128 v[120:123], v211 offset:25088
    s_mov_b64 exec, -1
    ds_read_b64_tr_b16 v[200:201], v212 offset:6144
    ds_read_b64_tr_b16 v[202:203], v212 offset:6656
    ds_read_b64_tr_b16 v[204:205], v213 offset:6144
    ds_read_b64_tr_b16 v[206:207], v213 offset:6656
.p2align 3
    v_exp_f32 v32, v32
    v_exp_f32 v33, v33
    v_smfmac_f32_32x32x32_bf16 v[224:239], v[112:115], v[24:31], v124
    v_exp_f32_e64 v34, v34
    v_lshrrev_b32_e64 v3, 1, v125
    v_exp_f32 v35, v35
    v_exp_f32 v36, v36
    v_exp_f32_e64 v37, v37
    v_mfma_f32_32x32x16_bf16 v[16:31], v[100:103], v[220:223], v[80:95]
    v_exp_f32 v38, v38
    v_exp_f32 v39, v39
    v_exp_f32 v40, v40
    v_exp_f32 v41, v41
    v_mfma_f32_32x32x16_bf16 v[144:159], v[168:171], v[196:199], v[144:159]
    v_exp_f32 v42, v42
    v_exp_f32 v43, v43
    v_exp_f32 v44, v44
    v_exp_f32 v45, v45
    v_smfmac_f32_32x32x32_bf16 v[224:239], v[116:119], v[32:39], v124
    v_exp_f32 v46, v46
    v_exp_f32 v47, v47
    s_setprio 1
    s_waitcnt lgkmcnt(0)
.p2align 3
    v_exp_f32_e64 v16, v16
    v_smfmac_f32_32x32x32_bf16 v[224:239], v[120:123], v[40:47], v124
    v_exp_f32 v17, v17
    v_exp_f32 v18, v18
    v_exp_f32_e64 v19, v19
    v_mfma_f32_32x32x16_bf16 v[32:47], v[104:107], v[220:223], v[80:95]
    v_exp_f32 v20, v20
    v_exp_f32 v21, v21
    v_exp_f32_e64 v22, v22
    v_mfma_f32_32x32x16_bf16 v[128:143], v[172:175], v[200:203], v[128:143]
    v_exp_f32 v23, v23
    v_exp_f32 v24, v24
    v_exp_f32_e64 v25, v25
    v_smfmac_f32_32x32x32_bf16 v[64:79], v[108:111], v[16:23], v124
    v_exp_f32 v26, v26
    v_exp_f32 v27, v27
    v_exp_f32_e64 v28, v28
    v_mfma_f32_32x32x16_bf16 v[144:159], v[172:175], v[204:207], v[144:159]
    v_exp_f32 v29, v29
    v_exp_f32 v30, v30
    v_exp_f32 v31, v31
    s_setprio 0
    s_waitcnt lgkmcnt(0)
    ds_write_b128 v125, v[224:227] offset:0
    ds_write_b128 v125, v[228:231] offset:1024
    ds_write_b32 v3, v232 offset:28672
.p2align 3
    v_exp_f32 v32, v32
    v_exp_f32 v33, v33
    v_smfmac_f32_32x32x32_bf16 v[64:79], v[112:115], v[24:31], v124
    v_exp_f32 v34, v34
    s_setprio 3
    v_exp_f32 v35, v35
    v_exp_f32 v36, v36
    v_exp_f32 v37, v37
    v_exp_f32 v38, v38
    v_exp_f32 v39, v39
    v_exp_f32 v40, v40
    v_exp_f32 v41, v41
    v_exp_f32 v42, v42
    v_exp_f32_e64 v43, v43
    v_smfmac_f32_32x32x32_bf16 v[64:79], v[116:119], v[32:39], v124
    v_exp_f32 v44, v44
    v_exp_f32 v45, v45
    v_exp_f32 v46, v46
    v_exp_f32 v47, v47
    s_setprio 0
    s_waitcnt vmcnt(0) lgkmcnt(0)
    s_barrier
    ds_read_b128 v[192:195], v125 offset:8192
    ds_read_b128 v[196:199], v125 offset:9216
    ds_read_b32 v200, v3 offset:28676
    v_smfmac_f32_32x32x32_bf16 v[64:79], v[120:123], v[40:47], v124
    s_mov_b32 s70, 0x7b800000
    s_mov_b32 s71, 0xa800000
    s_add_u32 s69, s83, 4096
    s_mov_b32 s81, 0
    s_lshl_b32 s68, s56, 13
    s_mov_b32 m0, s68
    s_waitcnt lgkmcnt(0)
    s_nop 4
    v_add_f32 v72, v72, v200
    v_add_f32 v64, v64, v192
    v_add_f32 v65, v65, v193
    v_add_f32 v66, v66, v194
    v_add_f32 v67, v67, v195
    v_add_f32 v68, v68, v196
    v_add_f32 v69, v69, v197
    v_add_f32 v70, v70, v198
    v_add_f32 v71, v71, v199
    v_rcp_f32 v10, v72
    v_maximum3_f32 v8, abs(v64), abs(v65), abs(v66)
    v_maximum3_f32 v9, abs(v67), abs(v68), abs(v69)
    v_maximum3_f32 v8, abs(v70), abs(v71), v8
    v_maximum3_f32 v6, v8, v9, v72
    v_max_f32 v8, v8, v9
    v_cmp_ngt_f32 vcc, s70, v6
    v_cmp_gt_f32 s[84:85], s71, v8
    v_mov_b32 v11, v10
    s_or_b64 vcc, vcc, s[84:85]
    s_cbranch_scc1 L_fb
    v_pk_mul_f32 v[64:65], v[64:65], v[10:11]
    v_pk_mul_f32 v[66:67], v[66:67], v[10:11]
    v_pk_mul_f32 v[68:69], v[68:69], v[10:11]
    v_pk_mul_f32 v[70:71], v[70:71], v[10:11]
    v_cvt_pk_bf16_f32 v12, v64, v65
    v_cvt_pk_bf16_f32 v13, v66, v67
    v_cvt_pk_bf16_f32 v14, v68, v69
    v_cvt_pk_bf16_f32 v15, v70, v71
L_ostA:
    buffer_store_dwordx4 v[12:15], v208, s[52:55], s72 offen sc1
    ds_read_b64_tr_b16 v[240:241], v126 offset:0
    ds_read_b64_tr_b16 v[242:243], v126 offset:512
    ds_read_b64_tr_b16 v[244:245], v127 offset:0
    ds_read_b64_tr_b16 v[246:247], v127 offset:512
    ds_read_b64_tr_b16 v[248:249], v126 offset:2048
    ds_read_b64_tr_b16 v[250:251], v126 offset:2560
    ds_read_b64_tr_b16 v[176:177], v127 offset:2048
    ds_read_b64_tr_b16 v[178:179], v127 offset:2560
    ds_read_b64_tr_b16 v[180:181], v126 offset:8192
    ds_read_b64_tr_b16 v[182:183], v126 offset:8704
    ds_read_b64_tr_b16 v[184:185], v127 offset:8192
    ds_read_b64_tr_b16 v[186:187], v127 offset:8704
    ds_read_b64_tr_b16 v[188:189], v126 offset:10240
    ds_read_b64_tr_b16 v[190:191], v126 offset:10752
    ds_read_b64_tr_b16 v[160:161], v127 offset:10240
    ds_read_b64_tr_b16 v[162:163], v127 offset:10752
    ds_read_b64_tr_b16 v[48:49], v126 offset:4096
    ds_read_b64_tr_b16 v[50:51], v126 offset:4608
    ds_read_b64_tr_b16 v[52:53], v127 offset:4096
    ds_read_b64_tr_b16 v[54:55], v127 offset:4608
    ds_read_b64_tr_b16 v[164:165], v126 offset:6144
    ds_read_b64_tr_b16 v[166:167], v126 offset:6656
    ds_read_b64_tr_b16 v[56:57], v127 offset:6144
    ds_read_b64_tr_b16 v[58:59], v127 offset:6656
    ds_read_b64_tr_b16 v[60:61], v126 offset:12288
    ds_read_b64_tr_b16 v[62:63], v126 offset:12800
    ds_read_b64_tr_b16 v[168:169], v127 offset:12288
    ds_read_b64_tr_b16 v[170:171], v127 offset:12800
    ds_read_b64_tr_b16 v[96:97], v126 offset:14336
    ds_read_b64_tr_b16 v[98:99], v126 offset:14848
    ds_read_b64_tr_b16 v[172:173], v127 offset:14336
    ds_read_b64_tr_b16 v[174:175], v127 offset:14848
    ds_write_addtid_b32 v128 offset:32768
    ds_write_addtid_b32 v129 offset:33024
    ds_write_addtid_b32 v130 offset:33280
    ds_write_addtid_b32 v131 offset:33536
    ds_write_addtid_b32 v132 offset:33792
    ds_write_addtid_b32 v133 offset:34048
    ds_write_addtid_b32 v134 offset:34304
    ds_write_addtid_b32 v135 offset:34560
    ds_write_addtid_b32 v136 offset:34816
    ds_write_addtid_b32 v137 offset:35072
    ds_write_addtid_b32 v138 offset:35328
    ds_write_addtid_b32 v139 offset:35584
    ds_write_addtid_b32 v140 offset:35840
    ds_write_addtid_b32 v141 offset:36096
    ds_write_addtid_b32 v142 offset:36352
    ds_write_addtid_b32 v143 offset:36608
    ds_write_addtid_b32 v144 offset:36864
    ds_write_addtid_b32 v145 offset:37120
    ds_write_addtid_b32 v146 offset:37376
    ds_write_addtid_b32 v147 offset:37632
    ds_write_addtid_b32 v148 offset:37888
    ds_write_addtid_b32 v149 offset:38144
    ds_write_addtid_b32 v150 offset:38400
    ds_write_addtid_b32 v151 offset:38656
    ds_write_addtid_b32 v152 offset:38912
    ds_write_addtid_b32 v153 offset:39168
    ds_write_addtid_b32 v154 offset:39424
    ds_write_addtid_b32 v155 offset:39680
    ds_write_addtid_b32 v156 offset:39936
    ds_write_addtid_b32 v157 offset:40192
    ds_write_addtid_b32 v158 offset:40448
    ds_write_addtid_b32 v159 offset:40704
    v_xor_b32 v5, 16, v0
    v_add_u32 v6, 0x10000, v0
    v_add_u32 v7, 0x10000, v5
    s_mov_b32 s84, 0xff00ff00
    s_mov_b32 s85, 0xff00ff00
    s_mov_b64 exec, s[84:85]
    v_swap_b32 v216, v218
    v_swap_b32 v217, v219
    s_mov_b64 exec, -1
    v_lshlrev_b32 v224, 16, v216
    v_and_b32 v225, 0xffff0000, v216
    v_lshlrev_b32 v226, 16, v217
    v_and_b32 v227, 0xffff0000, v217
    v_lshlrev_b32 v228, 16, v218
    v_and_b32 v229, 0xffff0000, v218
    v_lshlrev_b32 v230, 16, v219
    v_and_b32 v231, 0xffff0000, v219
    v_mov_b64 v[64:65], 0
    v_mov_b64 v[66:67], 0
    v_mov_b64 v[68:69], 0
    v_mov_b64 v[70:71], 0
    v_mov_b64 v[72:73], 0
    v_mov_b64 v[74:75], 0
    v_mov_b64 v[76:77], 0
    v_mov_b64 v[78:79], 0
    v_mov_b64 v[80:81], 0
    v_mov_b64 v[82:83], 0
    v_mov_b64 v[84:85], 0
    v_mov_b64 v[86:87], 0
    v_mov_b64 v[88:89], 0
    v_mov_b64 v[90:91], 0
    v_mov_b64 v[92:93], 0
    v_mov_b64 v[94:95], 0
    s_waitcnt lgkmcnt(0)
    s_barrier
    buffer_load_dwordx4 v[16:19], v208, s[52:55], s83 offen offset:0 sc1
    ds_read_b128 v[128:131], v0 offset:32768
    buffer_load_dwordx4 v[20:23], v208, s[52:55], s83 offen offset:1024 sc1
    ds_read_b128 v[132:135], v5 offset:32768
    buffer_load_dwordx4 v[24:27], v208, s[52:55], s69 offen offset:0 sc1
    ds_read_b128 v[136:139], v0 offset:49152
    buffer_load_dwordx4 v[28:31], v208, s[52:55], s69 offen offset:1024 sc1
    ds_read_b128 v[140:143], v5 offset:49152
    buffer_load_dwordx4 v[32:35], v208, s[52:55], s83 offen offset:2048 sc1
    ds_read_b128 v[144:147], v6 offset:0
    buffer_load_dwordx4 v[36:39], v208, s[52:55], s83 offen offset:3072 sc1
    ds_read_b128 v[148:151], v7 offset:0
    buffer_load_dwordx4 v[40:43], v208, s[52:55], s69 offen offset:2048 sc1
    ds_read_b128 v[152:155], v6 offset:16384
    buffer_load_dwordx4 v[44:47], v208, s[52:55], s69 offen offset:3072 sc1
    ds_read_b128 v[156:159], v7 offset:16384
    s_waitcnt vmcnt(7)
    v_max3_u32 v8, v16, v17, v18
    v_max_u32 v8, v19, v8
    v_cmp_eq_u32 vcc, -1, v8
    s_movk_i32 s88, 255
    s_cbranch_vccnz L_omissA
    v_mfma_f32_32x32x16_bf16 v[64:79], v[16:19], v[240:243], v[64:79]
    s_waitcnt vmcnt(6)
    v_max3_u32 v8, v20, v21, v22
    v_max_u32 v8, v23, v8
    v_cmp_eq_u32 vcc, -1, v8
    s_movk_i32 s88, 254
    v_mfma_f32_32x32x16_bf16 v[80:95], v[16:19], v[244:247], v[80:95]
    s_cbranch_vccnz L_omissA
    v_mfma_f32_32x32x16_bf16 v[64:79], v[20:23], v[248:251], v[64:79]
    s_waitcnt vmcnt(5)
    v_max3_u32 v8, v24, v25, v26
    v_max_u32 v8, v27, v8
    v_cmp_eq_u32 vcc, -1, v8
    s_movk_i32 s88, 252
    v_mfma_f32_32x32x16_bf16 v[80:95], v[20:23], v[176:179], v[80:95]
    s_cbranch_vccnz L_omissA
    v_mfma_f32_32x32x16_bf16 v[64:79], v[24:27], v[180:183], v[64:79]
    s_waitcnt vmcnt(4)
    v_max3_u32 v8, v28, v29, v30
    v_max_u32 v8, v31, v8
    v_cmp_eq_u32 vcc, -1, v8
    s_movk_i32 s88, 248
    v_mfma_f32_32x32x16_bf16 v[80:95], v[24:27], v[184:187], v[80:95]
    s_cbranch_vccnz L_omissA
    v_mfma_f32_32x32x16_bf16 v[64:79], v[28:31], v[188:191], v[64:79]
    s_waitcnt vmcnt(3)
    v_max3_u32 v8, v32, v33, v34
    v_max_u32 v8, v35, v8
    v_cmp_eq_u32 vcc, -1, v8
    s_movk_i32 s88, 240
    v_mfma_f32_32x32x16_bf16 v[80:95], v[28:31], v[160:163], v[80:95]
    s_cbranch_vccnz L_omissA
    v_mfma_f32_32x32x16_bf16 v[64:79], v[32:35], v[48:51], v[64:79]
    s_waitcnt vmcnt(2)
    v_max3_u32 v8, v36, v37, v38
    v_max_u32 v8, v39, v8
    v_cmp_eq_u32 vcc, -1, v8
    s_movk_i32 s88, 224
    v_mfma_f32_32x32x16_bf16 v[80:95], v[32:35], v[52:55], v[80:95]
    s_cbranch_vccnz L_omissA
    v_mfma_f32_32x32x16_bf16 v[64:79], v[36:39], v[164:167], v[64:79]
    s_waitcnt vmcnt(1)
    v_max3_u32 v8, v40, v41, v42
    v_max_u32 v8, v43, v8
    v_cmp_eq_u32 vcc, -1, v8
    s_movk_i32 s88, 192
    v_mfma_f32_32x32x16_bf16 v[80:95], v[36:39], v[56:59], v[80:95]
    s_cbranch_vccnz L_omissA
    v_mfma_f32_32x32x16_bf16 v[64:79], v[40:43], v[60:63], v[64:79]
    s_waitcnt vmcnt(0)
    v_max3_u32 v8, v44, v45, v46
    v_max_u32 v8, v47, v8
    v_cmp_eq_u32 vcc, -1, v8
    s_movk_i32 s88, 128
    v_mfma_f32_32x32x16_bf16 v[80:95], v[40:43], v[168:171], v[80:95]
    s_cbranch_vccnz L_omissA
    v_mfma_f32_32x32x16_bf16 v[64:79], v[44:47], v[96:99], v[64:79]
    v_mfma_f32_32x32x16_bf16 v[80:95], v[44:47], v[172:175], v[80:95]
L_ookA:
    s_nop 10
    ds_write_addtid_b32 v64 offset:0
    ds_write_addtid_b32 v65 offset:256
    ds_write_addtid_b32 v66 offset:512
    ds_write_addtid_b32 v67 offset:768
    ds_write_addtid_b32 v68 offset:1024
    ds_write_addtid_b32 v69 offset:1280
    ds_write_addtid_b32 v70 offset:1536
    ds_write_addtid_b32 v71 offset:1792
    ds_write_addtid_b32 v72 offset:2048
    ds_write_addtid_b32 v73 offset:2304
    ds_write_addtid_b32 v74 offset:2560
    ds_write_addtid_b32 v75 offset:2816
    ds_write_addtid_b32 v76 offset:3072
    ds_write_addtid_b32 v77 offset:3328
    ds_write_addtid_b32 v78 offset:3584
    ds_write_addtid_b32 v79 offset:3840
    ds_write_addtid_b32 v80 offset:4096
    ds_write_addtid_b32 v81 offset:4352
    ds_write_addtid_b32 v82 offset:4608
    ds_write_addtid_b32 v83 offset:4864
    ds_write_addtid_b32 v84 offset:5120
    ds_write_addtid_b32 v85 offset:5376
    ds_write_addtid_b32 v86 offset:5632
    ds_write_addtid_b32 v87 offset:5888
    ds_write_addtid_b32 v88 offset:6144
    ds_write_addtid_b32 v89 offset:6400
    ds_write_addtid_b32 v90 offset:6656
    ds_write_addtid_b32 v91 offset:6912
    ds_write_addtid_b32 v92 offset:7168
    ds_write_addtid_b32 v93 offset:7424
    ds_write_addtid_b32 v94 offset:7680
    ds_write_addtid_b32 v95 offset:7936
    s_waitcnt lgkmcnt(0)
    v_add_f32 v128, v128, v136
    v_add_f32 v129, v129, v137
    v_add_f32 v130, v130, v138
    v_add_f32 v131, v131, v139
    v_add_f32 v132, v132, v140
    v_add_f32 v133, v133, v141
    v_add_f32 v134, v134, v142
    v_add_f32 v135, v135, v143
    v_add_f32 v128, v128, v144
    v_add_f32 v129, v129, v145
    v_add_f32 v130, v130, v146
    v_add_f32 v131, v131, v147
    v_add_f32 v132, v132, v148
    v_add_f32 v133, v133, v149
    v_add_f32 v134, v134, v150
    v_add_f32 v135, v135, v151
    v_add_f32 v128, v128, v152
    v_add_f32 v129, v129, v153
    v_add_f32 v130, v130, v154
    v_add_f32 v131, v131, v155
    v_add_f32 v132, v132, v156
    v_add_f32 v133, v133, v157
    v_add_f32 v134, v134, v158
    v_add_f32 v135, v135, v159
    v_mul_f32 v232, 0xbfb8aa3b, v128
    v_mul_f32 v233, 0xbfb8aa3b, v129
    v_mul_f32 v234, 0xbfb8aa3b, v130
    v_mul_f32 v235, 0xbfb8aa3b, v131
    v_mul_f32 v236, 0xbfb8aa3b, v132
    v_mul_f32 v237, 0xbfb8aa3b, v133
    v_mul_f32 v238, 0xbfb8aa3b, v134
    v_mul_f32 v239, 0xbfb8aa3b, v135
    v_exp_f32 v232, v232
    v_exp_f32 v233, v233
    v_exp_f32 v234, v234
    v_exp_f32 v235, v235
    v_exp_f32 v236, v236
    v_exp_f32 v237, v237
    v_exp_f32 v238, v238
    v_exp_f32 v239, v239
    v_add_f32 v232, 1.0, v232
    v_add_f32 v233, 1.0, v233
    v_add_f32 v234, 1.0, v234
    v_add_f32 v235, 1.0, v235
    v_add_f32 v236, 1.0, v236
    v_add_f32 v237, 1.0, v237
    v_add_f32 v238, 1.0, v238
    v_add_f32 v239, 1.0, v239
    v_rcp_f32 v232, v232
    v_rcp_f32 v233, v233
    v_rcp_f32 v234, v234
    v_rcp_f32 v235, v235
    v_rcp_f32 v236, v236
    v_rcp_f32 v237, v237
    v_rcp_f32 v238, v238
    v_rcp_f32 v239, v239
    v_mul_f32 v128, v128, v232
    v_mul_f32 v129, v129, v233
    v_mul_f32 v130, v130, v234
    v_mul_f32 v131, v131, v235
    v_mul_f32 v132, v132, v236
    v_mul_f32 v133, v133, v237
    v_mul_f32 v134, v134, v238
    v_mul_f32 v135, v135, v239
    s_branch L_fin2
.p2align 6
L_stubL_attB:
    s_nop 0
    s_setpc_b64 s[0:1]
L_attB:
    s_waitcnt lgkmcnt(0)
    ds_read_b128 v[104:107], v209 offset:22528
    s_setprio 3
.p2align 3
    v_exp_f32 v16, v16
    v_exp_f32 v17, v17
    v_exp_f32 v18, v18
    v_exp_f32 v19, v19
    v_exp_f32 v20, v20
    v_exp_f32 v21, v21
    v_mfma_f32_32x32x16_bf16 v[32:47], v[100:103], v[220:223], v[80:95]
    v_exp_f32 v22, v22
    v_exp_f32 v23, v23
    v_exp_f32 v24, v24
    v_exp_f32 v25, v25
    v_exp_f32 v26, v26
    v_exp_f32 v27, v27
    v_smfmac_f32_32x32x32_bf16 v[224:239], v[108:111], v[16:23], v124
    v_exp_f32 v28, v28
    v_exp_f32 v29, v29
    v_exp_f32 v30, v30
    v_exp_f32 v31, v31
    s_setprio 2
    s_branch L_pg121
.p2align 12
L_stub121:
    s_nop 0
    s_setpc_b64 s[0:1]
L_pg121:
    s_waitcnt lgkmcnt(0)
    s_mov_b64 exec, s[62:63]
    ds_read_b128 v[116:119], v211 offset:22528
    ds_read_b128 v[120:123], v211 offset:23040
    s_mov_b64 exec, -1
.p2align 3
    v_exp_f32 v32, v32
    v_exp_f32 v33, v33
    v_smfmac_f32_32x32x32_bf16 v[224:239], v[112:115], v[24:31], v124
    v_exp_f32 v34, v34
    v_exp_f32 v35, v35
    v_exp_f32 v36, v36
    v_exp_f32 v37, v37
    v_mfma_f32_32x32x16_bf16 v[16:31], v[104:107], v[96:99], v[48:63]
    v_exp_f32 v38, v38
    v_exp_f32 v39, v39
    v_exp_f32 v40, v40
    v_exp_f32 v41, v41
    v_exp_f32 v42, v42
    v_exp_f32 v43, v43
    v_smfmac_f32_32x32x32_bf16 v[64:79], v[108:111], v[32:39], v124
    v_exp_f32 v44, v44
    v_exp_f32 v45, v45
    v_exp_f32 v46, v46
    v_exp_f32 v47, v47
    s_setprio 1
    s_waitcnt lgkmcnt(0)
    ds_read_b128 v[100:103], v209 offset:26624
.p2align 3
    v_exp_f32 v16, v16
    v_exp_f32 v17, v17
    v_smfmac_f32_32x32x32_bf16 v[64:79], v[112:115], v[40:47], v124
    v_exp_f32 v18, v18
    v_exp_f32 v19, v19
    v_exp_f32 v20, v20
    v_exp_f32 v21, v21
    v_mfma_f32_32x32x16_bf16 v[32:47], v[104:107], v[220:223], v[80:95]
    v_exp_f32 v22, v22
    v_exp_f32 v23, v23
    v_exp_f32 v24, v24
    v_exp_f32 v25, v25
    v_exp_f32 v26, v26
    v_exp_f32 v27, v27
    v_smfmac_f32_32x32x32_bf16 v[224:239], v[116:119], v[16:23], v124
    v_exp_f32 v28, v28
    v_exp_f32 v29, v29
    v_exp_f32 v30, v30
    v_exp_f32 v31, v31
    s_waitcnt lgkmcnt(0)
    s_mov_b64 exec, s[62:63]
    ds_read_b128 v[108:111], v211 offset:26624
    ds_read_b128 v[112:115], v211 offset:27136
    s_mov_b64 exec, -1
    s_setprio 3
.p2align 3
    v_exp_f32 v32, v32
    v_exp_f32 v33, v33
    v_smfmac_f32_32x32x32_bf16 v[224:239], v[120:123], v[24:31], v124
    v_exp_f32 v34, v34
    v_exp_f32 v35, v35
    v_exp_f32 v36, v36
    v_exp_f32 v37, v37
    v_mfma_f32_32x32x16_bf16 v[16:31], v[100:103], v[96:99], v[48:63]
    v_exp_f32 v38, v38
    v_exp_f32 v39, v39
    v_exp_f32 v40, v40
    v_exp_f32 v41, v41
    v_exp_f32 v42, v42
    v_exp_f32 v43, v43
    v_smfmac_f32_32x32x32_bf16 v[64:79], v[116:119], v[32:39], v124
    v_exp_f32 v44, v44
    v_exp_f32 v45, v45
    v_exp_f32 v46, v46
    v_exp_f32 v47, v47
    s_setprio 2
    s_waitcnt lgkmcnt(0)
    buffer_store_dwordx4 v[12:15], v208, s[52:55], s72 offen sc1
    ds_read_b128 v[104:107], v209 offset:30720
.p2align 3
    v_exp_f32 v16, v16
    v_exp_f32 v17, v17
    v_smfmac_f32_32x32x32_bf16 v[64:79], v[120:123], v[40:47], v124
    v_exp_f32 v18, v18
    v_exp_f32 v19, v19
    v_exp_f32 v20, v20
    v_exp_f32 v21, v21
    v_mfma_f32_32x32x16_bf16 v[32:47], v[100:103], v[220:223], v[80:95]
    v_exp_f32 v22, v22
    v_exp_f32 v23, v23
    v_exp_f32 v24, v24
    v_exp_f32 v25, v25
    v_exp_f32 v26, v26
    v_exp_f32 v27, v27
    v_smfmac_f32_32x32x32_bf16 v[224:239], v[108:111], v[16:23], v124
    v_exp_f32 v28, v28
    v_exp_f32 v29, v29
    v_exp_f32 v30, v30
    v_exp_f32 v31, v31
    s_setprio 1
    s_waitcnt lgkmcnt(0)
    s_mov_b64 exec, s[62:63]
    ds_read_b128 v[116:119], v211 offset:30720
    ds_read_b128 v[120:123], v211 offset:31232
    s_mov_b64 exec, -1
.p2align 3
    v_exp_f32 v32, v32
    v_exp_f32 v33, v33
    v_smfmac_f32_32x32x32_bf16 v[224:239], v[112:115], v[24:31], v124
    v_exp_f32 v34, v34
    s_waitcnt vmcnt(63) lgkmcnt(0)
    s_barrier
    v_exp_f32 v35, v35
    v_exp_f32 v36, v36
    v_exp_f32 v37, v37
    v_mfma_f32_32x32x16_bf16 v[16:31], v[104:107], v[96:99], v[48:63]
    v_exp_f32 v38, v38
    v_exp_f32 v39, v39
    v_exp_f32 v40, v40
    v_exp_f32 v41, v41
    v_exp_f32 v42, v42
    v_exp_f32 v43, v43
    v_smfmac_f32_32x32x32_bf16 v[64:79], v[108:111], v[32:39], v124
    v_exp_f32 v44, v44
    v_exp_f32 v45, v45
    v_exp_f32 v46, v46
    v_exp_f32 v47, v47
    s_waitcnt lgkmcnt(0)
    s_add_u32 m0, s80, 0
    s_add_u32 s68, s80, 32768
    s_cmp_ge_u32 s56, 6
    s_cselect_b32 s68, 16777216, s68
    buffer_load_dwordx4 v208, s[52:55], s68 offen sc1 lds
    ds_read_b128 v[100:103], v209 offset:34816
    buffer_load_dwordx4 v208, s[52:55], s68 offen offset:1024 sc1 lds
    s_setprio 3
.p2align 3
    v_exp_f32 v16, v16
    v_exp_f32 v17, v17
    v_smfmac_f32_32x32x32_bf16 v[64:79], v[112:115], v[40:47], v124
    v_exp_f32 v18, v18
    v_exp_f32 v19, v19
    v_exp_f32 v20, v20
    v_exp_f32 v21, v21
    v_mfma_f32_32x32x16_bf16 v[32:47], v[104:107], v[220:223], v[80:95]
    v_exp_f32 v22, v22
    v_exp_f32 v23, v23
    v_exp_f32 v24, v24
    v_exp_f32 v25, v25
    v_exp_f32 v26, v26
    v_exp_f32 v27, v27
    v_smfmac_f32_32x32x32_bf16 v[224:239], v[116:119], v[16:23], v124
    v_exp_f32 v28, v28
    v_exp_f32 v29, v29
    v_exp_f32 v30, v30
    v_exp_f32 v31, v31
    s_setprio 2
    s_waitcnt lgkmcnt(0)
    s_mov_b64 exec, s[62:63]
    ds_read_b128 v[108:111], v211 offset:34816
    ds_read_b128 v[112:115], v211 offset:35328
    s_mov_b64 exec, -1
.p2align 3
    v_exp_f32 v32, v32
    v_exp_f32 v33, v33
    v_smfmac_f32_32x32x32_bf16 v[224:239], v[120:123], v[24:31], v124
    v_exp_f32 v34, v34
    v_exp_f32 v35, v35
    v_exp_f32 v36, v36
    v_exp_f32 v37, v37
    v_mfma_f32_32x32x16_bf16 v[16:31], v[100:103], v[96:99], v[48:63]
    v_exp_f32 v38, v38
    v_exp_f32 v39, v39
    v_exp_f32 v40, v40
    v_exp_f32 v41, v41
    v_exp_f32 v42, v42
    v_exp_f32 v43, v43
    v_smfmac_f32_32x32x32_bf16 v[64:79], v[116:119], v[32:39], v124
    v_exp_f32 v44, v44
    v_exp_f32 v45, v45
    v_exp_f32 v46, v46
    v_exp_f32 v47, v47
    s_setprio 1
    s_waitcnt lgkmcnt(0)
    ds_read_b128 v[104:107], v209 offset:38912
.p2align 3
    v_exp_f32 v16, v16
    v_exp_f32 v17, v17
    v_smfmac_f32_32x32x32_bf16 v[64:79], v[120:123], v[40:47], v124
    v_exp_f32 v18, v18
    v_exp_f32 v19, v19
    v_exp_f32 v20, v20
    v_exp_f32 v21, v21
    v_mfma_f32_32x32x16_bf16 v[32:47], v[100:103], v[220:223], v[80:95]
    v_exp_f32 v22, v22
    v_exp_f32 v23, v23
    v_exp_f32 v24, v24
    v_exp_f32 v25, v25
    v_exp_f32 v26, v26
    v_exp_f32 v27, v27
    v_smfmac_f32_32x32x32_bf16 v[224:239], v[108:111], v[16:23], v124
    v_exp_f32 v28, v28
    v_exp_f32 v29, v29
    v_exp_f32 v30, v30
    v_exp_f32 v31, v31
    s_waitcnt lgkmcnt(0)
    s_lshl_b32 s85, s66, 16
    s_lshl_b32 s68, s60, 7
    s_add_u32 s85, s85, s68
    s_xor_b32 s68, s61, 0x40000
    s_add_u32 s85, s85, s68
    s_lshl_b32 s84, s3, 1
    s_add_u32 m0, s84, 131072
    s_add_u32 s68, s85, 0
    buffer_load_dwordx4 v210, s[40:43], s68 offen lds
    s_mov_b64 exec, s[62:63]
    ds_read_b128 v[116:119], v211 offset:38912
    ds_read_b128 v[120:123], v211 offset:39424
    s_mov_b64 exec, -1
    s_setprio 3
.p2align 3
    v_exp_f32 v32, v32
    v_exp_f32 v33, v33
    v_smfmac_f32_32x32x32_bf16 v[224:239], v[112:115], v[24:31], v124
    v_exp_f32 v34, v34
    v_exp_f32 v35, v35
    v_exp_f32 v36, v36
    v_exp_f32 v37, v37
    v_mfma_f32_32x32x16_bf16 v[16:31], v[104:107], v[96:99], v[48:63]
    v_exp_f32 v38, v38
    v_exp_f32 v39, v39
    v_exp_f32 v40, v40
    v_exp_f32 v41, v41
    v_exp_f32 v42, v42
    v_exp_f32 v43, v43
    v_smfmac_f32_32x32x32_bf16 v[64:79], v[108:111], v[32:39], v124
    v_exp_f32 v44, v44
    v_exp_f32 v45, v45
    v_exp_f32 v46, v46
    v_exp_f32 v47, v47
    s_setprio 2
    s_waitcnt lgkmcnt(0)
    s_waitcnt vmcnt(3)
    s_mov_b64 exec, 1
    buffer_store_dword v11, off, s[52:55], s73 sc1
    s_mov_b64 exec, -1
    ds_read_b128 v[100:103], v209 offset:43008
    s_add_u32 m0, s84, 132096
    s_add_u32 s68, s85, 8192
    buffer_load_dwordx4 v210, s[40:43], s68 offen lds
    s_mov_b64 exec, 3
    global_load_dword v2, v[252:253], off
    s_mov_b64 exec, -1
.p2align 3
    v_exp_f32 v16, v16
    v_exp_f32 v17, v17
    v_smfmac_f32_32x32x32_bf16 v[64:79], v[112:115], v[40:47], v124
    v_exp_f32 v18, v18
    v_exp_f32 v19, v19
    v_exp_f32 v20, v20
    v_exp_f32 v21, v21
    v_mfma_f32_32x32x16_bf16 v[32:47], v[104:107], v[220:223], v[80:95]
    v_exp_f32 v22, v22
    v_exp_f32 v23, v23
    v_exp_f32 v24, v24
    v_exp_f32 v25, v25
    v_exp_f32 v26, v26
    v_exp_f32 v27, v27
    v_smfmac_f32_32x32x32_bf16 v[224:239], v[116:119], v[16:23], v124
    v_exp_f32 v28, v28
    v_exp_f32 v29, v29
    v_exp_f32 v30, v30
    v_exp_f32 v31, v31
    s_setprio 1
    s_waitcnt lgkmcnt(0)
    s_mov_b64 exec, s[62:63]
    ds_read_b128 v[108:111], v211 offset:43008
    ds_read_b128 v[112:115], v211 offset:43520
    s_mov_b64 exec, -1
.p2align 3
    v_exp_f32 v32, v32
    v_exp_f32 v33, v33
    v_smfmac_f32_32x32x32_bf16 v[224:239], v[120:123], v[24:31], v124
    v_exp_f32_e64 v34, v34
    v_max_f32 v4, 0x15000000, v72
    v_frexp_exp_i32_f32_e64 v4, v4
    v_sub_u32 v4, -84, v4
    v_max_i32 v4, 0xffffff82, v4
    v_cvt_f32_i32 v5, v4
    v_add_f32 v6, v80, v5
    v_ldexp_f32 v4, 1.0, v4
    v_mov_b32 v7, v6
    v_mov_b64 v[8:9], v[6:7]
    v_exp_f32 v35, v35
    v_exp_f32 v36, v36
    v_exp_f32_e64 v37, v37
    v_mfma_f32_32x32x16_bf16 v[16:31], v[100:103], v[96:99], v[48:63]
    v_exp_f32 v38, v38
    v_exp_f32 v39, v39
    v_exp_f32 v40, v40
    v_exp_f32 v41, v41
    v_exp_f32 v42, v42
    v_exp_f32 v43, v43
    v_smfmac_f32_32x32x32_bf16 v[64:79], v[116:119], v[32:39], v124
    v_exp_f32 v44, v44
    v_exp_f32 v45, v45
    v_exp_f32 v46, v46
    v_exp_f32 v47, v47
    s_waitcnt lgkmcnt(0)
    s_add_u32 m0, s79, 65536
    s_add_u32 s68, s77, 0
    buffer_load_dwordx4 v210, s[36:39], s68 offen offset:0  lds
    ds_read_b128 v[104:107], v209 offset:47104
    ds_write_b128 v125, v[6:9] offset:58368
    ds_write_b32 v125, v4 offset:57344
    s_add_u32 m0, s84, 133120
    s_add_u32 s68, s85, 16384
    buffer_load_dwordx4 v210, s[40:43], s68 offen lds
    s_setprio 3
.p2align 3
    v_exp_f32 v16, v16
    v_exp_f32 v17, v17
    v_smfmac_f32_32x32x32_bf16 v[64:79], v[120:123], v[40:47], v124
    v_exp_f32 v18, v18
    v_exp_f32 v19, v19
    v_exp_f32 v20, v20
    v_exp_f32 v21, v21
    v_mfma_f32_32x32x16_bf16 v[32:47], v[100:103], v[220:223], v[80:95]
    v_exp_f32 v22, v22
    v_exp_f32 v23, v23
    v_exp_f32 v24, v24
    v_exp_f32 v25, v25
    v_exp_f32 v26, v26
    v_exp_f32 v27, v27
    v_smfmac_f32_32x32x32_bf16 v[224:239], v[108:111], v[16:23], v124
    v_exp_f32 v28, v28
    v_exp_f32 v29, v29
    v_exp_f32 v30, v30
    v_exp_f32 v31, v31
    s_setprio 2
    s_waitcnt lgkmcnt(0)
    s_add_u32 m0, s84, 134144
    s_add_u32 s68, s85, 24576
    buffer_load_dwordx4 v210, s[40:43], s68 offen lds
    s_mov_b64 exec, s[62:63]
    ds_read_b128 v[116:119], v211 offset:47104
    ds_read_b128 v[120:123], v211 offset:47616
    s_mov_b64 exec, -1
.p2align 3
    v_exp_f32 v32, v32
    v_exp_f32 v33, v33
    v_smfmac_f32_32x32x32_bf16 v[224:239], v[112:115], v[24:31], v124
    v_exp_f32 v34, v34
    s_waitcnt vmcnt(7) lgkmcnt(0)
    s_barrier
    v_exp_f32 v35, v35
    v_exp_f32 v36, v36
    v_exp_f32 v37, v37
    v_mfma_f32_32x32x16_bf16 v[16:31], v[104:107], v[96:99], v[48:63]
    v_exp_f32 v38, v38
    v_exp_f32 v39, v39
    v_exp_f32 v40, v40
    v_exp_f32 v41, v41
    v_exp_f32 v42, v42
    v_exp_f32 v43, v43
    v_smfmac_f32_32x32x32_bf16 v[64:79], v[108:111], v[32:39], v124
    v_exp_f32 v44, v44
    v_exp_f32 v45, v45
    v_exp_f32 v46, v46
    v_exp_f32 v47, v47
    s_setprio 1
    s_waitcnt lgkmcnt(0)
    s_add_u32 m0, s80, 16384
    s_add_u32 s68, s80, 45056
    s_cmp_ge_u32 s56, 6
    s_cselect_b32 s68, 16777216, s68
    buffer_load_dwordx4 v208, s[52:55], s68 offen sc1 lds
    ds_read_b128 v[100:103], v209 offset:2048
    ds_read_b32 v5, v125 offset:49152
    ds_read_b128 v[48:51], v125 offset:50176
    ds_read_b128 v[52:55], v125 offset:50176
    ds_read_b128 v[56:59], v125 offset:50176
    ds_read_b128 v[60:63], v125 offset:50176
    buffer_load_dwordx4 v208, s[52:55], s68 offen offset:1024 sc1 lds
.p2align 3
    v_exp_f32 v16, v16
    v_exp_f32 v17, v17
    v_smfmac_f32_32x32x32_bf16 v[64:79], v[112:115], v[40:47], v124
    v_exp_f32 v18, v18
    v_exp_f32 v19, v19
    v_exp_f32 v20, v20
    v_exp_f32 v21, v21
    v_mfma_f32_32x32x16_bf16 v[32:47], v[104:107], v[220:223], v[80:95]
    v_exp_f32 v22, v22
    v_exp_f32 v23, v23
    v_exp_f32 v24, v24
    v_exp_f32 v25, v25
    v_exp_f32 v26, v26
    v_exp_f32 v27, v27
    v_smfmac_f32_32x32x32_bf16 v[224:239], v[116:119], v[16:23], v124
    v_exp_f32 v28, v28
    v_exp_f32 v29, v29
    v_exp_f32 v30, v30
    v_exp_f32 v31, v31
    s_waitcnt lgkmcnt(0)
    s_mov_b32 s70, 163840
    buffer_load_dword v3, v214, s[52:55], s70 offen sc1
    s_mov_b64 exec, s[62:63]
    ds_read_b128 v[108:111], v211 offset:2048
    ds_read_b128 v[112:115], v211 offset:2560
    s_mov_b64 exec, -1
    ds_read_b128 v[80:83], v125 offset:58368
    ds_read_b128 v[84:87], v125 offset:58368
    ds_read_b128 v[88:91], v125 offset:58368
    ds_read_b128 v[92:95], v125 offset:58368
    s_add_u32 m0, s79, 65536
    s_add_u32 s68, s77, 7168
    buffer_load_dwordx4 v210, s[36:39], s68 offen offset:1024  lds
    s_setprio 3
.p2align 3
    v_exp_f32 v32, v32
    v_exp_f32 v33, v33
    v_smfmac_f32_32x32x32_bf16 v[224:239], v[120:123], v[24:31], v124
    v_exp_f32 v34, v34
    v_exp_f32 v35, v35
    v_exp_f32 v36, v36
    v_exp_f32 v37, v37
    v_mfma_f32_32x32x16_bf16 v[16:31], v[100:103], v[96:99], v[48:63]
    v_exp_f32 v38, v38
    v_exp_f32 v39, v39
    v_exp_f32 v40, v40
    v_exp_f32 v41, v41
    v_exp_f32 v42, v42
    v_exp_f32 v43, v43
    v_smfmac_f32_32x32x32_bf16 v[64:79], v[116:119], v[32:39], v124
    v_exp_f32 v44, v44
    v_exp_f32 v45, v45
    v_exp_f32 v46, v46
    v_exp_f32 v47, v47
    s_setprio 2
    s_waitcnt lgkmcnt(0)
    s_add_u32 m0, s79, 65536
    s_add_u32 s68, s77, 14336
    buffer_load_dwordx4 v210, s[36:39], s68 offen offset:2048  lds
    ds_read_b128 v[104:107], v209 offset:6144
    s_add_u32 m0, s79, 65536
    s_add_u32 s68, s77, 21504
    buffer_load_dwordx4 v210, s[36:39], s68 offen offset:3072  lds
    s_add_u32 m0, s84, 135168
    s_add_u32 s68, s85, 32768
    buffer_load_dwordx4 v210, s[40:43], s68 offen lds
.p2align 3
    v_exp_f32 v16, v16
    v_exp_f32 v17, v17
    v_smfmac_f32_32x32x32_bf16 v[64:79], v[120:123], v[40:47], v124
    v_exp_f32_e64 v18, v18
    v_mul_f32_e64 v224, v224, v5
    v_mul_f32 v225, v225, v5
    v_mul_f32 v226, v226, v5
    v_mul_f32 v227, v227, v5
    v_mul_f32 v228, v228, v5
    v_mul_f32 v229, v229, v5
    v_mul_f32 v230, v230, v5
    v_mul_f32 v231, v231, v5
    v_mul_f32 v232, v232, v5
    v_exp_f32 v19, v19
    v_exp_f32 v20, v20
    v_exp_f32_e64 v21, v21
    v_mfma_f32_32x32x16_bf16 v[32:47], v[100:103], v[220:223], v[80:95]
    v_exp_f32 v22, v22
    v_exp_f32 v23, v23
    v_exp_f32 v24, v24
    v_exp_f32 v25, v25
    v_exp_f32 v26, v26
    v_exp_f32 v27, v27
    v_smfmac_f32_32x32x32_bf16 v[224:239], v[108:111], v[16:23], v124
    v_exp_f32 v28, v28
    v_exp_f32 v29, v29
    v_exp_f32 v30, v30
    v_exp_f32 v31, v31
    s_setprio 1
    s_waitcnt lgkmcnt(0)
    s_waitcnt vmcnt(4)
    s_add_u32 m0, s84, 136192
    s_add_u32 s68, s85, 40960
    buffer_load_dwordx4 v210, s[40:43], s68 offen lds
    s_mov_b64 exec, s[62:63]
    ds_read_b128 v[116:119], v211 offset:6144
    ds_read_b128 v[120:123], v211 offset:6656
    s_mov_b64 exec, -1
    s_add_u32 m0, s84, 137216
    s_add_u32 s68, s85, 49152
    buffer_load_dwordx4 v210, s[40:43], s68 offen lds
.p2align 3
    v_exp_f32 v32, v32
    v_exp_f32 v33, v33
    v_smfmac_f32_32x32x32_bf16 v[224:239], v[112:115], v[24:31], v124
    v_exp_f32_e64 v34, v34
    v_mul_f32_e64 v64, v64, v4
    v_mul_f32 v65, v65, v4
    v_mul_f32 v66, v66, v4
    v_mul_f32 v67, v67, v4
    v_mul_f32 v68, v68, v4
    v_mul_f32 v69, v69, v4
    v_mul_f32 v70, v70, v4
    v_mul_f32 v71, v71, v4
    v_mul_f32 v72, v72, v4
    v_exp_f32 v35, v35
    v_exp_f32 v36, v36
    v_exp_f32_e64 v37, v37
    v_mfma_f32_32x32x16_bf16 v[16:31], v[104:107], v[96:99], v[48:63]
    v_exp_f32 v38, v38
    v_exp_f32 v39, v39
    v_exp_f32 v40, v40
    v_exp_f32 v41, v41
    v_exp_f32 v42, v42
    v_exp_f32 v43, v43
    v_smfmac_f32_32x32x32_bf16 v[64:79], v[108:111], v[32:39], v124
    v_exp_f32 v44, v44
    v_exp_f32 v45, v45
    v_exp_f32 v46, v46
    v_exp_f32 v47, v47
    v_cmp_ne_u32 vcc, 1, v3
    s_waitcnt lgkmcnt(0)
    s_cbranch_vccnz L_hspinB
L_hokB:
    s_add_u32 s69, s78, 0
    buffer_load_dwordx4 v[160:163], v208, s[52:55], s69 offen offset:0 sc1
    ds_read_b128 v[100:103], v209 offset:10240
    buffer_load_dwordx4 v[164:167], v208, s[52:55], s69 offen offset:1024 sc1
    s_setprio 3
.p2align 3
    v_exp_f32 v16, v16
    v_exp_f32 v17, v17
    v_smfmac_f32_32x32x32_bf16 v[64:79], v[112:115], v[40:47], v124
    v_exp_f32 v18, v18
    v_exp_f32 v19, v19
    v_exp_f32 v20, v20
    v_exp_f32 v21, v21
    v_mfma_f32_32x32x16_bf16 v[32:47], v[104:107], v[220:223], v[80:95]
    v_exp_f32 v22, v22
    v_exp_f32 v23, v23
    v_exp_f32 v24, v24
    v_exp_f32 v25, v25
    v_exp_f32 v26, v26
    v_exp_f32 v27, v27
    v_smfmac_f32_32x32x32_bf16 v[224:239], v[116:119], v[16:23], v124
    v_exp_f32 v28, v28
    v_exp_f32 v29, v29
    v_exp_f32 v30, v30
    v_exp_f32 v31, v31
    s_setprio 2
    s_waitcnt lgkmcnt(0)
    buffer_load_dwordx4 v[168:171], v208, s[52:55], s69 offen offset:2048 sc1
    s_mov_b64 exec, s[62:63]
    ds_read_b128 v[108:111], v211 offset:10240
    ds_read_b128 v[112:115], v211 offset:10752
    s_mov_b64 exec, -1
    buffer_load_dwordx4 v[172:175], v208, s[52:55], s69 offen offset:3072 sc1
.p2align 3
    v_exp_f32 v32, v32
    v_exp_f32 v33, v33
    v_smfmac_f32_32x32x32_bf16 v[224:239], v[120:123], v[24:31], v124
    v_exp_f32 v34, v34
    s_waitcnt vmcnt(7) lgkmcnt(0)
    s_barrier
    v_exp_f32 v35, v35
    v_exp_f32 v36, v36
    v_exp_f32 v37, v37
    v_mfma_f32_32x32x16_bf16 v[16:31], v[100:103], v[96:99], v[48:63]
    v_exp_f32 v38, v38
    v_exp_f32 v39, v39
    v_exp_f32 v40, v40
    v_exp_f32 v41, v41
    v_exp_f32 v42, v42
    v_exp_f32 v43, v43
    v_smfmac_f32_32x32x32_bf16 v[64:79], v[116:119], v[32:39], v124
    v_exp_f32 v44, v44
    v_exp_f32 v45, v45
    v_exp_f32 v46, v46
    v_exp_f32 v47, v47
    s_setprio 1
    s_waitcnt lgkmcnt(0)
    s_add_u32 m0, s80, 32768
    s_add_u32 s68, s80, 57344
    s_cmp_ge_u32 s56, 6
    s_cselect_b32 s68, 16777216, s68
    buffer_load_dwordx4 v208, s[52:55], s68 offen sc1 lds
    ds_read_b128 v[104:107], v209 offset:18432
    ds_read_b64_tr_b16 v[192:193], v212 offset:0
    ds_read_b64_tr_b16 v[194:195], v212 offset:512
    buffer_load_dwordx4 v208, s[52:55], s68 offen offset:1024 sc1 lds
.p2align 3
    v_exp_f32 v16, v16
    v_exp_f32 v17, v17
    v_smfmac_f32_32x32x32_bf16 v[64:79], v[120:123], v[40:47], v124
    v_exp_f32 v18, v18
    v_exp_f32 v19, v19
    v_exp_f32 v20, v20
    v_exp_f32 v21, v21
    v_mfma_f32_32x32x16_bf16 v[32:47], v[100:103], v[220:223], v[80:95]
    v_exp_f32 v22, v22
    v_exp_f32 v23, v23
    v_exp_f32 v24, v24
    v_exp_f32 v25, v25
    v_exp_f32 v26, v26
    v_exp_f32 v27, v27
    v_smfmac_f32_32x32x32_bf16 v[224:239], v[108:111], v[16:23], v124
    v_exp_f32 v28, v28
    v_exp_f32 v29, v29
    v_exp_f32 v30, v30
    v_exp_f32 v31, v31
    s_waitcnt lgkmcnt(0)
    s_add_u32 m0, s79, 98304
    s_add_u32 s68, s77, 65536
    buffer_load_dwordx4 v210, s[36:39], s68 offen offset:0  lds
    s_mov_b64 exec, s[62:63]
    ds_read_b128 v[116:119], v211 offset:18432
    ds_read_b128 v[120:123], v211 offset:18944
    s_mov_b64 exec, -1
    ds_read_b64_tr_b16 v[196:197], v213 offset:0
    ds_read_b64_tr_b16 v[198:199], v213 offset:512
    s_add_u32 m0, s79, 98304
    s_add_u32 s68, s77, 72704
    buffer_load_dwordx4 v210, s[36:39], s68 offen offset:1024  lds
    s_setprio 3
.p2align 3
    v_exp_f32 v32, v32
    v_exp_f32 v33, v33
    v_smfmac_f32_32x32x32_bf16 v[224:239], v[112:115], v[24:31], v124
    v_exp_f32 v34, v34
    v_exp_f32 v35, v35
    v_exp_f32 v36, v36
    v_exp_f32 v37, v37
    v_mfma_f32_32x32x16_bf16 v[16:31], v[104:107], v[96:99], v[48:63]
    v_exp_f32 v38, v38
    v_exp_f32 v39, v39
    v_exp_f32 v40, v40
    v_exp_f32 v41, v41
    v_exp_f32 v42, v42
    v_exp_f32 v43, v43
    v_smfmac_f32_32x32x32_bf16 v[64:79], v[108:111], v[32:39], v124
    v_exp_f32 v44, v44
    v_exp_f32 v45, v45
    v_exp_f32 v46, v46
    v_exp_f32 v47, v47
    s_setprio 2
    s_waitcnt lgkmcnt(0)
    s_waitcnt vmcnt(7)
    s_add_u32 m0, s79, 98304
    s_add_u32 s68, s77, 79872
    buffer_load_dwordx4 v210, s[36:39], s68 offen offset:2048  lds
    ds_read_b128 v[100:103], v209 offset:22528
    ds_read_b64_tr_b16 v[200:201], v212 offset:2048
    ds_read_b64_tr_b16 v[202:203], v212 offset:2560
    ds_read_b64_tr_b16 v[204:205], v213 offset:2048
    ds_read_b64_tr_b16 v[206:207], v213 offset:2560
.p2align 3
    v_exp_f32 v16, v16
    v_exp_f32 v17, v17
    v_smfmac_f32_32x32x32_bf16 v[64:79], v[112:115], v[40:47], v124
    v_exp_f32 v18, v18
    v_exp_f32 v19, v19
    v_exp_f32 v20, v20
    v_exp_f32 v21, v21
    v_mfma_f32_32x32x16_bf16 v[32:47], v[104:107], v[220:223], v[80:95]
    v_exp_f32 v22, v22
    v_exp_f32 v23, v23
    v_exp_f32 v24, v24
    v_exp_f32 v25, v25
    v_mfma_f32_32x32x16_bf16 v[128:143], v[160:163], v[192:195], 0
    v_exp_f32 v26, v26
    v_exp_f32 v27, v27
    v_exp_f32 v28, v28
    v_exp_f32 v29, v29
    v_smfmac_f32_32x32x32_bf16 v[224:239], v[116:119], v[16:23], v124
    v_exp_f32 v30, v30
    v_exp_f32 v31, v31
    s_setprio 1
    s_waitcnt lgkmcnt(0)
    s_add_u32 m0, s79, 98304
    s_add_u32 s68, s77, 87040
    buffer_load_dwordx4 v210, s[36:39], s68 offen offset:3072  lds
    s_mov_b64 exec, s[62:63]
    ds_read_b128 v[108:111], v211 offset:22528
    ds_read_b128 v[112:115], v211 offset:23040
    s_mov_b64 exec, -1
    ds_read_b64_tr_b16 v[192:193], v212 offset:4096
    ds_read_b64_tr_b16 v[194:195], v212 offset:4608
    s_add_u32 s69, s78, 4096
    buffer_load_dwordx4 v[176:179], v208, s[52:55], s69 offen offset:0 sc1
.p2align 3
    v_exp_f32 v32, v32
    v_exp_f32 v33, v33
    v_smfmac_f32_32x32x32_bf16 v[224:239], v[120:123], v[24:31], v124
    v_exp_f32 v34, v34
    v_exp_f32 v35, v35
    v_exp_f32 v36, v36
    v_exp_f32 v37, v37
    v_mfma_f32_32x32x16_bf16 v[16:31], v[100:103], v[96:99], v[48:63]
    v_exp_f32 v38, v38
    v_exp_f32 v39, v39
    v_exp_f32 v40, v40
    v_exp_f32 v41, v41
    v_mfma_f32_32x32x16_bf16 v[144:159], v[160:163], v[196:199], 0
    v_exp_f32 v42, v42
    v_exp_f32 v43, v43
    v_exp_f32 v44, v44
    v_exp_f32 v45, v45
    v_smfmac_f32_32x32x32_bf16 v[64:79], v[116:119], v[32:39], v124
    v_exp_f32 v46, v46
    v_exp_f32 v47, v47
    s_waitcnt lgkmcnt(0)
    s_waitcnt vmcnt(7)
    buffer_load_dwordx4 v[180:183], v208, s[52:55], s69 offen offset:1024 sc1
    ds_read_b128 v[104:107], v209 offset:26624
    ds_read_b64_tr_b16 v[196:197], v213 offset:4096
    ds_read_b64_tr_b16 v[198:199], v213 offset:4608
    buffer_load_dwordx4 v[184:187], v208, s[52:55], s69 offen offset:2048 sc1
    s_setprio 3
.p2align 3
    v_exp_f32_e64 v16, v16
    v_smfmac_f32_32x32x32_bf16 v[64:79], v[120:123], v[40:47], v124
    v_exp_f32 v17, v17
    v_exp_f32 v18, v18
    v_exp_f32_e64 v19, v19
    v_mfma_f32_32x32x16_bf16 v[32:47], v[100:103], v[220:223], v[80:95]
    v_exp_f32 v20, v20
    v_exp_f32 v21, v21
    v_exp_f32_e64 v22, v22
    v_mfma_f32_32x32x16_bf16 v[128:143], v[164:167], v[200:203], v[128:143]
    v_exp_f32 v23, v23
    v_exp_f32 v24, v24
    v_exp_f32_e64 v25, v25
    v_smfmac_f32_32x32x32_bf16 v[224:239], v[108:111], v[16:23], v124
    v_exp_f32 v26, v26
    v_exp_f32 v27, v27
    v_exp_f32_e64 v28, v28
    v_mfma_f32_32x32x16_bf16 v[144:159], v[164:167], v[204:207], v[144:159]
    v_exp_f32 v29, v29
    v_exp_f32 v30, v30
    v_exp_f32 v31, v31
    s_setprio 2
    s_branch L_pg145
.p2align 12
L_stub145:
    s_nop 0
    s_setpc_b64 s[0:1]
L_pg145:
    s_waitcnt lgkmcnt(0)
    buffer_load_dwordx4 v[188:191], v208, s[52:55], s69 offen offset:3072 sc1
    s_mov_b64 exec, s[62:63]
    ds_read_b128 v[116:119], v211 offset:26624
    ds_read_b128 v[120:123], v211 offset:27136
    s_mov_b64 exec, -1
    ds_read_b64_tr_b16 v[200:201], v212 offset:6144
    ds_read_b64_tr_b16 v[202:203], v212 offset:6656
    ds_read_b64_tr_b16 v[204:205], v213 offset:6144
    ds_read_b64_tr_b16 v[206:207], v213 offset:6656
.p2align 3
    v_exp_f32_e64 v32, v32
    v_smfmac_f32_32x32x32_bf16 v[224:239], v[112:115], v[24:31], v124
    v_exp_f32 v33, v33
    v_exp_f32 v34, v34
    s_waitcnt vmcnt(4) lgkmcnt(0)
    s_barrier
    v_exp_f32_e64 v35, v35
    v_mfma_f32_32x32x16_bf16 v[16:31], v[104:107], v[96:99], v[48:63]
    v_exp_f32 v36, v36
    v_exp_f32 v37, v37
    v_exp_f32_e64 v38, v38
    v_mfma_f32_32x32x16_bf16 v[128:143], v[168:171], v[192:195], v[128:143]
    v_exp_f32 v39, v39
    v_exp_f32 v40, v40
    v_exp_f32_e64 v41, v41
    v_smfmac_f32_32x32x32_bf16 v[64:79], v[108:111], v[32:39], v124
    v_exp_f32 v42, v42
    v_exp_f32 v43, v43
    v_exp_f32_e64 v44, v44
    v_mfma_f32_32x32x16_bf16 v[144:159], v[168:171], v[196:199], v[144:159]
    v_exp_f32 v45, v45
    v_exp_f32 v46, v46
    v_exp_f32 v47, v47
    s_setprio 1
    s_waitcnt lgkmcnt(0)
    s_add_u32 m0, s80, 0
    s_add_u32 s68, s80, 69632
    s_cmp_ge_u32 s56, 6
    s_cselect_b32 s68, 16777216, s68
    buffer_load_dwordx4 v208, s[52:55], s68 offen sc1 lds
    ds_read_b128 v[100:103], v209 offset:34816
    ds_read_b64_tr_b16 v[192:193], v212 offset:32768
    ds_read_b64_tr_b16 v[194:195], v212 offset:33280
    buffer_load_dwordx4 v208, s[52:55], s68 offen offset:1024 sc1 lds
.p2align 3
    v_exp_f32_e64 v16, v16
    v_smfmac_f32_32x32x32_bf16 v[64:79], v[112:115], v[40:47], v124
    v_exp_f32 v17, v17
    v_exp_f32 v18, v18
    v_exp_f32_e64 v19, v19
    v_mfma_f32_32x32x16_bf16 v[32:47], v[104:107], v[220:223], v[80:95]
    v_exp_f32 v20, v20
    v_exp_f32 v21, v21
    v_exp_f32_e64 v22, v22
    v_mfma_f32_32x32x16_bf16 v[128:143], v[172:175], v[200:203], v[128:143]
    v_exp_f32 v23, v23
    v_exp_f32 v24, v24
    v_exp_f32_e64 v25, v25
    v_smfmac_f32_32x32x32_bf16 v[224:239], v[116:119], v[16:23], v124
    v_exp_f32 v26, v26
    v_exp_f32 v27, v27
    v_exp_f32_e64 v28, v28
    v_mfma_f32_32x32x16_bf16 v[144:159], v[172:175], v[204:207], v[144:159]
    v_exp_f32 v29, v29
    v_exp_f32 v30, v30
    v_exp_f32 v31, v31
    s_waitcnt lgkmcnt(0)
    s_waitcnt vmcnt(5)
    s_add_u32 m0, s79, 65536
    s_add_u32 s68, s77, 131072
    buffer_load_dwordx4 v210, s[36:39], s68 offen offset:0  lds
    s_mov_b64 exec, s[62:63]
    ds_read_b128 v[108:111], v211 offset:34816
    ds_read_b128 v[112:115], v211 offset:35328
    s_mov_b64 exec, -1
    ds_read_b64_tr_b16 v[196:197], v213 offset:32768
    ds_read_b64_tr_b16 v[198:199], v213 offset:33280
    s_add_u32 m0, s79, 65536
    s_add_u32 s68, s77, 138240
    buffer_load_dwordx4 v210, s[36:39], s68 offen offset:1024  lds
    s_setprio 3
.p2align 3
    v_exp_f32 v32, v32
    v_exp_f32 v33, v33
    v_smfmac_f32_32x32x32_bf16 v[224:239], v[120:123], v[24:31], v124
    v_exp_f32 v34, v34
    v_exp_f32 v35, v35
    v_exp_f32 v36, v36
    v_exp_f32 v37, v37
    v_mfma_f32_32x32x16_bf16 v[16:31], v[100:103], v[96:99], v[48:63]
    v_exp_f32 v38, v38
    v_exp_f32 v39, v39
    v_exp_f32 v40, v40
    v_exp_f32 v41, v41
    v_mfma_f32_32x32x16_bf16 v[128:143], v[176:179], v[192:195], v[128:143]
    v_exp_f32 v42, v42
    v_exp_f32 v43, v43
    v_exp_f32 v44, v44
    v_exp_f32 v45, v45
    v_smfmac_f32_32x32x32_bf16 v[64:79], v[116:119], v[32:39], v124
    v_exp_f32 v46, v46
    v_exp_f32 v47, v47
    s_setprio 2
    s_waitcnt lgkmcnt(0)
    s_add_u32 m0, s79, 65536
    s_add_u32 s68, s77, 145408
    buffer_load_dwordx4 v210, s[36:39], s68 offen offset:2048  lds
    ds_read_b128 v[104:107], v209 offset:38912
    ds_read_b64_tr_b16 v[200:201], v212 offset:34816
    ds_read_b64_tr_b16 v[202:203], v212 offset:35328
    ds_read_b64_tr_b16 v[204:205], v213 offset:34816
    ds_read_b64_tr_b16 v[206:207], v213 offset:35328
    s_add_u32 m0, s84, 138240
    s_add_u32 s68, s85, 57344
    buffer_load_dwordx4 v210, s[40:43], s68 offen lds
.p2align 3
    v_exp_f32 v16, v16
    v_exp_f32 v17, v17
    v_smfmac_f32_32x32x32_bf16 v[64:79], v[120:123], v[40:47], v124
    v_exp_f32 v18, v18
    v_exp_f32 v19, v19
    v_exp_f32 v20, v20
    v_exp_f32 v21, v21
    v_mfma_f32_32x32x16_bf16 v[32:47], v[100:103], v[220:223], v[80:95]
    v_exp_f32 v22, v22
    v_exp_f32 v23, v23
    v_exp_f32 v24, v24
    v_exp_f32 v25, v25
    v_mfma_f32_32x32x16_bf16 v[144:159], v[176:179], v[196:199], v[144:159]
    v_exp_f32 v26, v26
    v_exp_f32 v27, v27
    v_exp_f32 v28, v28
    v_exp_f32 v29, v29
    v_smfmac_f32_32x32x32_bf16 v[224:239], v[108:111], v[16:23], v124
    v_exp_f32 v30, v30
    v_exp_f32 v31, v31
    s_setprio 1
    s_waitcnt lgkmcnt(0)
    s_waitcnt vmcnt(6)
    s_add_u32 m0, s79, 65536
    s_add_u32 s68, s77, 152576
    buffer_load_dwordx4 v210, s[36:39], s68 offen offset:3072  lds
    s_mov_b64 exec, s[62:63]
    ds_read_b128 v[116:119], v211 offset:38912
    ds_read_b128 v[120:123], v211 offset:39424
    s_mov_b64 exec, -1
    ds_read_b64_tr_b16 v[192:193], v212 offset:36864
    ds_read_b64_tr_b16 v[194:195], v212 offset:37376
    s_add_u32 s69, s78, 8192
    buffer_load_dwordx4 v[160:163], v208, s[52:55], s69 offen offset:0 sc1
.p2align 3
    v_exp_f32 v32, v32
    v_exp_f32 v33, v33
    v_smfmac_f32_32x32x32_bf16 v[224:239], v[112:115], v[24:31], v124
    v_exp_f32 v34, v34
    v_exp_f32 v35, v35
    v_exp_f32 v36, v36
    v_exp_f32 v37, v37
    v_mfma_f32_32x32x16_bf16 v[16:31], v[104:107], v[96:99], v[48:63]
    v_exp_f32 v38, v38
    v_exp_f32 v39, v39
    v_exp_f32 v40, v40
    v_exp_f32 v41, v41
    v_mfma_f32_32x32x16_bf16 v[128:143], v[180:183], v[200:203], v[128:143]
    v_exp_f32 v42, v42
    v_exp_f32 v43, v43
    v_exp_f32 v44, v44
    v_exp_f32 v45, v45
    v_smfmac_f32_32x32x32_bf16 v[64:79], v[108:111], v[32:39], v124
    v_exp_f32 v46, v46
    v_exp_f32 v47, v47
    s_waitcnt lgkmcnt(0)
    buffer_load_dwordx4 v[164:167], v208, s[52:55], s69 offen offset:1024 sc1
    ds_read_b128 v[100:103], v209 offset:43008
    ds_read_b64_tr_b16 v[196:197], v213 offset:36864
    ds_read_b64_tr_b16 v[198:199], v213 offset:37376
    buffer_load_dwordx4 v[168:171], v208, s[52:55], s69 offen offset:2048 sc1
    s_setprio 3
.p2align 3
    v_exp_f32_e64 v16, v16
    v_smfmac_f32_32x32x32_bf16 v[64:79], v[112:115], v[40:47], v124
    v_exp_f32 v17, v17
    v_exp_f32 v18, v18
    v_exp_f32_e64 v19, v19
    v_mfma_f32_32x32x16_bf16 v[32:47], v[104:107], v[220:223], v[80:95]
    v_exp_f32 v20, v20
    v_exp_f32 v21, v21
    v_exp_f32_e64 v22, v22
    v_mfma_f32_32x32x16_bf16 v[144:159], v[180:183], v[204:207], v[144:159]
    v_exp_f32 v23, v23
    v_exp_f32 v24, v24
    v_exp_f32_e64 v25, v25
    v_smfmac_f32_32x32x32_bf16 v[224:239], v[116:119], v[16:23], v124
    v_exp_f32 v26, v26
    v_exp_f32 v27, v27
    v_exp_f32_e64 v28, v28
    v_mfma_f32_32x32x16_bf16 v[128:143], v[184:187], v[192:195], v[128:143]
    v_exp_f32 v29, v29
    v_exp_f32 v30, v30
    v_exp_f32 v31, v31
    s_setprio 2
    s_waitcnt lgkmcnt(0)
    buffer_load_dwordx4 v[172:175], v208, s[52:55], s69 offen offset:3072 sc1
    s_mov_b64 exec, s[62:63]
    ds_read_b128 v[108:111], v211 offset:43008
    ds_read_b128 v[112:115], v211 offset:43520
    s_mov_b64 exec, -1
    ds_read_b64_tr_b16 v[200:201], v212 offset:38912
    ds_read_b64_tr_b16 v[202:203], v212 offset:39424
    ds_read_b64_tr_b16 v[204:205], v213 offset:38912
    ds_read_b64_tr_b16 v[206:207], v213 offset:39424
.p2align 3
    v_exp_f32 v32, v32
    v_exp_f32 v33, v33
    v_smfmac_f32_32x32x32_bf16 v[224:239], v[120:123], v[24:31], v124
    v_exp_f32 v34, v34
    s_waitcnt vmcnt(4) lgkmcnt(0)
    s_barrier
    v_exp_f32 v35, v35
    v_exp_f32 v36, v36
    v_exp_f32 v37, v37
    v_mfma_f32_32x32x16_bf16 v[16:31], v[100:103], v[96:99], v[48:63]
    v_exp_f32 v38, v38
    v_exp_f32 v39, v39
    v_exp_f32 v40, v40
    v_exp_f32 v41, v41
    v_mfma_f32_32x32x16_bf16 v[144:159], v[184:187], v[196:199], v[144:159]
    v_exp_f32 v42, v42
    v_exp_f32 v43, v43
    v_exp_f32 v44, v44
    v_exp_f32 v45, v45
    v_smfmac_f32_32x32x32_bf16 v[64:79], v[116:119], v[32:39], v124
    v_exp_f32 v46, v46
    v_exp_f32 v47, v47
    s_setprio 1
    s_waitcnt lgkmcnt(0)
    s_add_u32 m0, s80, 16384
    s_add_u32 s68, s80, 81920
    s_cmp_ge_u32 s56, 6
    s_cselect_b32 s68, 16777216, s68
    buffer_load_dwordx4 v208, s[52:55], s68 offen sc1 lds
    ds_read_b128 v[104:107], v209 offset:2048
    ds_read_b64_tr_b16 v[192:193], v212 offset:0
    ds_read_b64_tr_b16 v[194:195], v212 offset:512
    buffer_load_dwordx4 v208, s[52:55], s68 offen offset:1024 sc1 lds
.p2align 3
    v_exp_f32_e64 v16, v16
    v_smfmac_f32_32x32x32_bf16 v[64:79], v[120:123], v[40:47], v124
    v_exp_f32 v17, v17
    v_exp_f32 v18, v18
    v_exp_f32_e64 v19, v19
    v_mfma_f32_32x32x16_bf16 v[32:47], v[100:103], v[220:223], v[80:95]
    v_exp_f32 v20, v20
    v_exp_f32 v21, v21
    v_exp_f32_e64 v22, v22
    v_mfma_f32_32x32x16_bf16 v[128:143], v[188:191], v[200:203], v[128:143]
    v_exp_f32 v23, v23
    v_exp_f32 v24, v24
    v_exp_f32_e64 v25, v25
    v_smfmac_f32_32x32x32_bf16 v[224:239], v[108:111], v[16:23], v124
    v_exp_f32 v26, v26
    v_exp_f32 v27, v27
    v_exp_f32_e64 v28, v28
    v_mfma_f32_32x32x16_bf16 v[144:159], v[188:191], v[204:207], v[144:159]
    v_exp_f32 v29, v29
    v_exp_f32 v30, v30
    v_exp_f32 v31, v31
    s_waitcnt lgkmcnt(0)
    s_waitcnt vmcnt(5)
    s_add_u32 m0, s79, 98304
    s_add_u32 s68, s77, 196608
    buffer_load_dwordx4 v210, s[36:39], s68 offen offset:0  lds
    s_mov_b64 exec, s[62:63]
    ds_read_b128 v[116:119], v211 offset:2048
    ds_read_b128 v[120:123], v211 offset:2560
    s_mov_b64 exec, -1
    ds_read_b64_tr_b16 v[196:197], v213 offset:0
    ds_read_b64_tr_b16 v[198:199], v213 offset:512
    s_add_u32 m0, s79, 98304
    s_add_u32 s68, s77, 203776
    buffer_load_dwordx4 v210, s[36:39], s68 offen offset:1024  lds
    s_setprio 3
.p2align 3
    v_exp_f32 v32, v32
    v_exp_f32 v33, v33
    v_smfmac_f32_32x32x32_bf16 v[224:239], v[112:115], v[24:31], v124
    v_exp_f32 v34, v34
    v_exp_f32 v35, v35
    v_exp_f32 v36, v36
    v_exp_f32 v37, v37
    v_mfma_f32_32x32x16_bf16 v[16:31], v[104:107], v[96:99], v[48:63]
    v_exp_f32 v38, v38
    v_exp_f32 v39, v39
    v_exp_f32 v40, v40
    v_exp_f32 v41, v41
    v_mfma_f32_32x32x16_bf16 v[128:143], v[160:163], v[192:195], v[128:143]
    v_exp_f32 v42, v42
    v_exp_f32 v43, v43
    v_exp_f32 v44, v44
    v_exp_f32 v45, v45
    v_smfmac_f32_32x32x32_bf16 v[64:79], v[108:111], v[32:39], v124
    v_exp_f32 v46, v46
    v_exp_f32 v47, v47
    s_setprio 2
    s_waitcnt lgkmcnt(0)
    s_add_u32 m0, s79, 98304
    s_add_u32 s68, s77, 210944
    buffer_load_dwordx4 v210, s[36:39], s68 offen offset:2048  lds
    ds_read_b128 v[100:103], v209 offset:6144
    ds_read_b64_tr_b16 v[200:201], v212 offset:2048
    ds_read_b64_tr_b16 v[202:203], v212 offset:2560
    ds_read_b64_tr_b16 v[204:205], v213 offset:2048
    ds_read_b64_tr_b16 v[206:207], v213 offset:2560
.p2align 3
    v_exp_f32 v16, v16
    v_exp_f32 v17, v17
    v_smfmac_f32_32x32x32_bf16 v[64:79], v[112:115], v[40:47], v124
    v_exp_f32 v18, v18
    v_exp_f32 v19, v19
    v_exp_f32 v20, v20
    v_exp_f32 v21, v21
    v_mfma_f32_32x32x16_bf16 v[32:47], v[104:107], v[220:223], v[80:95]
    v_exp_f32 v22, v22
    v_exp_f32 v23, v23
    v_exp_f32 v24, v24
    v_exp_f32 v25, v25
    v_mfma_f32_32x32x16_bf16 v[144:159], v[160:163], v[196:199], v[144:159]
    v_exp_f32 v26, v26
    v_exp_f32 v27, v27
    v_exp_f32 v28, v28
    v_exp_f32 v29, v29
    v_smfmac_f32_32x32x32_bf16 v[224:239], v[116:119], v[16:23], v124
    v_exp_f32 v30, v30
    v_exp_f32 v31, v31
    s_setprio 1
    s_waitcnt lgkmcnt(0)
    s_waitcnt vmcnt(5)
    s_add_u32 m0, s79, 98304
    s_add_u32 s68, s77, 218112
    buffer_load_dwordx4 v210, s[36:39], s68 offen offset:3072  lds
    s_mov_b64 exec, s[62:63]
    ds_read_b128 v[108:111], v211 offset:6144
    ds_read_b128 v[112:115], v211 offset:6656
    s_mov_b64 exec, -1
    ds_read_b64_tr_b16 v[192:193], v212 offset:4096
    ds_read_b64_tr_b16 v[194:195], v212 offset:4608
    s_add_u32 s69, s78, 12288
    buffer_load_dwordx4 v[176:179], v208, s[52:55], s69 offen offset:0 sc1
.p2align 3
    v_exp_f32 v32, v32
    v_exp_f32 v33, v33
    v_smfmac_f32_32x32x32_bf16 v[224:239], v[120:123], v[24:31], v124
    v_exp_f32 v34, v34
    v_exp_f32 v35, v35
    v_exp_f32 v36, v36
    v_exp_f32 v37, v37
    v_mfma_f32_32x32x16_bf16 v[16:31], v[100:103], v[96:99], v[48:63]
    v_exp_f32 v38, v38
    v_exp_f32 v39, v39
    v_exp_f32 v40, v40
    v_exp_f32 v41, v41
    v_mfma_f32_32x32x16_bf16 v[128:143], v[164:167], v[200:203], v[128:143]
    v_exp_f32 v42, v42
    v_exp_f32 v43, v43
    v_exp_f32 v44, v44
    v_exp_f32 v45, v45
    v_smfmac_f32_32x32x32_bf16 v[64:79], v[116:119], v[32:39], v124
    v_exp_f32 v46, v46
    v_exp_f32 v47, v47
    s_waitcnt lgkmcnt(0)
    buffer_load_dwordx4 v[180:183], v208, s[52:55], s69 offen offset:1024 sc1
    ds_read_b128 v[104:107], v209 offset:10240
    ds_read_b64_tr_b16 v[196:197], v213 offset:4096
    ds_read_b64_tr_b16 v[198:199], v213 offset:4608
    buffer_load_dwordx4 v[184:187], v208, s[52:55], s69 offen offset:2048 sc1
    s_setprio 3
.p2align 3
    v_exp_f32_e64 v16, v16
    v_smfmac_f32_32x32x32_bf16 v[64:79], v[120:123], v[40:47], v124
    v_exp_f32 v17, v17
    v_exp_f32 v18, v18
    v_exp_f32_e64 v19, v19
    v_mfma_f32_32x32x16_bf16 v[32:47], v[100:103], v[220:223], v[80:95]
    v_exp_f32 v20, v20
    v_exp_f32 v21, v21
    v_exp_f32_e64 v22, v22
    v_mfma_f32_32x32x16_bf16 v[144:159], v[164:167], v[204:207], v[144:159]
    v_exp_f32 v23, v23
    v_exp_f32 v24, v24
    v_exp_f32_e64 v25, v25
    v_smfmac_f32_32x32x32_bf16 v[224:239], v[108:111], v[16:23], v124
    v_exp_f32 v26, v26
    v_exp_f32 v27, v27
    v_exp_f32_e64 v28, v28
    v_mfma_f32_32x32x16_bf16 v[128:143], v[168:171], v[192:195], v[128:143]
    v_exp_f32 v29, v29
    v_exp_f32 v30, v30
    v_exp_f32 v31, v31
    s_setprio 2
    s_waitcnt lgkmcnt(0)
    buffer_load_dwordx4 v[188:191], v208, s[52:55], s69 offen offset:3072 sc1
    s_mov_b64 exec, s[62:63]
    ds_read_b128 v[116:119], v211 offset:10240
    ds_read_b128 v[120:123], v211 offset:10752
    s_mov_b64 exec, -1
    ds_read_b64_tr_b16 v[200:201], v212 offset:6144
    ds_read_b64_tr_b16 v[202:203], v212 offset:6656
    ds_read_b64_tr_b16 v[204:205], v213 offset:6144
    ds_read_b64_tr_b16 v[206:207], v213 offset:6656
.p2align 3
    v_exp_f32 v32, v32
    v_exp_f32 v33, v33
    v_smfmac_f32_32x32x32_bf16 v[224:239], v[112:115], v[24:31], v124
    v_exp_f32 v34, v34
    s_waitcnt vmcnt(4) lgkmcnt(0)
    s_barrier
    v_exp_f32 v35, v35
    v_exp_f32 v36, v36
    v_exp_f32 v37, v37
    v_mfma_f32_32x32x16_bf16 v[16:31], v[104:107], v[96:99], v[48:63]
    v_exp_f32 v38, v38
    v_exp_f32 v39, v39
    v_exp_f32 v40, v40
    v_exp_f32 v41, v41
    v_mfma_f32_32x32x16_bf16 v[144:159], v[168:171], v[196:199], v[144:159]
    v_exp_f32 v42, v42
    v_exp_f32 v43, v43
    v_exp_f32 v44, v44
    v_exp_f32 v45, v45
    v_smfmac_f32_32x32x32_bf16 v[64:79], v[108:111], v[32:39], v124
    v_exp_f32 v46, v46
    v_exp_f32 v47, v47
    s_setprio 1
    s_waitcnt lgkmcnt(0)
    s_add_u32 m0, s80, 32768
    s_add_u32 s68, s80, 94208
    s_cmp_ge_u32 s56, 6
    s_cselect_b32 s68, 16777216, s68
    buffer_load_dwordx4 v208, s[52:55], s68 offen sc1 lds
    ds_read_b128 v[100:103], v209 offset:18432
    ds_read_b64_tr_b16 v[192:193], v212 offset:32768
    ds_read_b64_tr_b16 v[194:195], v212 offset:33280
    buffer_load_dwordx4 v208, s[52:55], s68 offen offset:1024 sc1 lds
.p2align 3
    v_exp_f32_e64 v16, v16
    v_smfmac_f32_32x32x32_bf16 v[64:79], v[112:115], v[40:47], v124
    v_exp_f32 v17, v17
    v_exp_f32 v18, v18
    v_exp_f32_e64 v19, v19
    v_mfma_f32_32x32x16_bf16 v[32:47], v[104:107], v[220:223], v[80:95]
    v_exp_f32 v20, v20
    v_exp_f32 v21, v21
    v_exp_f32_e64 v22, v22
    v_mfma_f32_32x32x16_bf16 v[128:143], v[172:175], v[200:203], v[128:143]
    v_exp_f32 v23, v23
    v_exp_f32 v24, v24
    v_exp_f32_e64 v25, v25
    v_smfmac_f32_32x32x32_bf16 v[224:239], v[116:119], v[16:23], v124
    v_exp_f32 v26, v26
    v_exp_f32 v27, v27
    v_exp_f32_e64 v28, v28
    v_mfma_f32_32x32x16_bf16 v[144:159], v[172:175], v[204:207], v[144:159]
    v_exp_f32 v29, v29
    v_exp_f32 v30, v30
    v_exp_f32 v31, v31
    s_waitcnt lgkmcnt(0)
    s_waitcnt vmcnt(5)
    s_add_u32 m0, s79, 65536
    s_add_u32 s68, s77, 262144
    buffer_load_dwordx4 v210, s[36:39], s68 offen offset:0  lds
    s_mov_b64 exec, s[62:63]
    ds_read_b128 v[108:111], v211 offset:18432
    ds_read_b128 v[112:115], v211 offset:18944
    s_mov_b64 exec, -1
    ds_read_b64_tr_b16 v[196:197], v213 offset:32768
    ds_read_b64_tr_b16 v[198:199], v213 offset:33280
    s_add_u32 m0, s79, 65536
    s_add_u32 s68, s77, 269312
    buffer_load_dwordx4 v210, s[36:39], s68 offen offset:1024  lds
    s_setprio 3
.p2align 3
    v_exp_f32 v32, v32
    v_exp_f32 v33, v33
    v_smfmac_f32_32x32x32_bf16 v[224:239], v[120:123], v[24:31], v124
    v_exp_f32 v34, v34
    v_exp_f32 v35, v35
    v_exp_f32 v36, v36
    v_exp_f32 v37, v37
    v_mfma_f32_32x32x16_bf16 v[16:31], v[100:103], v[96:99], v[48:63]
    v_exp_f32 v38, v38
    v_exp_f32 v39, v39
    v_exp_f32 v40, v40
    v_exp_f32 v41, v41
    v_mfma_f32_32x32x16_bf16 v[128:143], v[176:179], v[192:195], v[128:143]
    v_exp_f32 v42, v42
    v_exp_f32 v43, v43
    v_exp_f32 v44, v44
    v_exp_f32 v45, v45
    v_smfmac_f32_32x32x32_bf16 v[64:79], v[116:119], v[32:39], v124
    v_exp_f32 v46, v46
    v_exp_f32 v47, v47
    s_setprio 2
    s_waitcnt lgkmcnt(0)
    s_add_u32 m0, s79, 65536
    s_add_u32 s68, s77, 276480
    buffer_load_dwordx4 v210, s[36:39], s68 offen offset:2048  lds
    ds_read_b128 v[104:107], v209 offset:22528
    ds_read_b64_tr_b16 v[200:201], v212 offset:34816
    ds_read_b64_tr_b16 v[202:203], v212 offset:35328
    ds_read_b64_tr_b16 v[204:205], v213 offset:34816
    ds_read_b64_tr_b16 v[206:207], v213 offset:35328
.p2align 3
    v_exp_f32 v16, v16
    v_exp_f32 v17, v17
    v_smfmac_f32_32x32x32_bf16 v[64:79], v[120:123], v[40:47], v124
    v_exp_f32 v18, v18
    v_exp_f32 v19, v19
    v_exp_f32 v20, v20
    v_exp_f32 v21, v21
    v_mfma_f32_32x32x16_bf16 v[32:47], v[100:103], v[220:223], v[80:95]
    v_exp_f32 v22, v22
    v_exp_f32 v23, v23
    v_exp_f32 v24, v24
    v_exp_f32 v25, v25
    v_mfma_f32_32x32x16_bf16 v[144:159], v[176:179], v[196:199], v[144:159]
    v_exp_f32 v26, v26
    v_exp_f32 v27, v27
    v_exp_f32 v28, v28
    v_exp_f32 v29, v29
    v_smfmac_f32_32x32x32_bf16 v[224:239], v[108:111], v[16:23], v124
    v_exp_f32 v30, v30
    v_exp_f32 v31, v31
    s_setprio 1
    s_waitcnt lgkmcnt(0)
    s_waitcnt vmcnt(5)
    s_add_u32 m0, s79, 65536
    s_add_u32 s68, s77, 283648
    buffer_load_dwordx4 v210, s[36:39], s68 offen offset:3072  lds
    s_mov_b64 exec, s[62:63]
    ds_read_b128 v[116:119], v211 offset:22528
    ds_read_b128 v[120:123], v211 offset:23040
    s_mov_b64 exec, -1
    ds_read_b64_tr_b16 v[192:193], v212 offset:36864
    ds_read_b64_tr_b16 v[194:195], v212 offset:37376
    s_add_u32 s69, s78, 16384
    buffer_load_dwordx4 v[160:163], v208, s[52:55], s69 offen offset:0 sc1
.p2align 3
    v_exp_f32 v32, v32
    v_exp_f32 v33, v33
    v_smfmac_f32_32x32x32_bf16 v[224:239], v[112:115], v[24:31], v124
    v_exp_f32 v34, v34
    v_exp_f32 v35, v35
    v_exp_f32 v36, v36
    v_exp_f32 v37, v37
    v_mfma_f32_32x32x16_bf16 v[16:31], v[104:107], v[96:99], v[48:63]
    v_exp_f32 v38, v38
    v_exp_f32 v39, v39
    v_exp_f32 v40, v40
    v_exp_f32 v41, v41
    v_mfma_f32_32x32x16_bf16 v[128:143], v[180:183], v[200:203], v[128:143]
    v_exp_f32 v42, v42
    v_exp_f32 v43, v43
    v_exp_f32 v44, v44
    v_exp_f32 v45, v45
    v_smfmac_f32_32x32x32_bf16 v[64:79], v[108:111], v[32:39], v124
    v_exp_f32 v46, v46
    v_exp_f32 v47, v47
    s_waitcnt lgkmcnt(0)
    buffer_load_dwordx4 v[164:167], v208, s[52:55], s69 offen offset:1024 sc1
    ds_read_b128 v[100:103], v209 offset:26624
    ds_read_b64_tr_b16 v[196:197], v213 offset:36864
    ds_read_b64_tr_b16 v[198:199], v213 offset:37376
    buffer_load_dwordx4 v[168:171], v208, s[52:55], s69 offen offset:2048 sc1
    s_mov_b64 exec, 3
    global_load_dword v2, v[252:253], off
    s_mov_b64 exec, -1
    s_setprio 3
.p2align 3
    v_exp_f32_e64 v16, v16
    v_smfmac_f32_32x32x32_bf16 v[64:79], v[112:115], v[40:47], v124
    v_exp_f32 v17, v17
    v_exp_f32 v18, v18
    v_exp_f32_e64 v19, v19
    v_mfma_f32_32x32x16_bf16 v[32:47], v[104:107], v[220:223], v[80:95]
    v_exp_f32 v20, v20
    v_exp_f32 v21, v21
    v_exp_f32_e64 v22, v22
    v_mfma_f32_32x32x16_bf16 v[144:159], v[180:183], v[204:207], v[144:159]
    v_exp_f32 v23, v23
    v_exp_f32 v24, v24
    v_exp_f32_e64 v25, v25
    v_smfmac_f32_32x32x32_bf16 v[224:239], v[116:119], v[16:23], v124
    v_exp_f32 v26, v26
    v_exp_f32 v27, v27
    v_exp_f32_e64 v28, v28
    v_mfma_f32_32x32x16_bf16 v[128:143], v[184:187], v[192:195], v[128:143]
    v_exp_f32 v29, v29
    v_exp_f32 v30, v30
    v_exp_f32 v31, v31
    s_setprio 2
    s_waitcnt lgkmcnt(0)
    buffer_load_dwordx4 v[172:175], v208, s[52:55], s69 offen offset:3072 sc1
    s_mov_b64 exec, s[62:63]
    ds_read_b128 v[108:111], v211 offset:26624
    ds_read_b128 v[112:115], v211 offset:27136
    s_mov_b64 exec, -1
    ds_read_b64_tr_b16 v[200:201], v212 offset:38912
    ds_read_b64_tr_b16 v[202:203], v212 offset:39424
    ds_read_b64_tr_b16 v[204:205], v213 offset:38912
    ds_read_b64_tr_b16 v[206:207], v213 offset:39424
.p2align 3
    v_exp_f32 v32, v32
    v_exp_f32 v33, v33
    v_smfmac_f32_32x32x32_bf16 v[224:239], v[120:123], v[24:31], v124
    v_exp_f32 v34, v34
    s_waitcnt vmcnt(5) lgkmcnt(0)
    s_barrier
    v_exp_f32 v35, v35
    v_exp_f32 v36, v36
    v_exp_f32 v37, v37
    v_mfma_f32_32x32x16_bf16 v[16:31], v[100:103], v[96:99], v[48:63]
    v_exp_f32 v38, v38
    v_exp_f32 v39, v39
    v_exp_f32 v40, v40
    v_exp_f32 v41, v41
    v_mfma_f32_32x32x16_bf16 v[144:159], v[184:187], v[196:199], v[144:159]
    v_exp_f32 v42, v42
    v_exp_f32 v43, v43
    v_exp_f32 v44, v44
    v_exp_f32 v45, v45
    v_smfmac_f32_32x32x32_bf16 v[64:79], v[116:119], v[32:39], v124
    v_exp_f32 v46, v46
    v_exp_f32 v47, v47
    s_setprio 1
    s_waitcnt lgkmcnt(0)
    s_add_u32 m0, s80, 0
    s_add_u32 s68, s80, 106496
    s_cmp_ge_u32 s56, 6
    s_cselect_b32 s68, 16777216, s68
    buffer_load_dwordx4 v208, s[52:55], s68 offen sc1 lds
    ds_read_b128 v[104:107], v209 offset:34816
    ds_read_b64_tr_b16 v[192:193], v212 offset:0
    ds_read_b64_tr_b16 v[194:195], v212 offset:512
    buffer_load_dwordx4 v208, s[52:55], s68 offen offset:1024 sc1 lds
.p2align 3
    v_exp_f32_e64 v16, v16
    v_smfmac_f32_32x32x32_bf16 v[64:79], v[120:123], v[40:47], v124
    v_exp_f32 v17, v17
    v_exp_f32 v18, v18
    v_exp_f32_e64 v19, v19
    v_mfma_f32_32x32x16_bf16 v[32:47], v[100:103], v[220:223], v[80:95]
    v_exp_f32 v20, v20
    v_exp_f32 v21, v21
    v_exp_f32_e64 v22, v22
    v_mfma_f32_32x32x16_bf16 v[128:143], v[188:191], v[200:203], v[128:143]
    v_exp_f32 v23, v23
    v_exp_f32 v24, v24
    v_exp_f32_e64 v25, v25
    v_smfmac_f32_32x32x32_bf16 v[224:239], v[108:111], v[16:23], v124
    v_exp_f32 v26, v26
    v_exp_f32 v27, v27
    v_exp_f32_e64 v28, v28
    v_mfma_f32_32x32x16_bf16 v[144:159], v[188:191], v[204:207], v[144:159]
    v_exp_f32 v29, v29
    v_exp_f32 v30, v30
    v_exp_f32 v31, v31
    s_waitcnt lgkmcnt(0)
    s_waitcnt vmcnt(6)
    s_add_u32 m0, s79, 98304
    s_add_u32 s68, s77, 327680
    buffer_load_dwordx4 v210, s[36:39], s68 offen offset:0  lds
    s_mov_b64 exec, s[62:63]
    ds_read_b128 v[116:119], v211 offset:34816
    ds_read_b128 v[120:123], v211 offset:35328
    s_mov_b64 exec, -1
    ds_read_b64_tr_b16 v[196:197], v213 offset:0
    ds_read_b64_tr_b16 v[198:199], v213 offset:512
    s_add_u32 m0, s79, 98304
    s_add_u32 s68, s77, 334848
    buffer_load_dwordx4 v210, s[36:39], s68 offen offset:1024  lds
    s_setprio 3
.p2align 3
    v_exp_f32 v32, v32
    v_exp_f32 v33, v33
    v_smfmac_f32_32x32x32_bf16 v[224:239], v[112:115], v[24:31], v124
    v_exp_f32 v34, v34
    v_exp_f32 v35, v35
    v_exp_f32 v36, v36
    v_exp_f32 v37, v37
    v_mfma_f32_32x32x16_bf16 v[16:31], v[104:107], v[96:99], v[48:63]
    v_exp_f32 v38, v38
    v_exp_f32 v39, v39
    v_exp_f32 v40, v40
    v_exp_f32 v41, v41
    v_mfma_f32_32x32x16_bf16 v[128:143], v[160:163], v[192:195], v[128:143]
    v_exp_f32 v42, v42
    v_exp_f32 v43, v43
    v_exp_f32 v44, v44
    v_exp_f32 v45, v45
    v_smfmac_f32_32x32x32_bf16 v[64:79], v[108:111], v[32:39], v124
    v_exp_f32 v46, v46
    v_exp_f32 v47, v47
    s_setprio 2
    s_branch L_pg166
.p2align 12
L_stub166:
    s_nop 0
    s_setpc_b64 s[0:1]
L_pg166:
    s_waitcnt lgkmcnt(0)
    s_add_u32 m0, s79, 98304
    s_add_u32 s68, s77, 342016
    buffer_load_dwordx4 v210, s[36:39], s68 offen offset:2048  lds
    ds_read_b128 v[100:103], v209 offset:38912
    ds_read_b64_tr_b16 v[200:201], v212 offset:2048
    ds_read_b64_tr_b16 v[202:203], v212 offset:2560
    ds_read_b64_tr_b16 v[204:205], v213 offset:2048
    ds_read_b64_tr_b16 v[206:207], v213 offset:2560
.p2align 3
    v_exp_f32 v16, v16
    v_exp_f32 v17, v17
    v_smfmac_f32_32x32x32_bf16 v[64:79], v[112:115], v[40:47], v124
    v_exp_f32 v18, v18
    v_exp_f32 v19, v19
    v_exp_f32 v20, v20
    v_exp_f32 v21, v21
    v_mfma_f32_32x32x16_bf16 v[32:47], v[104:107], v[220:223], v[80:95]
    v_exp_f32 v22, v22
    v_exp_f32 v23, v23
    v_exp_f32 v24, v24
    v_exp_f32 v25, v25
    v_mfma_f32_32x32x16_bf16 v[144:159], v[160:163], v[196:199], v[144:159]
    v_exp_f32 v26, v26
    v_exp_f32 v27, v27
    v_exp_f32 v28, v28
    v_exp_f32 v29, v29
    v_smfmac_f32_32x32x32_bf16 v[224:239], v[116:119], v[16:23], v124
    v_exp_f32 v30, v30
    v_exp_f32 v31, v31
    s_setprio 1
    s_waitcnt lgkmcnt(0)
    s_waitcnt vmcnt(5)
    s_add_u32 m0, s79, 98304
    s_add_u32 s68, s77, 349184
    buffer_load_dwordx4 v210, s[36:39], s68 offen offset:3072  lds
    s_mov_b64 exec, s[62:63]
    ds_read_b128 v[108:111], v211 offset:38912
    ds_read_b128 v[112:115], v211 offset:39424
    s_mov_b64 exec, -1
    ds_read_b64_tr_b16 v[192:193], v212 offset:4096
    ds_read_b64_tr_b16 v[194:195], v212 offset:4608
    s_add_u32 s69, s78, 20480
    buffer_load_dwordx4 v[176:179], v208, s[52:55], s69 offen offset:0 sc1
.p2align 3
    v_exp_f32 v32, v32
    v_exp_f32 v33, v33
    v_smfmac_f32_32x32x32_bf16 v[224:239], v[120:123], v[24:31], v124
    v_exp_f32 v34, v34
    v_exp_f32 v35, v35
    v_exp_f32 v36, v36
    v_exp_f32 v37, v37
    v_mfma_f32_32x32x16_bf16 v[16:31], v[100:103], v[96:99], v[48:63]
    v_exp_f32 v38, v38
    v_exp_f32 v39, v39
    v_exp_f32 v40, v40
    v_exp_f32 v41, v41
    v_mfma_f32_32x32x16_bf16 v[128:143], v[164:167], v[200:203], v[128:143]
    v_exp_f32 v42, v42
    v_exp_f32 v43, v43
    v_exp_f32 v44, v44
    v_exp_f32 v45, v45
    v_smfmac_f32_32x32x32_bf16 v[64:79], v[116:119], v[32:39], v124
    v_exp_f32 v46, v46
    v_exp_f32 v47, v47
    s_waitcnt lgkmcnt(0)
    buffer_load_dwordx4 v[180:183], v208, s[52:55], s69 offen offset:1024 sc1
    ds_read_b128 v[104:107], v209 offset:43008
    ds_read_b64_tr_b16 v[196:197], v213 offset:4096
    ds_read_b64_tr_b16 v[198:199], v213 offset:4608
    buffer_load_dwordx4 v[184:187], v208, s[52:55], s69 offen offset:2048 sc1
    s_setprio 3
.p2align 3
    v_exp_f32_e64 v16, v16
    v_smfmac_f32_32x32x32_bf16 v[64:79], v[120:123], v[40:47], v124
    v_exp_f32 v17, v17
    v_exp_f32 v18, v18
    v_exp_f32_e64 v19, v19
    v_mfma_f32_32x32x16_bf16 v[32:47], v[100:103], v[220:223], v[80:95]
    v_exp_f32 v20, v20
    v_exp_f32 v21, v21
    v_exp_f32_e64 v22, v22
    v_mfma_f32_32x32x16_bf16 v[144:159], v[164:167], v[204:207], v[144:159]
    v_exp_f32 v23, v23
    v_exp_f32 v24, v24
    v_exp_f32_e64 v25, v25
    v_smfmac_f32_32x32x32_bf16 v[224:239], v[108:111], v[16:23], v124
    v_exp_f32 v26, v26
    v_exp_f32 v27, v27
    v_exp_f32_e64 v28, v28
    v_mfma_f32_32x32x16_bf16 v[128:143], v[168:171], v[192:195], v[128:143]
    v_exp_f32 v29, v29
    v_exp_f32 v30, v30
    v_exp_f32 v31, v31
    s_setprio 2
    s_waitcnt lgkmcnt(0)
    buffer_load_dwordx4 v[188:191], v208, s[52:55], s69 offen offset:3072 sc1
    s_mov_b64 exec, s[62:63]
    ds_read_b128 v[116:119], v211 offset:43008
    ds_read_b128 v[120:123], v211 offset:43520
    s_mov_b64 exec, -1
    ds_read_b64_tr_b16 v[200:201], v212 offset:6144
    ds_read_b64_tr_b16 v[202:203], v212 offset:6656
    ds_read_b64_tr_b16 v[204:205], v213 offset:6144
    ds_read_b64_tr_b16 v[206:207], v213 offset:6656
.p2align 3
    v_exp_f32 v32, v32
    v_exp_f32 v33, v33
    v_smfmac_f32_32x32x32_bf16 v[224:239], v[112:115], v[24:31], v124
    v_exp_f32 v34, v34
    s_waitcnt vmcnt(4) lgkmcnt(0)
    s_barrier
    v_exp_f32 v35, v35
    v_exp_f32 v36, v36
    v_exp_f32 v37, v37
    v_mfma_f32_32x32x16_bf16 v[16:31], v[104:107], v[96:99], v[48:63]
    v_exp_f32 v38, v38
    v_exp_f32 v39, v39
    v_exp_f32 v40, v40
    v_exp_f32 v41, v41
    v_mfma_f32_32x32x16_bf16 v[144:159], v[168:171], v[196:199], v[144:159]
    v_exp_f32 v42, v42
    v_exp_f32 v43, v43
    v_exp_f32 v44, v44
    v_exp_f32 v45, v45
    v_smfmac_f32_32x32x32_bf16 v[64:79], v[108:111], v[32:39], v124
    v_exp_f32 v46, v46
    v_exp_f32 v47, v47
    s_setprio 1
    s_waitcnt lgkmcnt(0)
    s_add_u32 m0, s80, 16384
    s_add_u32 s68, s80, 118784
    s_cmp_ge_u32 s56, 6
    s_cselect_b32 s68, 16777216, s68
    buffer_load_dwordx4 v208, s[52:55], s68 offen sc1 lds
    ds_read_b128 v[100:103], v209 offset:2048
    ds_read_b64_tr_b16 v[192:193], v212 offset:32768
    ds_read_b64_tr_b16 v[194:195], v212 offset:33280
    buffer_load_dwordx4 v208, s[52:55], s68 offen offset:1024 sc1 lds
.p2align 3
    v_exp_f32_e64 v16, v16
    v_smfmac_f32_32x32x32_bf16 v[64:79], v[112:115], v[40:47], v124
    v_exp_f32 v17, v17
    v_exp_f32 v18, v18
    v_exp_f32_e64 v19, v19
    v_mfma_f32_32x32x16_bf16 v[32:47], v[104:107], v[220:223], v[80:95]
    v_exp_f32 v20, v20
    v_exp_f32 v21, v21
    v_exp_f32_e64 v22, v22
    v_mfma_f32_32x32x16_bf16 v[128:143], v[172:175], v[200:203], v[128:143]
    v_exp_f32 v23, v23
    v_exp_f32 v24, v24
    v_exp_f32_e64 v25, v25
    v_smfmac_f32_32x32x32_bf16 v[224:239], v[116:119], v[16:23], v124
    v_exp_f32 v26, v26
    v_exp_f32 v27, v27
    v_exp_f32_e64 v28, v28
    v_mfma_f32_32x32x16_bf16 v[144:159], v[172:175], v[204:207], v[144:159]
    v_exp_f32 v29, v29
    v_exp_f32 v30, v30
    v_exp_f32 v31, v31
    s_waitcnt lgkmcnt(0)
    s_waitcnt vmcnt(5)
    s_add_u32 m0, s79, 65536
    s_add_u32 s68, s77, 393216
    buffer_load_dwordx4 v210, s[36:39], s68 offen offset:0  lds
    s_mov_b64 exec, s[62:63]
    ds_read_b128 v[108:111], v211 offset:2048
    ds_read_b128 v[112:115], v211 offset:2560
    s_mov_b64 exec, -1
    ds_read_b64_tr_b16 v[196:197], v213 offset:32768
    ds_read_b64_tr_b16 v[198:199], v213 offset:33280
    s_add_u32 m0, s79, 65536
    s_add_u32 s68, s77, 400384
    buffer_load_dwordx4 v210, s[36:39], s68 offen offset:1024  lds
    s_setprio 3
.p2align 3
    v_exp_f32 v32, v32
    v_exp_f32 v33, v33
    v_smfmac_f32_32x32x32_bf16 v[224:239], v[120:123], v[24:31], v124
    v_exp_f32 v34, v34
    v_exp_f32 v35, v35
    v_exp_f32 v36, v36
    v_exp_f32 v37, v37
    v_mfma_f32_32x32x16_bf16 v[16:31], v[100:103], v[96:99], v[48:63]
    v_exp_f32 v38, v38
    v_exp_f32 v39, v39
    v_exp_f32 v40, v40
    v_exp_f32 v41, v41
    v_mfma_f32_32x32x16_bf16 v[128:143], v[176:179], v[192:195], v[128:143]
    v_exp_f32 v42, v42
    v_exp_f32 v43, v43
    v_exp_f32 v44, v44
    v_exp_f32 v45, v45
    v_smfmac_f32_32x32x32_bf16 v[64:79], v[116:119], v[32:39], v124
    v_exp_f32 v46, v46
    v_exp_f32 v47, v47
    s_setprio 2
    s_waitcnt lgkmcnt(0)
    s_add_u32 m0, s79, 65536
    s_add_u32 s68, s77, 407552
    buffer_load_dwordx4 v210, s[36:39], s68 offen offset:2048  lds
    ds_read_b128 v[104:107], v209 offset:6144
    ds_read_b64_tr_b16 v[200:201], v212 offset:34816
    ds_read_b64_tr_b16 v[202:203], v212 offset:35328
    ds_read_b64_tr_b16 v[204:205], v213 offset:34816
    ds_read_b64_tr_b16 v[206:207], v213 offset:35328
    ds_read_b64_tr_b16 v[240:241], v126 offset:0
    ds_read_b64_tr_b16 v[242:243], v126 offset:512
.p2align 3
    v_exp_f32 v16, v16
    v_exp_f32 v17, v17
    v_smfmac_f32_32x32x32_bf16 v[64:79], v[120:123], v[40:47], v124
    v_exp_f32 v18, v18
    v_exp_f32 v19, v19
    v_exp_f32 v20, v20
    v_exp_f32 v21, v21
    v_mfma_f32_32x32x16_bf16 v[32:47], v[100:103], v[220:223], v[80:95]
    v_exp_f32 v22, v22
    v_exp_f32 v23, v23
    v_exp_f32 v24, v24
    v_exp_f32 v25, v25
    v_mfma_f32_32x32x16_bf16 v[144:159], v[176:179], v[196:199], v[144:159]
    v_exp_f32 v26, v26
    v_exp_f32 v27, v27
    v_exp_f32 v28, v28
    v_exp_f32 v29, v29
    v_smfmac_f32_32x32x32_bf16 v[224:239], v[108:111], v[16:23], v124
    v_exp_f32 v30, v30
    v_exp_f32 v31, v31
    s_setprio 1
    s_waitcnt lgkmcnt(0)
    s_waitcnt vmcnt(5)
    s_add_u32 m0, s79, 65536
    s_add_u32 s68, s77, 414720
    buffer_load_dwordx4 v210, s[36:39], s68 offen offset:3072  lds
    s_mov_b64 exec, s[62:63]
    ds_read_b128 v[116:119], v211 offset:6144
    ds_read_b128 v[120:123], v211 offset:6656
    s_mov_b64 exec, -1
    ds_read_b64_tr_b16 v[192:193], v212 offset:36864
    ds_read_b64_tr_b16 v[194:195], v212 offset:37376
    s_add_u32 s69, s78, 24576
    buffer_load_dwordx4 v[160:163], v208, s[52:55], s69 offen offset:0 sc1
.p2align 3
    v_exp_f32 v32, v32
    v_exp_f32 v33, v33
    v_smfmac_f32_32x32x32_bf16 v[224:239], v[112:115], v[24:31], v124
    v_exp_f32 v34, v34
    v_exp_f32 v35, v35
    v_exp_f32 v36, v36
    v_exp_f32 v37, v37
    v_mfma_f32_32x32x16_bf16 v[16:31], v[104:107], v[96:99], v[48:63]
    v_exp_f32 v38, v38
    v_exp_f32 v39, v39
    v_exp_f32 v40, v40
    v_exp_f32 v41, v41
    v_mfma_f32_32x32x16_bf16 v[128:143], v[180:183], v[200:203], v[128:143]
    v_exp_f32 v42, v42
    v_exp_f32 v43, v43
    v_exp_f32 v44, v44
    v_exp_f32 v45, v45
    v_smfmac_f32_32x32x32_bf16 v[64:79], v[108:111], v[32:39], v124
    v_exp_f32 v46, v46
    v_exp_f32 v47, v47
    s_waitcnt lgkmcnt(0)
    buffer_load_dwordx4 v[164:167], v208, s[52:55], s69 offen offset:1024 sc1
    ds_read_b128 v[100:103], v209 offset:10240
    ds_read_b64_tr_b16 v[196:197], v213 offset:36864
    ds_read_b64_tr_b16 v[198:199], v213 offset:37376
    ds_read_b64_tr_b16 v[244:245], v127 offset:0
    ds_read_b64_tr_b16 v[246:247], v127 offset:512
    buffer_load_dwordx4 v[168:171], v208, s[52:55], s69 offen offset:2048 sc1
    s_setprio 3
.p2align 3
    v_exp_f32_e64 v16, v16
    v_smfmac_f32_32x32x32_bf16 v[64:79], v[112:115], v[40:47], v124
    v_exp_f32 v17, v17
    v_exp_f32 v18, v18
    v_exp_f32_e64 v19, v19
    v_mfma_f32_32x32x16_bf16 v[32:47], v[104:107], v[220:223], v[80:95]
    v_exp_f32 v20, v20
    v_exp_f32 v21, v21
    v_exp_f32_e64 v22, v22
    v_mfma_f32_32x32x16_bf16 v[144:159], v[180:183], v[204:207], v[144:159]
    v_exp_f32 v23, v23
    v_exp_f32 v24, v24
    v_exp_f32_e64 v25, v25
    v_smfmac_f32_32x32x32_bf16 v[224:239], v[116:119], v[16:23], v124
    v_exp_f32 v26, v26
    v_exp_f32 v27, v27
    v_exp_f32_e64 v28, v28
    v_mfma_f32_32x32x16_bf16 v[128:143], v[184:187], v[192:195], v[128:143]
    v_exp_f32 v29, v29
    v_exp_f32 v30, v30
    v_exp_f32 v31, v31
    s_setprio 2
    s_waitcnt lgkmcnt(0)
    buffer_load_dwordx4 v[172:175], v208, s[52:55], s69 offen offset:3072 sc1
    s_mov_b64 exec, s[62:63]
    ds_read_b128 v[108:111], v211 offset:10240
    ds_read_b128 v[112:115], v211 offset:10752
    s_mov_b64 exec, -1
    ds_read_b64_tr_b16 v[200:201], v212 offset:38912
    ds_read_b64_tr_b16 v[202:203], v212 offset:39424
    ds_read_b64_tr_b16 v[204:205], v213 offset:38912
    ds_read_b64_tr_b16 v[206:207], v213 offset:39424
.p2align 3
    v_exp_f32 v32, v32
    v_exp_f32 v33, v33
    v_smfmac_f32_32x32x32_bf16 v[224:239], v[120:123], v[24:31], v124
    v_exp_f32 v34, v34
    s_waitcnt vmcnt(4) lgkmcnt(0)
    s_barrier
    v_exp_f32 v35, v35
    v_exp_f32 v36, v36
    v_exp_f32 v37, v37
    v_mfma_f32_32x32x16_bf16 v[16:31], v[100:103], v[96:99], v[48:63]
    v_exp_f32 v38, v38
    v_exp_f32 v39, v39
    v_exp_f32 v40, v40
    v_exp_f32 v41, v41
    v_mfma_f32_32x32x16_bf16 v[144:159], v[184:187], v[196:199], v[144:159]
    v_exp_f32 v42, v42
    v_exp_f32 v43, v43
    v_exp_f32 v44, v44
    v_exp_f32 v45, v45
    v_smfmac_f32_32x32x32_bf16 v[64:79], v[116:119], v[32:39], v124
    v_exp_f32 v46, v46
    v_exp_f32 v47, v47
    s_setprio 1
    s_waitcnt lgkmcnt(0)
    s_add_u32 m0, s79, 98304
    s_add_u32 s68, s82, 0
    buffer_load_dwordx4 v210, s[40:43], s68 offen offset:0  lds
    ds_read_b128 v[104:107], v209 offset:18432
    ds_read_b64_tr_b16 v[192:193], v212 offset:0
    ds_read_b64_tr_b16 v[194:195], v212 offset:512
    ds_read_b64_tr_b16 v[248:249], v126 offset:2048
    ds_read_b64_tr_b16 v[250:251], v126 offset:2560
    s_add_u32 m0, s79, 98304
    s_add_u32 s68, s82, 7168
    buffer_load_dwordx4 v210, s[40:43], s68 offen offset:1024  lds
.p2align 3
    v_exp_f32_e64 v16, v16
    v_smfmac_f32_32x32x32_bf16 v[64:79], v[120:123], v[40:47], v124
    v_exp_f32 v17, v17
    v_exp_f32 v18, v18
    v_exp_f32_e64 v19, v19
    v_mfma_f32_32x32x16_bf16 v[32:47], v[100:103], v[220:223], v[80:95]
    v_exp_f32 v20, v20
    v_exp_f32 v21, v21
    v_exp_f32_e64 v22, v22
    v_mfma_f32_32x32x16_bf16 v[128:143], v[188:191], v[200:203], v[128:143]
    v_exp_f32 v23, v23
    v_exp_f32 v24, v24
    v_exp_f32_e64 v25, v25
    v_smfmac_f32_32x32x32_bf16 v[224:239], v[108:111], v[16:23], v124
    v_exp_f32 v26, v26
    v_exp_f32 v27, v27
    v_exp_f32_e64 v28, v28
    v_mfma_f32_32x32x16_bf16 v[144:159], v[188:191], v[204:207], v[144:159]
    v_exp_f32 v29, v29
    v_exp_f32 v30, v30
    v_exp_f32 v31, v31
    s_waitcnt lgkmcnt(0)
    s_waitcnt vmcnt(5)
    s_add_u32 m0, s79, 98304
    s_add_u32 s68, s82, 14336
    buffer_load_dwordx4 v210, s[40:43], s68 offen offset:2048  lds
    s_mov_b64 exec, s[62:63]
    ds_read_b128 v[116:119], v211 offset:18432
    ds_read_b128 v[120:123], v211 offset:18944
    s_mov_b64 exec, -1
    ds_read_b64_tr_b16 v[196:197], v213 offset:0
    ds_read_b64_tr_b16 v[198:199], v213 offset:512
    ds_read_b64_tr_b16 v[176:177], v127 offset:2048
    ds_read_b64_tr_b16 v[178:179], v127 offset:2560
    s_add_u32 m0, s79, 98304
    s_add_u32 s68, s82, 21504
    buffer_load_dwordx4 v210, s[40:43], s68 offen offset:3072  lds
    s_setprio 3
.p2align 3
    v_exp_f32 v32, v32
    v_exp_f32 v33, v33
    v_smfmac_f32_32x32x32_bf16 v[224:239], v[112:115], v[24:31], v124
    v_exp_f32 v34, v34
    v_exp_f32 v35, v35
    v_exp_f32 v36, v36
    v_exp_f32 v37, v37
    v_mfma_f32_32x32x16_bf16 v[16:31], v[104:107], v[96:99], v[48:63]
    v_exp_f32 v38, v38
    v_exp_f32 v39, v39
    v_exp_f32 v40, v40
    v_exp_f32 v41, v41
    v_mfma_f32_32x32x16_bf16 v[128:143], v[160:163], v[192:195], v[128:143]
    v_exp_f32 v42, v42
    v_exp_f32 v43, v43
    v_exp_f32 v44, v44
    v_exp_f32 v45, v45
    v_smfmac_f32_32x32x32_bf16 v[64:79], v[108:111], v[32:39], v124
    v_exp_f32 v46, v46
    v_exp_f32 v47, v47
    s_setprio 2
    s_waitcnt lgkmcnt(0)
    buffer_load_dwordx4 v[216:219], v215, s[28:31], 0 offen
    ds_read_b128 v[100:103], v209 offset:22528
    ds_read_b64_tr_b16 v[200:201], v212 offset:2048
    ds_read_b64_tr_b16 v[202:203], v212 offset:2560
    ds_read_b64_tr_b16 v[204:205], v213 offset:2048
    ds_read_b64_tr_b16 v[206:207], v213 offset:2560
    ds_read_b64_tr_b16 v[180:181], v126 offset:8192
    ds_read_b64_tr_b16 v[182:183], v126 offset:8704
    ds_read_b64_tr_b16 v[184:185], v127 offset:8192
    ds_read_b64_tr_b16 v[186:187], v127 offset:8704
.p2align 3
    v_exp_f32 v16, v16
    v_exp_f32 v17, v17
    v_smfmac_f32_32x32x32_bf16 v[64:79], v[112:115], v[40:47], v124
    v_exp_f32 v18, v18
    v_exp_f32 v19, v19
    v_exp_f32 v20, v20
    v_exp_f32 v21, v21
    v_mfma_f32_32x32x16_bf16 v[32:47], v[104:107], v[220:223], v[80:95]
    v_exp_f32 v22, v22
    v_exp_f32 v23, v23
    v_exp_f32 v24, v24
    v_exp_f32 v25, v25
    v_mfma_f32_32x32x16_bf16 v[144:159], v[160:163], v[196:199], v[144:159]
    v_exp_f32 v26, v26
    v_exp_f32 v27, v27
    v_exp_f32 v28, v28
    v_exp_f32 v29, v29
    v_smfmac_f32_32x32x32_bf16 v[224:239], v[116:119], v[16:23], v124
    v_exp_f32 v30, v30
    v_exp_f32 v31, v31
    s_setprio 1
    s_waitcnt lgkmcnt(0)
    s_waitcnt vmcnt(5)
    ds_read_b128 v[104:107], v209 offset:26624
    s_mov_b64 exec, s[62:63]
    ds_read_b128 v[108:111], v211 offset:22528
    ds_read_b128 v[112:115], v211 offset:23040
    s_mov_b64 exec, -1
    ds_read_b64_tr_b16 v[192:193], v212 offset:4096
    ds_read_b64_tr_b16 v[194:195], v212 offset:4608
.p2align 3
    v_exp_f32 v32, v32
    v_exp_f32 v33, v33
    v_smfmac_f32_32x32x32_bf16 v[224:239], v[120:123], v[24:31], v124
    v_exp_f32 v34, v34
    v_exp_f32 v35, v35
    v_exp_f32 v36, v36
    v_exp_f32 v37, v37
    v_mfma_f32_32x32x16_bf16 v[16:31], v[100:103], v[96:99], v[48:63]
    v_exp_f32 v38, v38
    v_exp_f32 v39, v39
    v_exp_f32 v40, v40
    v_exp_f32 v41, v41
    v_mfma_f32_32x32x16_bf16 v[128:143], v[164:167], v[200:203], v[128:143]
    v_exp_f32 v42, v42
    v_exp_f32 v43, v43
    v_exp_f32 v44, v44
    v_exp_f32 v45, v45
    v_smfmac_f32_32x32x32_bf16 v[64:79], v[116:119], v[32:39], v124
    v_exp_f32 v46, v46
    v_exp_f32 v47, v47
    s_waitcnt lgkmcnt(0)
    s_mov_b64 exec, s[62:63]
    ds_read_b128 v[116:119], v211 offset:26624
    s_mov_b64 exec, -1
    ds_read_b64_tr_b16 v[196:197], v213 offset:4096
    ds_read_b64_tr_b16 v[198:199], v213 offset:4608
    ds_read_b64_tr_b16 v[188:189], v126 offset:10240
    ds_read_b64_tr_b16 v[190:191], v126 offset:10752
    ds_read_b64_tr_b16 v[160:161], v127 offset:10240
    ds_read_b64_tr_b16 v[162:163], v127 offset:10752
    s_setprio 3
.p2align 3
    v_exp_f32_e64 v16, v16
    v_smfmac_f32_32x32x32_bf16 v[64:79], v[120:123], v[40:47], v124
    v_exp_f32 v17, v17
    v_exp_f32 v18, v18
    v_exp_f32_e64 v19, v19
    v_mfma_f32_32x32x16_bf16 v[32:47], v[104:107], v[96:99], v[48:63]
    v_exp_f32 v20, v20
    v_exp_f32 v21, v21
    v_exp_f32_e64 v22, v22
    v_mfma_f32_32x32x16_bf16 v[144:159], v[164:167], v[204:207], v[144:159]
    v_exp_f32 v23, v23
    v_exp_f32 v24, v24
    v_exp_f32_e64 v25, v25
    v_smfmac_f32_32x32x32_bf16 v[224:239], v[108:111], v[16:23], v124
    v_exp_f32 v26, v26
    v_exp_f32 v27, v27
    v_exp_f32_e64 v28, v28
    v_mfma_f32_32x32x16_bf16 v[128:143], v[168:171], v[192:195], v[128:143]
    v_exp_f32 v29, v29
    v_exp_f32 v30, v30
    v_exp_f32 v31, v31
    s_setprio 2
    s_waitcnt lgkmcnt(0)
    s_mov_b64 exec, s[62:63]
    ds_read_b128 v[120:123], v211 offset:27136
    s_mov_b64 exec, -1
    ds_read_b64_tr_b16 v[200:201], v212 offset:6144
    ds_read_b64_tr_b16 v[202:203], v212 offset:6656
    ds_read_b64_tr_b16 v[204:205], v213 offset:6144
    ds_read_b64_tr_b16 v[206:207], v213 offset:6656
    ds_read_b64_tr_b16 v[48:49], v126 offset:4096
    ds_read_b64_tr_b16 v[50:51], v126 offset:4608
    ds_read_b64_tr_b16 v[52:53], v127 offset:4096
    ds_read_b64_tr_b16 v[54:55], v127 offset:4608
.p2align 3
    v_exp_f32 v32, v32
    v_exp_f32 v33, v33
    v_smfmac_f32_32x32x32_bf16 v[224:239], v[112:115], v[24:31], v124
    v_exp_f32_e64 v34, v34
    v_lshrrev_b32_e64 v3, 1, v125
    v_exp_f32 v35, v35
    v_exp_f32 v36, v36
    v_exp_f32_e64 v37, v37
    v_mfma_f32_32x32x16_bf16 v[16:31], v[100:103], v[220:223], v[80:95]
    v_exp_f32 v38, v38
    v_exp_f32 v39, v39
    v_exp_f32 v40, v40
    v_exp_f32 v41, v41
    v_mfma_f32_32x32x16_bf16 v[144:159], v[168:171], v[196:199], v[144:159]
    v_exp_f32 v42, v42
    v_exp_f32 v43, v43
    v_exp_f32 v44, v44
    v_exp_f32 v45, v45
    v_smfmac_f32_32x32x32_bf16 v[224:239], v[116:119], v[32:39], v124
    v_exp_f32 v46, v46
    v_exp_f32 v47, v47
    s_setprio 1
    s_waitcnt lgkmcnt(0)
    ds_read_b64_tr_b16 v[164:165], v126 offset:6144
    ds_read_b64_tr_b16 v[166:167], v126 offset:6656
    ds_read_b64_tr_b16 v[56:57], v127 offset:6144
    ds_read_b64_tr_b16 v[58:59], v127 offset:6656
    ds_read_b64_tr_b16 v[60:61], v126 offset:12288
    ds_read_b64_tr_b16 v[62:63], v126 offset:12800
    ds_read_b64_tr_b16 v[168:169], v127 offset:12288
    ds_read_b64_tr_b16 v[170:171], v127 offset:12800
    ds_read_b64_tr_b16 v[96:97], v126 offset:14336
    ds_read_b64_tr_b16 v[98:99], v126 offset:14848
.p2align 3
    v_exp_f32_e64 v16, v16
    v_smfmac_f32_32x32x32_bf16 v[224:239], v[120:123], v[40:47], v124
    v_exp_f32 v17, v17
    v_exp_f32 v18, v18
    v_exp_f32_e64 v19, v19
    v_mfma_f32_32x32x16_bf16 v[32:47], v[104:107], v[220:223], v[80:95]
    v_exp_f32 v20, v20
    v_exp_f32 v21, v21
    v_exp_f32_e64 v22, v22
    v_mfma_f32_32x32x16_bf16 v[128:143], v[172:175], v[200:203], v[128:143]
    v_exp_f32 v23, v23
    v_exp_f32 v24, v24
    v_exp_f32_e64 v25, v25
    v_smfmac_f32_32x32x32_bf16 v[64:79], v[108:111], v[16:23], v124
    v_exp_f32 v26, v26
    v_exp_f32 v27, v27
    v_exp_f32_e64 v28, v28
    v_mfma_f32_32x32x16_bf16 v[144:159], v[172:175], v[204:207], v[144:159]
    v_exp_f32 v29, v29
    v_exp_f32 v30, v30
    v_exp_f32 v31, v31
    s_branch L_pg183
.p2align 12
L_stub183:
    s_nop 0
    s_setpc_b64 s[0:1]
L_pg183:
    s_waitcnt lgkmcnt(0)
    ds_write_b128 v125, v[224:227] offset:8192
    ds_write_b128 v125, v[228:231] offset:9216
    ds_write_b32 v3, v232 offset:28676
    ds_read_b64_tr_b16 v[172:173], v127 offset:14336
    ds_read_b64_tr_b16 v[174:175], v127 offset:14848
    s_setprio 3
.p2align 3
    v_exp_f32 v32, v32
    v_exp_f32 v33, v33
    v_smfmac_f32_32x32x32_bf16 v[64:79], v[112:115], v[24:31], v124
    v_exp_f32 v34, v34
    v_exp_f32 v35, v35
    v_exp_f32 v36, v36
    v_exp_f32 v37, v37
    s_waitcnt vmcnt(0) lgkmcnt(0)
    s_barrier
    v_exp_f32 v38, v38
    v_exp_f32 v39, v39
    v_exp_f32 v40, v40
    ds_read_b128 v[192:195], v125 offset:0
    ds_read_b128 v[196:199], v125 offset:1024
    ds_read_b32 v200, v3 offset:28672
    v_exp_f32 v41, v41
    v_exp_f32 v42, v42
    v_exp_f32 v43, v43
    v_smfmac_f32_32x32x32_bf16 v[64:79], v[116:119], v[32:39], v124
    v_exp_f32 v44, v44
    v_exp_f32 v45, v45
    v_exp_f32 v46, v46
    v_exp_f32 v47, v47
    s_setprio 0
    s_nop 1
    v_smfmac_f32_32x32x32_bf16 v[64:79], v[120:123], v[40:47], v124
    s_mov_b32 s70, 0x7b800000
    s_mov_b32 s71, 0xa800000
    s_add_u32 s69, s83, 4096
    s_mov_b32 s81, 0
    s_lshl_b32 s68, s56, 13
    s_mov_b32 m0, s68
    s_waitcnt lgkmcnt(0)
    s_nop 4
    v_add_f32 v72, v72, v200
    v_add_f32 v64, v64, v192
    v_add_f32 v65, v65, v193
    v_add_f32 v66, v66, v194
    v_add_f32 v67, v67, v195
    v_add_f32 v68, v68, v196
    v_add_f32 v69, v69, v197
    v_add_f32 v70, v70, v198
    v_add_f32 v71, v71, v199
    v_rcp_f32 v10, v72
    v_maximum3_f32 v8, abs(v64), abs(v65), abs(v66)
    v_maximum3_f32 v9, abs(v67), abs(v68), abs(v69)
    v_maximum3_f32 v8, abs(v70), abs(v71), v8
    v_maximum3_f32 v6, v8, v9, v72
    v_max_f32 v8, v8, v9
    v_cmp_ngt_f32 vcc, s70, v6
    v_cmp_gt_f32 s[84:85], s71, v8
    v_mov_b32 v11, v10
    s_or_b64 vcc, vcc, s[84:85]
    s_cbranch_scc1 L_fb
    v_pk_mul_f32 v[64:65], v[64:65], v[10:11]
    v_pk_mul_f32 v[66:67], v[66:67], v[10:11]
    v_pk_mul_f32 v[68:69], v[68:69], v[10:11]
    v_pk_mul_f32 v[70:71], v[70:71], v[10:11]
    v_cvt_pk_bf16_f32 v12, v64, v65
    v_cvt_pk_bf16_f32 v13, v66, v67
    v_cvt_pk_bf16_f32 v14, v68, v69
    v_cvt_pk_bf16_f32 v15, v70, v71
L_ostB:
    buffer_store_dwordx4 v[12:15], v208, s[52:55], s72 offen sc1
    ds_write_addtid_b32 v128 offset:32768
    ds_write_addtid_b32 v129 offset:33024
    ds_write_addtid_b32 v130 offset:33280
    ds_write_addtid_b32 v131 offset:33536
    ds_write_addtid_b32 v132 offset:33792
    ds_write_addtid_b32 v133 offset:34048
    ds_write_addtid_b32 v134 offset:34304
    ds_write_addtid_b32 v135 offset:34560
    ds_write_addtid_b32 v136 offset:34816
    ds_write_addtid_b32 v137 offset:35072
    ds_write_addtid_b32 v138 offset:35328
    ds_write_addtid_b32 v139 offset:35584
    ds_write_addtid_b32 v140 offset:35840
    ds_write_addtid_b32 v141 offset:36096
    ds_write_addtid_b32 v142 offset:36352
    ds_write_addtid_b32 v143 offset:36608
    ds_write_addtid_b32 v144 offset:36864
    ds_write_addtid_b32 v145 offset:37120
    ds_write_addtid_b32 v146 offset:37376
    ds_write_addtid_b32 v147 offset:37632
    ds_write_addtid_b32 v148 offset:37888
    ds_write_addtid_b32 v149 offset:38144
    ds_write_addtid_b32 v150 offset:38400
    ds_write_addtid_b32 v151 offset:38656
    ds_write_addtid_b32 v152 offset:38912
    ds_write_addtid_b32 v153 offset:39168
    ds_write_addtid_b32 v154 offset:39424
    ds_write_addtid_b32 v155 offset:39680
    ds_write_addtid_b32 v156 offset:39936
    ds_write_addtid_b32 v157 offset:40192
    ds_write_addtid_b32 v158 offset:40448
    ds_write_addtid_b32 v159 offset:40704
    v_xor_b32 v5, 16, v0
    v_add_u32 v6, 0x10000, v0
    v_add_u32 v7, 0x10000, v5
    s_mov_b32 s84, 0xff00ff00
    s_mov_b32 s85, 0xff00ff00
    s_mov_b64 exec, s[84:85]
    v_swap_b32 v216, v218
    v_swap_b32 v217, v219
    s_mov_b64 exec, -1
    v_lshlrev_b32 v224, 16, v216
    v_and_b32 v225, 0xffff0000, v216
    v_lshlrev_b32 v226, 16, v217
    v_and_b32 v227, 0xffff0000, v217
    v_lshlrev_b32 v228, 16, v218
    v_and_b32 v229, 0xffff0000, v218
    v_lshlrev_b32 v230, 16, v219
    v_and_b32 v231, 0xffff0000, v219
    v_mov_b64 v[64:65], 0
    v_mov_b64 v[66:67], 0
    v_mov_b64 v[68:69], 0
    v_mov_b64 v[70:71], 0
    v_mov_b64 v[72:73], 0
    v_mov_b64 v[74:75], 0
    v_mov_b64 v[76:77], 0
    v_mov_b64 v[78:79], 0
    v_mov_b64 v[80:81], 0
    v_mov_b64 v[82:83], 0
    v_mov_b64 v[84:85], 0
    v_mov_b64 v[86:87], 0
    v_mov_b64 v[88:89], 0
    v_mov_b64 v[90:91], 0
    v_mov_b64 v[92:93], 0
    v_mov_b64 v[94:95], 0
    s_waitcnt lgkmcnt(0)
    s_barrier
    s_add_u32 m0, s68, 7940
    ds_read_b128 v[128:131], v0 offset:32768
    ds_read_b128 v[132:135], v5 offset:32768
    ds_read_b128 v[136:139], v0 offset:49152
    ds_read_b128 v[140:143], v5 offset:49152
    ds_read_b128 v[144:147], v6 offset:0
    ds_read_b128 v[148:151], v7 offset:0
    ds_read_b128 v[152:155], v6 offset:16384
    ds_read_b128 v[156:159], v7 offset:16384
    s_waitcnt lgkmcnt(0)
    buffer_load_dwordx4 v[16:19], v208, s[52:55], s83 offen offset:0 sc1
    v_add_f32 v128, v128, v136
    v_add_f32 v129, v129, v137
    v_add_f32 v130, v130, v138
    v_add_f32 v131, v131, v139
    v_add_f32 v132, v132, v140
    buffer_load_dwordx4 v[20:23], v208, s[52:55], s83 offen offset:1024 sc1
    v_add_f32 v133, v133, v141
    v_add_f32 v134, v134, v142
    v_add_f32 v135, v135, v143
    v_add_f32 v128, v128, v144
    v_add_f32 v129, v129, v145
    buffer_load_dwordx4 v[24:27], v208, s[52:55], s69 offen offset:0 sc1
    v_add_f32 v130, v130, v146
    v_add_f32 v131, v131, v147
    v_add_f32 v132, v132, v148
    v_add_f32 v133, v133, v149
    v_add_f32 v134, v134, v150
    buffer_load_dwordx4 v[28:31], v208, s[52:55], s69 offen offset:1024 sc1
    v_add_f32 v135, v135, v151
    v_add_f32 v128, v128, v152
    v_add_f32 v129, v129, v153
    v_add_f32 v130, v130, v154
    v_add_f32 v131, v131, v155
    buffer_load_dwordx4 v[32:35], v208, s[52:55], s83 offen offset:2048 sc1
    v_add_f32 v132, v132, v156
    v_add_f32 v133, v133, v157
    v_add_f32 v134, v134, v158
    v_add_f32 v135, v135, v159
    v_mul_f32 v232, 0xbfb8aa3b, v128
    buffer_load_dwordx4 v[36:39], v208, s[52:55], s83 offen offset:3072 sc1
    v_mul_f32 v233, 0xbfb8aa3b, v129
    v_mul_f32 v234, 0xbfb8aa3b, v130
    v_mul_f32 v235, 0xbfb8aa3b, v131
    v_mul_f32 v236, 0xbfb8aa3b, v132
    v_mul_f32 v237, 0xbfb8aa3b, v133
    buffer_load_dwordx4 v[40:43], v208, s[52:55], s69 offen offset:2048 sc1
    v_mul_f32 v238, 0xbfb8aa3b, v134
    v_mul_f32 v239, 0xbfb8aa3b, v135
    v_exp_f32 v232, v232
    v_exp_f32 v233, v233
    v_exp_f32 v234, v234
    buffer_load_dwordx4 v[44:47], v208, s[52:55], s69 offen offset:3072 sc1
    v_exp_f32 v235, v235
    v_exp_f32 v236, v236
    v_exp_f32 v237, v237
    v_exp_f32 v238, v238
    v_exp_f32 v239, v239
    v_add_f32 v232, 1.0, v232
    v_add_f32 v233, 1.0, v233
    v_add_f32 v234, 1.0, v234
    v_add_f32 v235, 1.0, v235
    v_add_f32 v236, 1.0, v236
    v_add_f32 v237, 1.0, v237
    v_add_f32 v238, 1.0, v238
    v_add_f32 v239, 1.0, v239
    v_rcp_f32 v232, v232
    v_rcp_f32 v233, v233
    v_rcp_f32 v234, v234
    v_rcp_f32 v235, v235
    v_rcp_f32 v236, v236
    v_rcp_f32 v237, v237
    v_rcp_f32 v238, v238
    v_rcp_f32 v239, v239
    v_mul_f32 v128, v128, v232
    v_mul_f32 v129, v129, v233
    v_mul_f32 v130, v130, v234
    v_mul_f32 v131, v131, v235
    v_mul_f32 v132, v132, v236
    v_mul_f32 v133, v133, v237
    v_mul_f32 v134, v134, v238
    v_mul_f32 v135, v135, v239
    s_setprio 1
    s_waitcnt vmcnt(7)
    v_max3_u32 v8, v16, v17, v18
    v_max_u32 v8, v19, v8
    v_cmp_eq_u32 vcc, -1, v8
    s_movk_i32 s88, 255
    s_cbranch_vccnz L_omissB
    v_mfma_f32_32x32x16_bf16 v[64:79], v[16:19], v[240:243], v[64:79]
    s_waitcnt vmcnt(6)
    v_max3_u32 v8, v20, v21, v22
    v_max_u32 v8, v23, v8
    v_cmp_eq_u32 vcc, -1, v8
    s_movk_i32 s88, 254
    v_mfma_f32_32x32x16_bf16 v[80:95], v[16:19], v[244:247], v[80:95]
    s_cbranch_vccnz L_omissB
    v_mfma_f32_32x32x16_bf16 v[64:79], v[20:23], v[248:251], v[64:79]
    s_waitcnt vmcnt(5)
    v_max3_u32 v8, v24, v25, v26
    v_max_u32 v8, v27, v8
    v_cmp_eq_u32 vcc, -1, v8
    s_movk_i32 s88, 252
    v_mfma_f32_32x32x16_bf16 v[80:95], v[20:23], v[176:179], v[80:95]
    s_cbranch_vccnz L_omissB
    v_mfma_f32_32x32x16_bf16 v[64:79], v[24:27], v[180:183], v[64:79]
    s_waitcnt vmcnt(4)
    v_max3_u32 v8, v28, v29, v30
    v_max_u32 v8, v31, v8
    v_cmp_eq_u32 vcc, -1, v8
    s_movk_i32 s88, 248
    v_mfma_f32_32x32x16_bf16 v[80:95], v[24:27], v[184:187], v[80:95]
    s_cbranch_vccnz L_omissB
    v_mfma_f32_32x32x16_bf16 v[64:79], v[28:31], v[188:191], v[64:79]
    s_waitcnt vmcnt(3)
    v_max3_u32 v8, v32, v33, v34
    v_max_u32 v8, v35, v8
    v_cmp_eq_u32 vcc, -1, v8
    s_movk_i32 s88, 240
    v_mfma_f32_32x32x16_bf16 v[80:95], v[28:31], v[160:163], v[80:95]
    s_cbranch_vccnz L_omissB
    v_mfma_f32_32x32x16_bf16 v[64:79], v[32:35], v[48:51], v[64:79]
    s_waitcnt vmcnt(2)
    v_max3_u32 v8, v36, v37, v38
    v_max_u32 v8, v39, v8
    v_cmp_eq_u32 vcc, -1, v8
    s_movk_i32 s88, 224
    v_mfma_f32_32x32x16_bf16 v[80:95], v[32:35], v[52:55], v[80:95]
    s_cbranch_vccnz L_omissB
    v_mfma_f32_32x32x16_bf16 v[64:79], v[36:39], v[164:167], v[64:79]
    s_waitcnt vmcnt(1)
    v_max3_u32 v8, v40, v41, v42
    v_max_u32 v8, v43, v8
    v_cmp_eq_u32 vcc, -1, v8
    s_movk_i32 s88, 192
    v_mfma_f32_32x32x16_bf16 v[80:95], v[36:39], v[56:59], v[80:95]
    s_cbranch_vccnz L_omissB
    v_mfma_f32_32x32x16_bf16 v[64:79], v[40:43], v[60:63], v[64:79]
    s_waitcnt vmcnt(0)
    v_max3_u32 v8, v44, v45, v46
    v_max_u32 v8, v47, v8
    v_cmp_eq_u32 vcc, -1, v8
    s_movk_i32 s88, 128
    v_mfma_f32_32x32x16_bf16 v[80:95], v[40:43], v[168:171], v[80:95]
    s_cbranch_vccnz L_omissB
    v_mfma_f32_32x32x16_bf16 v[64:79], v[44:47], v[96:99], v[64:79]
    v_mfma_f32_32x32x16_bf16 v[80:95], v[44:47], v[172:175], v[80:95]
L_ookB:
    s_nop 10
    ds_write_addtid_b32 v64 offset:57596
    ds_write_addtid_b32 v65 offset:57852
    ds_write_addtid_b32 v66 offset:58108
    ds_write_addtid_b32 v67 offset:58364
    ds_write_addtid_b32 v68 offset:58620
    ds_write_addtid_b32 v69 offset:58876
    ds_write_addtid_b32 v70 offset:59132
    ds_write_addtid_b32 v71 offset:59388
    ds_write_addtid_b32 v72 offset:59644
    ds_write_addtid_b32 v73 offset:59900
    ds_write_addtid_b32 v74 offset:60156
    ds_write_addtid_b32 v75 offset:60412
    ds_write_addtid_b32 v76 offset:60668
    ds_write_addtid_b32 v77 offset:60924
    ds_write_addtid_b32 v78 offset:61180
    ds_write_addtid_b32 v79 offset:61436
    ds_write_addtid_b32 v80 offset:61692
    ds_write_addtid_b32 v81 offset:61948
    ds_write_addtid_b32 v82 offset:62204
    ds_write_addtid_b32 v83 offset:62460
    ds_write_addtid_b32 v84 offset:62716
    ds_write_addtid_b32 v85 offset:62972
    ds_write_addtid_b32 v86 offset:63228
    ds_write_addtid_b32 v87 offset:63484
    ds_write_addtid_b32 v88 offset:63740
    ds_write_addtid_b32 v89 offset:63996
    ds_write_addtid_b32 v90 offset:64252
    ds_write_addtid_b32 v91 offset:64508
    ds_write_addtid_b32 v92 offset:64764
    ds_write_addtid_b32 v93 offset:65020
    ds_write_addtid_b32 v94 offset:65276
    ds_write_addtid_b32 v95 offset:65532
L_fin2:
    s_waitcnt lgkmcnt(0)
    s_barrier
    ds_read_b128 v[16:19], v0 offset:0
    ds_read_b128 v[20:23], v5 offset:0
    ds_read_b128 v[24:27], v0 offset:16384
    ds_read_b128 v[28:31], v5 offset:16384
    ds_read_b128 v[32:35], v6 offset:32768
    ds_read_b128 v[36:39], v7 offset:32768
    ds_read_b128 v[40:43], v6 offset:49152
    ds_read_b128 v[44:47], v7 offset:49152
    s_waitcnt lgkmcnt(4)
    v_pk_add_f32 v[16:17], v[16:17], v[24:25]
    v_pk_add_f32 v[18:19], v[18:19], v[26:27]
    v_pk_add_f32 v[20:21], v[20:21], v[28:29]
    v_pk_add_f32 v[22:23], v[22:23], v[30:31]
    s_waitcnt lgkmcnt(0)
    v_pk_add_f32 v[32:33], v[32:33], v[40:41]
    v_pk_add_f32 v[34:35], v[34:35], v[42:43]
    v_pk_add_f32 v[36:37], v[36:37], v[44:45]
    v_pk_add_f32 v[38:39], v[38:39], v[46:47]
    v_pk_add_f32 v[16:17], v[16:17], v[32:33]
    v_pk_add_f32 v[18:19], v[18:19], v[34:35]
    v_pk_add_f32 v[20:21], v[20:21], v[36:37]
    v_pk_add_f32 v[22:23], v[22:23], v[38:39]
    v_pk_fma_f32 v[16:17], v[16:17], v[128:129], v[224:225]
    v_pk_fma_f32 v[18:19], v[18:19], v[130:131], v[226:227]
    v_pk_fma_f32 v[20:21], v[20:21], v[132:133], v[228:229]
    v_pk_fma_f32 v[22:23], v[22:23], v[134:135], v[230:231]
    v_cvt_pk_bf16_f32 v12, v16, v17
    v_cvt_pk_bf16_f32 v13, v18, v19
    v_cvt_pk_bf16_f32 v14, v20, v21
    v_cvt_pk_bf16_f32 v15, v22, v23
    s_mov_b64 exec, s[84:85]
    v_swap_b32 v12, v14
    v_swap_b32 v13, v15
    s_mov_b64 exec, -1
    buffer_store_dwordx4 v[12:15], v215, s[44:47], 0 offen sc1
L_end:
    s_endpgm
L_omissB:
    s_call_b64 s[0:1], L_ofix
    s_branch L_ookB
L_omissA:
    s_call_b64 s[0:1], L_ofix
    s_branch L_ookA
L_ofix:
    s_mov_b32 s70, 0
    s_waitcnt vmcnt(0)
    s_bitcmp1_b32 s88, 0
    s_cbranch_scc0 L_ofb0
    v_max3_u32 v8, v16, v17, v18
    v_max_u32 v8, v19, v8
    v_cmp_eq_u32 vcc, -1, v8
    s_cmp_lg_u32 s70, 0
    s_cbranch_vccz L_ofa0
    buffer_load_dwordx4 v[16:19], v208, s[52:55], s83 offen offset:0 sc1
    s_mov_b32 s70, 1
    s_branch L_ofb0
L_ofa0:
    s_cbranch_scc1 L_ofb0
    s_bitset0_b32 s88, 0
    v_mfma_f32_32x32x16_bf16 v[64:79], v[16:19], v[240:243], v[64:79]
    v_mfma_f32_32x32x16_bf16 v[80:95], v[16:19], v[244:247], v[80:95]
L_ofb0:
    s_bitcmp1_b32 s88, 1
    s_cbranch_scc0 L_ofb1
    v_max3_u32 v8, v20, v21, v22
    v_max_u32 v8, v23, v8
    v_cmp_eq_u32 vcc, -1, v8
    s_cmp_lg_u32 s70, 0
    s_cbranch_vccz L_ofa1
    buffer_load_dwordx4 v[20:23], v208, s[52:55], s83 offen offset:1024 sc1
    s_mov_b32 s70, 1
    s_branch L_ofb1
L_ofa1:
    s_cbranch_scc1 L_ofb1
    s_bitset0_b32 s88, 1
    v_mfma_f32_32x32x16_bf16 v[64:79], v[20:23], v[248:251], v[64:79]
    v_mfma_f32_32x32x16_bf16 v[80:95], v[20:23], v[176:179], v[80:95]
L_ofb1:
    s_bitcmp1_b32 s88, 2
    s_cbranch_scc0 L_ofb2
    v_max3_u32 v8, v24, v25, v26
    v_max_u32 v8, v27, v8
    v_cmp_eq_u32 vcc, -1, v8
    s_cmp_lg_u32 s70, 0
    s_cbranch_vccz L_ofa2
    buffer_load_dwordx4 v[24:27], v208, s[52:55], s69 offen offset:0 sc1
    s_mov_b32 s70, 1
    s_branch L_ofb2
L_ofa2:
    s_cbranch_scc1 L_ofb2
    s_bitset0_b32 s88, 2
    v_mfma_f32_32x32x16_bf16 v[64:79], v[24:27], v[180:183], v[64:79]
    v_mfma_f32_32x32x16_bf16 v[80:95], v[24:27], v[184:187], v[80:95]
L_ofb2:
    s_bitcmp1_b32 s88, 3
    s_cbranch_scc0 L_ofb3
    v_max3_u32 v8, v28, v29, v30
    v_max_u32 v8, v31, v8
    v_cmp_eq_u32 vcc, -1, v8
    s_cmp_lg_u32 s70, 0
    s_cbranch_vccz L_ofa3
    buffer_load_dwordx4 v[28:31], v208, s[52:55], s69 offen offset:1024 sc1
    s_mov_b32 s70, 1
    s_branch L_ofb3
L_ofa3:
    s_cbranch_scc1 L_ofb3
    s_bitset0_b32 s88, 3
    v_mfma_f32_32x32x16_bf16 v[64:79], v[28:31], v[188:191], v[64:79]
    v_mfma_f32_32x32x16_bf16 v[80:95], v[28:31], v[160:163], v[80:95]
L_ofb3:
    s_bitcmp1_b32 s88, 4
    s_cbranch_scc0 L_ofb4
    v_max3_u32 v8, v32, v33, v34
    v_max_u32 v8, v35, v8
    v_cmp_eq_u32 vcc, -1, v8
    s_cmp_lg_u32 s70, 0
    s_cbranch_vccz L_ofa4
    buffer_load_dwordx4 v[32:35], v208, s[52:55], s83 offen offset:2048 sc1
    s_mov_b32 s70, 1
    s_branch L_ofb4
L_ofa4:
    s_cbranch_scc1 L_ofb4
    s_bitset0_b32 s88, 4
    v_mfma_f32_32x32x16_bf16 v[64:79], v[32:35], v[48:51], v[64:79]
    v_mfma_f32_32x32x16_bf16 v[80:95], v[32:35], v[52:55], v[80:95]
L_ofb4:
    s_bitcmp1_b32 s88, 5
    s_cbranch_scc0 L_ofb5
    v_max3_u32 v8, v36, v37, v38
    v_max_u32 v8, v39, v8
    v_cmp_eq_u32 vcc, -1, v8
    s_cmp_lg_u32 s70, 0
    s_cbranch_vccz L_ofa5
    buffer_load_dwordx4 v[36:39], v208, s[52:55], s83 offen offset:3072 sc1
    s_mov_b32 s70, 1
    s_branch L_ofb5
L_ofa5:
    s_cbranch_scc1 L_ofb5
    s_bitset0_b32 s88, 5
    v_mfma_f32_32x32x16_bf16 v[64:79], v[36:39], v[164:167], v[64:79]
    v_mfma_f32_32x32x16_bf16 v[80:95], v[36:39], v[56:59], v[80:95]
L_ofb5:
    s_bitcmp1_b32 s88, 6
    s_cbranch_scc0 L_ofb6
    v_max3_u32 v8, v40, v41, v42
    v_max_u32 v8, v43, v8
    v_cmp_eq_u32 vcc, -1, v8
    s_cmp_lg_u32 s70, 0
    s_cbranch_vccz L_ofa6
    buffer_load_dwordx4 v[40:43], v208, s[52:55], s69 offen offset:2048 sc1
    s_mov_b32 s70, 1
    s_branch L_ofb6
L_ofa6:
    s_cbranch_scc1 L_ofb6
    s_bitset0_b32 s88, 6
    v_mfma_f32_32x32x16_bf16 v[64:79], v[40:43], v[60:63], v[64:79]
    v_mfma_f32_32x32x16_bf16 v[80:95], v[40:43], v[168:171], v[80:95]
L_ofb6:
    s_bitcmp1_b32 s88, 7
    s_cbranch_scc0 L_ofb7
    v_max3_u32 v8, v44, v45, v46
    v_max_u32 v8, v47, v8
    v_cmp_eq_u32 vcc, -1, v8
    s_cmp_lg_u32 s70, 0
    s_cbranch_vccz L_ofa7
    buffer_load_dwordx4 v[44:47], v208, s[52:55], s69 offen offset:3072 sc1
    s_mov_b32 s70, 1
    s_branch L_ofb7
L_ofa7:
    s_cbranch_scc1 L_ofb7
    s_bitset0_b32 s88, 7
    v_mfma_f32_32x32x16_bf16 v[64:79], v[44:47], v[96:99], v[64:79]
    v_mfma_f32_32x32x16_bf16 v[80:95], v[44:47], v[172:175], v[80:95]
L_ofb7:
    s_add_u32 s81, s81, 1
    s_cmp_ge_u32 s81, 262144
    s_cselect_b32 s88, 0, s88
    s_cmp_lg_u32 s88, 0
    s_cbranch_scc1 L_ofix
    s_setpc_b64 s[0:1]
L_hspinA:
    s_mov_b32 s81, 0
L_hchkA:
    s_sleep 2
    buffer_load_dword v3, v214, s[52:55], s70 offen sc1
    s_waitcnt vmcnt(0)
    v_cmp_ne_u32 vcc, 1, v3
    s_add_u32 s81, s81, 1
    s_cbranch_vccz L_hokA
    s_cmp_lt_u32 s81, 262144
    s_cbranch_scc1 L_hchkA
    s_branch L_hokA
L_hspinB:
    s_mov_b32 s81, 0
L_hchkB:
    s_sleep 2
    buffer_load_dword v3, v214, s[52:55], s70 offen sc1
    s_waitcnt vmcnt(0)
    v_cmp_ne_u32 vcc, 1, v3
    s_add_u32 s81, s81, 1
    s_cbranch_vccz L_hokB
    s_cmp_lt_u32 s81, 262144
    s_cbranch_scc1 L_hchkB
    s_branch L_hokB
L_fb:
    v_mov_b32 v8, 0xff800000
    s_mov_b32 s88, 0
    v_subrev_u32 v10, 0, v211
L_fb1:
    buffer_load_dwordx4 v[100:103], v208, s[52:55], s88 offen sc1
    s_waitcnt vmcnt(0)
    v_mfma_f32_32x32x16_bf16 v[16:31], v[100:103], v[220:223], 0
    s_nop 11
    v_max3_f32 v8, v16, v17, v8
    v_max3_f32 v8, v18, v19, v8
    v_max3_f32 v8, v20, v21, v8
    v_max3_f32 v8, v22, v23, v8
    v_max3_f32 v8, v24, v25, v8
    v_max3_f32 v8, v26, v27, v8
    v_max3_f32 v8, v28, v29, v8
    v_max3_f32 v8, v30, v31, v8
    s_add_u32 s88, s88, 2048
    s_cmp_lt_u32 s88, 131072
    s_cbranch_scc1 L_fb1
    v_mov_b32 v9, v8
    s_nop 1
    v_permlane32_swap_b32 v8, v9
    v_max_f32 v8, v8, v9
    v_sub_f32 v80, 0, v8
    v_mov_b32 v81, v80
    v_mov_b64 v[82:83], v[80:81]
    v_mov_b64 v[84:85], v[80:81]
    v_mov_b64 v[86:87], v[80:81]
    v_mov_b64 v[88:89], v[80:81]
    v_mov_b64 v[90:91], v[80:81]
    v_mov_b64 v[92:93], v[80:81]
    v_mov_b64 v[94:95], v[80:81]
    v_mov_b32 v64, 0
    v_mov_b32 v65, 0
    v_mov_b32 v66, 0
    v_mov_b32 v67, 0
    v_mov_b32 v68, 0
    v_mov_b32 v69, 0
    v_mov_b32 v70, 0
    v_mov_b32 v71, 0
    v_mov_b32 v72, 0
    v_mov_b32 v73, 0
    v_mov_b32 v74, 0
    v_mov_b32 v75, 0
    v_mov_b32 v76, 0
    v_mov_b32 v77, 0
    v_mov_b32 v78, 0
    v_mov_b32 v79, 0
    s_mov_b32 s88, 0
L_fb2:
    buffer_load_dwordx4 v[100:103], v208, s[52:55], s88 offen sc1
    s_mov_b64 exec, s[62:63]
    buffer_load_dwordx4 v[108:111], v10, s[52:55], s88 offen sc1
    buffer_load_dwordx4 v[112:115], v10, s[52:55], s88 offen offset:512 sc1
    s_mov_b64 exec, -1
    s_waitcnt vmcnt(0)
    v_mfma_f32_32x32x16_bf16 v[16:31], v[100:103], v[220:223], v[80:95]
    s_nop 11
    v_exp_f32 v16, v16
    v_exp_f32 v17, v17
    v_exp_f32 v18, v18
    v_exp_f32 v19, v19
    v_exp_f32 v20, v20
    v_exp_f32 v21, v21
    v_exp_f32 v22, v22
    v_exp_f32 v23, v23
    v_exp_f32 v24, v24
    v_exp_f32 v25, v25
    v_exp_f32 v26, v26
    v_exp_f32 v27, v27
    v_exp_f32 v28, v28
    v_exp_f32 v29, v29
    v_exp_f32 v30, v30
    v_exp_f32 v31, v31
    s_nop 1
    v_smfmac_f32_32x32x32_bf16 v[64:79], v[108:111], v[16:23], v124
    v_smfmac_f32_32x32x32_bf16 v[64:79], v[112:115], v[24:31], v124
    s_add_u32 s88, s88, 2048
    s_cmp_lt_u32 s88, 131072
    s_cbranch_scc1 L_fb2
    s_nop 11
    v_rcp_f32 v10, v72
    s_nop 0
    v_mov_b32 v11, v10
    v_pk_mul_f32 v[64:65], v[64:65], v[10:11]
    v_pk_mul_f32 v[66:67], v[66:67], v[10:11]
    v_pk_mul_f32 v[68:69], v[68:69], v[10:11]
    v_pk_mul_f32 v[70:71], v[70:71], v[10:11]
    v_cvt_pk_bf16_f32 v12, v64, v65
    v_cvt_pk_bf16_f32 v13, v66, v67
    v_cvt_pk_bf16_f32 v14, v68, v69
    v_cvt_pk_bf16_f32 v15, v70, v71
    v_min_u32 v12, -2, v12
    v_min_u32 v13, -2, v13
    v_min_u32 v14, -2, v14
    v_min_u32 v15, -2, v15
    s_cmp_ge_u32 s56, 4
    s_cbranch_scc1 L_ostB
    s_branch L_ostA
L_code_end:
.section .rodata,"a"
.p2align 6
.amdhsa_kernel recurrent_scan__grouped_kv_mqa__glu_gated_geglu__prompt_kernel
  .amdhsa_next_free_vgpr 256
  .amdhsa_next_free_sgpr 102
  .amdhsa_accum_offset 256
  .amdhsa_group_segment_fixed_size 0
  .amdhsa_kernarg_size 96
  .amdhsa_user_sgpr_count 2
  .amdhsa_user_sgpr_kernarg_segment_ptr 1
  .amdhsa_system_sgpr_workgroup_id_x 1
.end_amdhsa_kernel
```
